```python
import torch

def _softmax(x, axis=-1):
    return torch.softmax(x, dim=axis)
def _gelu(x):
    return torch.nn.functional.gelu(x, approximate="tanh")
def _silu(x):
    return torch.nn.functional.silu(x)
def _sigmoid(x):
    return torch.sigmoid(x)
def _layernorm(x, axis=-1, eps=1e-5):
    m = x.mean(dim=axis, keepdim=True)
    v = x.var(dim=axis, keepdim=True, unbiased=False)
    return (x - m) / torch.sqrt(v + eps)
def _scatter_add(tgt, idx, src, axis=0):
    return tgt.clone().index_add_(axis, idx, src)
def _segment_sum(src, seg, n):
    out = torch.zeros((n,) + src.shape[1:], dtype=src.dtype)
    return out.index_add_(0, seg, src)
def _pad(x, pw):
    flat = tuple(v for pair in reversed(pw) for v in pair)
    return torch.nn.functional.pad(x, flat)

kernel_name = 'sequential_preLN__spectral_fnet__geglu_ffn__prompt'

def setup_inputs():

    _w = (lambda a: (lambda t: t.to(torch.bfloat16) if t.is_floating_point() else t)(torch.as_tensor(a)))
    def _A_setup():
        B, S, D = 1, 2048, 640
        ns = torch.arange(S)[:, None] * torch.arange(S)[None, :]
        nd = torch.arange(D)[:, None] * torch.arange(D)[None, :]
        Ws_re = torch.cos(-2.0 * torch.pi * ns / S).to(float)
        Ws_im = torch.sin(-2.0 * torch.pi * ns / S).to(float)
        Wd_re = torch.cos(-2.0 * torch.pi * nd / D).to(float)
        Wd_im = torch.sin(-2.0 * torch.pi * nd / D).to(float)
        return {
            "x": _w((lambda *s: torch.randn(*s, dtype=torch.bfloat16) * 0.05)(B, S, D)),
            "dft_seq_re": _w(Ws_re),
            "dft_seq_im": _w(Ws_im),
            "dft_hid_re": _w(Wd_re),
            "dft_hid_im": _w(Wd_im),
        }
    _A_in = _A_setup()

    def _B_setup():
        B, S, D, F = 1, 2048, 640, 1536
        return {
            "x": _w((lambda *s: torch.randn(*s, dtype=torch.bfloat16) * 0.05)(B, S, D)),
            "w_gate": _w((lambda *s: torch.randn(*s, dtype=torch.bfloat16) * 0.2)(D, F)),
            "w_up": _w((lambda *s: torch.randn(*s, dtype=torch.bfloat16) * 0.2)(D, F)),
            "w_down": _w((lambda *s: torch.randn(*s, dtype=torch.bfloat16) * 0.2)(F, D)),
        }
    _B_in = _B_setup()

    return {
        "A_x": _A_in["x"],
        "A_dft_seq_re": _A_in["dft_seq_re"],
        "A_dft_seq_im": _A_in["dft_seq_im"],
        "A_dft_hid_re": _A_in["dft_hid_re"],
        "A_dft_hid_im": _A_in["dft_hid_im"],
        "B_x": _B_in["x"],
        "B_w_gate": _B_in["w_gate"],
        "B_w_up": _B_in["w_up"],
        "B_w_down": _B_in["w_down"],
    }

def reference(A_x, A_dft_seq_re, A_dft_seq_im, A_dft_hid_re, A_dft_hid_im, B_x, B_w_gate, B_w_up, B_w_down):
    def _A_ref(x, dft_seq_re, dft_seq_im, dft_hid_re, dft_hid_im):
        a = torch.einsum("bsd,ed->bse", x, dft_hid_re)
        b = torch.einsum("bsd,ed->bse", x, dft_hid_im)
        y = torch.einsum("ts,bse->bte", dft_seq_re, a) - torch.einsum("ts,bse->bte", dft_seq_im, b)
        return y

    def _B_ref(x, w_gate, w_up, w_down):
        return (_gelu(x @ w_gate) * (x @ w_up)) @ w_down

    x = A_x
    h = x + _A_ref(_layernorm(x, axis=-1), A_dft_seq_re, A_dft_seq_im, A_dft_hid_re, A_dft_hid_im)
    h2 = h + _B_ref(_layernorm(h, axis=-1), B_w_gate, B_w_up, B_w_down)
    return h2
```

```asm
; @launch kernel=kf_kernel grid=(256,1,1) block=(256,1,1) lds=163840
.amdgcn_target "amdgcn-amd-amdhsa--gfx950"
.text
.globl kf_kernel
.p2align 12
.p2align 8
.type kf_kernel,@function
kf_kernel:
    s_cmp_ge_u32 s2, 256
    s_cbranch_scc1 kf_kernel_end
    s_xor_b32 s2, s2, 1
    s_load_dwordx16 s[16:31], s[0:1], 0
    s_load_dwordx8 s[32:39], s[0:1], 64
    s_memrealtime s[96:97]
    v_and_b32 v1, 63, v0
    v_lshrrev_b32 v4, 6, v0
    v_and_b32 v2, 15, v1
    v_lshrrev_b32 v3, 4, v1
    v_readfirstlane_b32 s64, v4
    s_nop 1
    s_getpc_b64 s[40:41]
kf_pc:
    s_lshr_b32 s7, s2, 3
    s_mul_i32 s8, s7, 57
    s_lshr_b32 s8, s8, 9
    s_mul_i32 s8, s8, 9
    s_sub_u32 s7, s7, s8
    s_lshl_b32 s7, s7, 2
    s_add_u32 s7, s7, s64
    s_lshl_b32 s7, s7, 11
    v_lshlrev_b32 v5, 7, v2
    v_add_u32 v5, s7, v5
    v_min_u32 v5, kf_code_end - kf_pc - 4, v5
    s_mov_b64 exec, 0xffff
    global_load_dword v255, v5, s[40:41]
    s_mov_b64 exec, -1
    s_and_b32 s7, s2, 7
    s_lshr_b32 s8, s2, 3
    s_and_b32 s65, s7, 3
    s_and_b32 s73, s8, 3
    s_lshl2_add_u32 s65, s65, s73
    s_lshr_b32 s9, s8, 2
    v_lshrrev_b32 v5, 3, v1
    v_and_b32 v6, 7, v1
    v_mul_u32_u24 v7, 1280, v5
    s_lshl2_add_u32 s75, s65, s64
    s_mul_i32 s75, s75, 40960
    v_and_b32 v8, 3, v5
    v_xor_b32 v8, v8, v6
    v_lshl_add_u32 v8, v8, 4, v7
    v_add_u32 v40, s75, v8
    v_xor_b32 v41, 64, v40
    s_add_u32 s73, s9, s73
    s_lshr_b32 s75, s64, 1
    s_lshl1_add_u32 s73, s73, s75
    s_lshl_b32 s73, s73, 7
    s_sub_u32 s77, s73, 1280
    s_min_u32 s73, s73, s77
    s_sub_u32 s77, s73, 1280
    s_min_u32 s67, s73, s77
    s_lshl_b32 s78, s64, 12
    s_add_u32 s78, s78, 65536
    s_waitcnt lgkmcnt(0)
    s_mov_b32 s52, s16
    s_and_b32 s53, s17, 0xffff
    s_mov_b32 s54, 2621440
    s_mov_b32 s55, 0x00020000
    s_add_u32 m0, s78, 0
    s_add_u32 s77, s67, 0
    buffer_load_dwordx4 v40, s[52:55], s77 offen lds
    s_add_u32 m0, s78, 1024
    s_add_u32 s77, s67, 10240
    buffer_load_dwordx4 v41, s[52:55], s77 offen lds
    s_add_u32 m0, s78, 2048
    s_add_u32 s77, s67, 20480
    buffer_load_dwordx4 v40, s[52:55], s77 offen lds
    s_add_u32 m0, s78, 3072
    s_add_u32 s77, s67, 30720
    buffer_load_dwordx4 v41, s[52:55], s77 offen lds
    s_and_b32 s76, s64, 1
    s_mul_i32 s85, s64, 5120
    s_lshl1_add_u32 s84, s9, s76
    s_mul_i32 s84, s84, 51200
    v_xor_b32 v8, v6, v5
    v_lshlrev_b32 v8, 4, v8
    v_add3_u32 v42, s84, v7, v8
    s_bitcmp0_b32 s7, 2
    s_cselect_b32 s40, s22, s24
    s_cselect_b32 s77, s23, s25
    s_and_b32 s41, s77, 0xffff
    s_mov_b32 s42, 819200
    s_mov_b32 s43, 0x00020000
    s_add_u32 m0, s85, 102400
    s_add_u32 s77, s67, 0
    buffer_load_dwordx4 v42, s[40:43], s77 offen lds
    s_add_u32 m0, s85, 103424
    s_add_u32 s77, s67, 10240
    buffer_load_dwordx4 v42, s[40:43], s77 offen lds
    s_add_u32 m0, s85, 104448
    s_add_u32 s77, s67, 20480
    buffer_load_dwordx4 v42, s[40:43], s77 offen lds
    s_add_u32 m0, s85, 105472
    s_add_u32 s77, s67, 30720
    buffer_load_dwordx4 v42, s[40:43], s77 offen lds
    s_add_u32 m0, s85, 106496
    s_add_u32 s77, s67, 40960
    buffer_load_dwordx4 v42, s[40:43], s77 offen lds
    s_lshl_b32 s73, s64, 13
    v_lshl_add_u32 v13, v5, 12, v8
    v_lshlrev_b32 v17, 4, v1
    s_lshr_b32 s66, s7, 2
    s_lshl_b32 s66, s66, 3
    s_add_u32 s66, s66, s9
    s_lshl_b32 s4, s7, 5
    s_add_u32 s4, s4, s8
    s_lshl_b32 s94, s4, 10
    s_add_u32 s94, s94, 24711168
    s_mov_b32 s48, s38
    s_and_b32 s49, s39, 0xffff
    s_mov_b32 s50, 32116736
    s_mov_b32 s51, 0x00020000
    s_cmp_lg_u32 s64, 3
    s_cbranch_scc1 k1_nozero
    v_mov_b32 v176, 1511506921
    v_mov_b32 v177, 1511506921
    v_mov_b32 v178, 1511506921
    v_mov_b32 v179, 1511506921
    v_mov_b32 v180, 0
    v_lshlrev_b32 v182, 8, v1
    s_mov_b32 s81, 20119552
    buffer_store_dwordx4 v[176:179], v17, s[48:51], s94 offen sc1
    s_cmp_lg_u32 s2, 0
    s_cbranch_scc1 k1_nozero
    buffer_store_dword v180, v182, s[48:51], s81 offen sc1
k1_nozero:
    s_add_u32 m0, s73, 0
    s_add_u32 s77, s67, 0
    s_xor_b32 s77, s77, 128
    buffer_load_dwordx4 v40, s[52:55], s77 offen lds
    s_add_u32 m0, s73, 1024
    s_add_u32 s77, s67, 10240
    s_xor_b32 s77, s77, 128
    buffer_load_dwordx4 v41, s[52:55], s77 offen lds
    s_add_u32 m0, s73, 2048
    s_add_u32 s77, s67, 20480
    s_xor_b32 s77, s77, 128
    buffer_load_dwordx4 v40, s[52:55], s77 offen lds
    s_add_u32 m0, s73, 3072
    s_add_u32 s77, s67, 30720
    s_xor_b32 s77, s77, 128
    buffer_load_dwordx4 v41, s[52:55], s77 offen lds
    s_lshr_b32 s71, s64, 1
    s_cmp_eq_u32 s64, 3
    s_cselect_b32 s71, 2, s71
    s_cmp_ge_u32 s2, 240
    s_cselect_b32 s71, 2, s71
    v_mov_b32 v58, s16
    v_mov_b32 v59, s17
    s_mov_b32 s68, 0
    s_mov_b32 s69, 0
    s_mov_b32 s70, 0
    s_cmp_eq_u32 s71, 2
    s_cbranch_scc1 k1_ts_done
    s_cmp_eq_u32 s71, 1
    s_cbranch_scc1 k1_ts_dn
    s_mul_hi_u32 s75, s2, 0xcccccccd
    s_lshr_b32 s75, s75, 4
    s_mul_i32 s76, s75, 20
    s_sub_u32 s76, s2, s76
    s_mul_i32 s80, s76, 98304
    s_lshl_b32 s77, s75, 8
    s_add_u32 s80, s80, s77
    s_lshl_b32 s77, s64, 7
    s_add_u32 s80, s80, s77
    v_mul_u32_u24 v7, 12288, v3
    v_lshrrev_b32 v8, 2, v2
    v_lshl_add_u32 v7, v8, 5, v7
    v_and_b32 v8, 1, v2
    v_lshl_add_u32 v7, v8, 4, v7
    s_mov_b32 vcc_lo, 0xcccccccc
    s_mov_b32 vcc_hi, 0xcccccccc
    v_mov_b32 v5, s28
    v_mov_b32 v6, s30
    v_cndmask_b32 v58, v5, v6, vcc
    v_mov_b32 v5, s29
    v_mov_b32 v6, s31
    v_cndmask_b32 v59, v5, v6, vcc
    s_mov_b32 s68, 3072
    s_mov_b32 s69, 6144
    s_mov_b32 s70, 49152
    s_mul_i32 s81, s75, 327680
    s_lshl_b32 s77, s76, 10
    s_add_u32 s81, s81, s77
    s_mul_i32 s77, s64, 20480
    s_add_u32 s81, s81, s77
    s_add_u32 s81, s81, 14155776
    s_branch k1_ts_add
k1_ts_dn:
    s_mul_hi_u32 s75, s2, 0xaaaaaaab
    s_lshr_b32 s75, s75, 5
    s_mul_i32 s76, s75, 48
    s_sub_u32 s76, s2, s76
    s_lshr_b32 s80, s76, 2
    s_lshl_b32 s80, s80, 7
    s_and_b32 s77, s76, 3
    s_lshl1_add_u32 s80, s77, s80
    s_mul_i32 s80, s80, 1280
    s_lshl_b32 s77, s75, 8
    s_add_u32 s80, s80, s77
    s_mul_i32 s81, s75, 393216
    s_lshl_b32 s77, s76, 10
    s_add_u32 s81, s81, s77
    s_add_u32 s81, s81, 18087936
    v_lshrrev_b32 v7, 1, v2
    v_mul_u32_u24 v7, 1040, v7
    v_and_b32 v8, 1, v2
    v_lshl_add_u32 v7, v8, 7, v7
    v_lshl_add_u32 v7, v3, 8, v7
    v_add_u32 v53, 151552, v7
    v_add_u32 v54, 151552, v17
    v_mul_u32_u24 v7, 20480, v3
    v_lshl_add_u32 v7, v2, 4, v7
    v_mov_b32 v58, s32
    v_mov_b32 v59, s33
    s_mov_b32 s68, 10240
    s_mov_b32 s69, 81920
    s_mov_b32 s70, 1280
k1_ts_add:
    v_add_u32 v7, s80, v7
    v_add_co_u32 v58, vcc, v58, v7
    v_addc_co_u32 v59, vcc, 0, v59, vcc
k1_ts_done:
    v_and_b32 v5, 7, v2
    v_xor_b32 v5, v5, v3
    v_lshlrev_b32 v5, 4, v5
    v_lshl_add_u32 v14, v2, 7, v5
    s_and_b32 s76, s64, 1
    s_lshl_b32 s76, s76, 6
    v_xor_b32 v5, s76, v5
    v_xor_b32 v6, s76, v14
    s_lshr_b32 s75, s64, 1
    s_mul_i32 s75, s75, 10240
    s_sub_u32 s77, 92160, s75
    s_add_u32 s75, s75, 81920
    v_add_u32 v32, s75, v6
    v_xor_b32 v33, 64, v32
    v_add_u32 v34, s77, v6
    v_xor_b32 v35, 64, v34
    v_lshrrev_b32 v6, 2, v2
    v_lshlrev_b32 v6, 3, v6
    v_and_b32 v7, 3, v2
    v_add_u32 v6, v6, v7
    v_lshl_add_u32 v6, v6, 7, v5
    v_add_u32 v36, s73, v6
    v_xor_b32 v37, 64, v36
    v_add_u32 v38, s78, v6
    v_xor_b32 v39, 64, v38
    v_mov_b32 v48, 0x3f803f80
    v_mov_b32 v49, 0x3f803f80
    v_mov_b32 v50, 0x3f803f80
    v_mov_b32 v51, 0x3f803f80
    v_mul_u32_u24 v43, 80, v3
    v_lshlrev_b32 v44, 4, v2
    v_add_u32 v45, 159744, v44
    s_lshl_b32 s75, s64, 2
    v_add_u32 v44, s75, v45
    s_bitset1_b32 s96, 31
    s_mov_b32 s82, 0x05040100
    s_mov_b32 s83, 0x07060302
    v_add_u32 v14, s73, v14
    v_xor_b32 v15, 64, v14
    v_add_u32 v28, 0x10000, v14
    v_add_u32 v29, 0x10000, v15
    v_add_u32 v30, 0x8000, v13
    s_cmp_lt_u32 s66, 8
    s_cselect_b32 s12, 1.0, -1.0
    s_mul_i32 s79, s66, 327680
    s_lshl_b32 s77, s65, 12
    s_add_u32 s79, s79, s77
    s_lshl_b32 s77, s64, 10
    s_add_u32 s79, s79, s77
    v_lshrrev_b32 v5, 2, v2
    v_lshlrev_b32 v5, 16, v5
    v_and_b32 v6, 3, v2
    v_lshl_add_u32 v5, v6, 13, v5
    v_and_b32 v6, 1, v3
    v_lshl_add_u32 v5, v6, 8, v5
    s_lshr_b32 s75, s66, 3
    s_lshl_b32 s75, s75, 5
    s_and_b32 s76, s66, 7
    s_add_u32 s75, s75, s76
    s_lshl_b32 s75, s75, 10
    s_lshl_b32 s76, s65, 2
    s_add_u32 s76, s76, s64
    s_lshl_b32 s76, s76, 2
    s_add_u32 s75, s75, s76
    s_add_u32 s75, s75, 24711168
    v_add_u32 v31, s75, v5
    s_and_b32 s66, s8, 7
    s_and_b32 s10, s7, 1
    s_lshr_b32 s5, s7, 1
    s_lshl_b32 s5, s5, 2
    s_lshr_b32 s9, s8, 3
    s_add_u32 s5, s5, s9
    s_lshl_b32 s65, s5, 1
    s_add_u32 s65, s65, s10
    s_mul_i32 s9, s9, 0
    s_add_u32 s9, s9, s66
    s_and_b32 s9, s9, 7
    s_lshl_b32 s3, s9, 7
    s_lshl_b32 s6, s9, 11
    s_lshl_b32 s76, s64, 10
    s_lshl_b32 s9, s65, 18
    s_add_u32 s76, s76, s9
    s_add_u32 s75, s64, 0
    s_and_b32 s75, s75, 3
    s_lshl_b32 s75, s75, 16
    s_add_u32 s90, s75, s76
    s_xor_b32 s86, s90, 262144
    s_add_u32 s75, s64, 1
    s_and_b32 s75, s75, 3
    s_lshl_b32 s75, s75, 16
    s_add_u32 s91, s75, s76
    s_xor_b32 s87, s91, 262144
    s_add_u32 s75, s64, 2
    s_and_b32 s75, s75, 3
    s_lshl_b32 s75, s75, 16
    s_add_u32 s92, s75, s76
    s_xor_b32 s88, s92, 262144
    s_add_u32 s75, s64, 3
    s_and_b32 s75, s75, 3
    s_lshl_b32 s75, s75, 16
    s_add_u32 s93, s75, s76
    s_xor_b32 s89, s93, 262144
    s_bitcmp0_b32 s7, 0
    s_cselect_b32 s44, s18, s20
    s_cselect_b32 s75, s19, s21
    s_and_b32 s45, s75, 0xffff
    s_mov_b32 s46, 8388608
    s_mov_b32 s47, 0x00020000
    v_lshrrev_b32 v5, 3, v2
    v_lshlrev_b32 v5, 15, v5
    v_and_b32 v6, 7, v2
    v_lshl_add_u32 v5, v6, 10, v5
    s_and_b32 s75, s4, 0xd8
    s_lshl_b32 s75, s75, 10
    s_lshl_b32 s76, s10, 3
    s_add_u32 s76, s76, s66
    s_lshl_b32 s76, s76, 2
    s_add_u32 s76, s76, s64
    s_lshl_b32 s76, s76, 2
    s_add_u32 s75, s75, s76
    s_add_u32 s75, s75, 24711680
    s_mov_b32 exec_lo, 0
    v_add_u32 v31, s75, v5
    s_mov_b32 exec_lo, -1
    s_mul_i32 s75, s10, 40
    s_mul_i32 s76, s66, 5
    s_add_u32 s75, s75, s76
    s_lshl_b32 s75, s75, 16
    s_lshl_b32 s76, s64, 14
    s_add_u32 s75, s75, s76
    v_add_u32 v8, s75, v17
    v_add_u32 v9, 65536, v8
    v_add_u32 v10, 131072, v8
    v_add_u32 v11, 196608, v8
    v_add_u32 v12, 262144, v8
    v_lshlrev_b32 v0, 2, v1
    s_lshl_b32 s95, s64, 6
    s_add_u32 s95, s95, s94
    s_and_b32 s14, s7, 1
    s_mul_i32 s14, s14, 8
    s_lshr_b32 s9, s8, 2
    s_add_u32 s14, s14, s9
    s_lshr_b32 s15, s7, 1
    s_mul_i32 s15, s15, 4
    s_and_b32 s9, s8, 3
    s_add_u32 s15, s15, s9
    s_lshl_b32 s75, s65, 6
    s_lshl_b32 s76, s64, 4
    s_add_u32 s75, s75, s76
    v_add_u32 v5, s75, v2
    v_mul_u32_u24 v5, 1280, v5
    v_lshlrev_b32 v6, 3, v3
    v_add_u32 v5, v5, v6
    s_mul_i32 s75, s66, 160
    v_add_u32 v16, s75, v5
    s_lshl_b32 s75, s5, 3
    s_add_u32 s75, s75, s66
    s_lshl_b32 s75, s75, 1
    s_add_u32 s75, s75, s10
    s_lshl_b32 s76, s64, 12
    s_add_u32 s76, s76, 20287488
    s_lshl_b32 s77, s75, 14
    s_add_u32 s60, s76, s77
    s_xor_b32 s77, s77, 16384
    s_add_u32 s61, s76, s77
    s_lshl_b32 s75, s65, 2
    s_add_u32 s75, s75, s64
    s_mul_i32 s75, s75, 20480
    s_add_u32 s75, s75, 5242880
    s_mul_i32 s76, s66, 5
    s_lshr_b32 s76, s76, 1
    s_lshl_b32 s76, s76, 10
    s_add_u32 s84, s75, s76
    s_mul_i32 s11, s15, 12
    s_mul_i32 s77, s64, 3
    s_add_u32 s11, s11, s77
    s_mul_i32 s11, s11, 20480
    s_add_u32 s11, s11, 14155776
    s_mul_i32 s13, s64, 12288
    s_mul_i32 s77, s66, 245760
    s_add_u32 s13, s13, s77
    s_add_u32 s13, s13, 18087936
    s_lshr_b32 s9, s8, 3
    s_add_u32 s9, s9, s66
    s_and_b32 s9, s9, 3
    s_lshl_b32 s3, s9, 7
    s_and_b32 s6, s66, 4
    s_lshl_b32 s6, s6, 7
    s_xor_b32 s9, s6, 512
    s_add_u32 s72, s67, 256
    s_sub_u32 s77, s67, 1024
    s_min_u32 s72, s72, s77
    s_add_u32 m0, s85, 131072
    s_add_u32 s77, s72, 0
    buffer_load_dwordx4 v42, s[40:43], s77 offen lds
    s_add_u32 m0, s85, 132096
    s_add_u32 s77, s72, 10240
    buffer_load_dwordx4 v42, s[40:43], s77 offen lds
    s_add_u32 m0, s85, 133120
    s_add_u32 s77, s72, 20480
    buffer_load_dwordx4 v42, s[40:43], s77 offen lds
    s_add_u32 m0, s85, 134144
    s_add_u32 s77, s72, 30720
    buffer_load_dwordx4 v42, s[40:43], s77 offen lds
    s_add_u32 m0, s85, 135168
    s_add_u32 s77, s72, 40960
    buffer_load_dwordx4 v42, s[40:43], s77 offen lds
    s_add_u32 m0, s73, 4096
    s_add_u32 s77, s72, 0
    buffer_load_dwordx4 v40, s[52:55], s77 offen lds
    s_add_u32 m0, s73, 5120
    s_add_u32 s77, s72, 10240
    buffer_load_dwordx4 v41, s[52:55], s77 offen lds
    s_add_u32 m0, s73, 6144
    s_add_u32 s77, s72, 20480
    buffer_load_dwordx4 v40, s[52:55], s77 offen lds
    s_add_u32 m0, s73, 7168
    s_add_u32 s77, s72, 30720
    buffer_load_dwordx4 v41, s[52:55], s77 offen lds
    s_mov_b32 s56, s34
    s_and_b32 s57, s35, 0xffff
    s_mov_b32 s58, 2621440
    s_mov_b32 s59, 0x00020000
    s_waitcnt vmcnt(18)
    ds_read_b128 v[144:147], v38 offset:0
    ds_read_b128 v[152:155], v38 offset:512
    ds_read_b128 v[148:151], v39 offset:0
    ds_read_b128 v[156:159], v39 offset:512
    s_waitcnt vmcnt(13)
    s_barrier
    ds_read_b128 v[64:67], v32 offset:20480
    ds_read_b128 v[68:71], v32 offset:22528
    ds_read_b128 v[72:75], v32 offset:24576
    ds_read_b128 v[76:79], v32 offset:26624
    ds_read_b128 v[80:83], v32 offset:28672
    ds_read_b128 v[84:87], v33 offset:20480
    ds_read_b128 v[88:91], v33 offset:22528
    ds_read_b128 v[92:95], v33 offset:24576
    ds_read_b128 v[96:99], v33 offset:26624
    ds_read_b128 v[100:103], v33 offset:28672
    s_add_u32 s74, s72, 256
    s_sub_u32 s77, s72, 1024
    s_min_u32 s74, s74, s77
    s_add_u32 s100, s74, 256
    s_sub_u32 s77, s74, 1024
    s_min_u32 s100, s100, s77
    s_add_u32 s101, s100, 256
    s_sub_u32 s77, s100, 1024
    s_min_u32 s101, s101, s77
    s_waitcnt lgkmcnt(0)
    v_mfma_f32_16x16x32_bf16 a[16:19], v[48:51], v[64:67], 0
    s_add_u32 m0, s73, 32768
    s_add_u32 s77, s72, 0
    s_xor_b32 s77, s77, 128
    buffer_load_dwordx4 v40, s[52:55], s77 offen lds
    v_mfma_f32_16x16x32_bf16 a[20:23], v[48:51], v[68:71], 0
    s_add_u32 m0, s73, 33792
    s_add_u32 s77, s72, 10240
    s_xor_b32 s77, s77, 128
    buffer_load_dwordx4 v41, s[52:55], s77 offen lds
    v_mfma_f32_16x16x32_bf16 a[24:27], v[48:51], v[72:75], 0
    s_add_u32 m0, s73, 34816
    s_add_u32 s77, s72, 20480
    s_xor_b32 s77, s77, 128
    buffer_load_dwordx4 v40, s[52:55], s77 offen lds
    v_mfma_f32_16x16x32_bf16 a[28:31], v[48:51], v[76:79], 0
    s_add_u32 m0, s73, 35840
    s_add_u32 s77, s72, 30720
    s_xor_b32 s77, s77, 128
    buffer_load_dwordx4 v41, s[52:55], s77 offen lds
    v_mfma_f32_16x16x32_bf16 a[32:35], v[48:51], v[80:83], 0
    s_add_u32 m0, s85, 81920
    s_add_u32 s77, s74, 0
    buffer_load_dwordx4 v42, s[40:43], s77 offen lds
    v_mfma_f32_16x16x32_bf16 a[8:11], v[144:147], v[144:147], 0
    s_add_u32 m0, s85, 82944
    s_add_u32 s77, s74, 10240
    buffer_load_dwordx4 v42, s[40:43], s77 offen lds
    v_mfma_f32_16x16x32_bf16 a[0:3], v[48:51], v[144:147], 0
    s_add_u32 m0, s85, 83968
    s_add_u32 s77, s74, 20480
    buffer_load_dwordx4 v42, s[40:43], s77 offen lds
    v_mfma_f32_16x16x32_bf16 a[12:15], v[152:155], v[152:155], 0
    s_add_u32 m0, s85, 84992
    s_add_u32 s77, s74, 30720
    buffer_load_dwordx4 v42, s[40:43], s77 offen lds
    v_mfma_f32_16x16x32_bf16 a[4:7], v[48:51], v[152:155], 0
    s_add_u32 m0, s85, 86016
    s_add_u32 s77, s74, 40960
    buffer_load_dwordx4 v42, s[40:43], s77 offen lds
    v_mfma_f32_16x16x32_bf16 a[8:11], v[148:151], v[148:151], a[8:11]
    s_add_u32 m0, s73, 36864
    s_add_u32 s77, s74, 0
    buffer_load_dwordx4 v40, s[52:55], s77 offen lds
    v_mfma_f32_16x16x32_bf16 a[0:3], v[48:51], v[148:151], a[0:3]
    s_add_u32 m0, s73, 37888
    s_add_u32 s77, s74, 10240
    buffer_load_dwordx4 v41, s[52:55], s77 offen lds
    v_mfma_f32_16x16x32_bf16 a[12:15], v[156:159], v[156:159], a[12:15]
    s_add_u32 m0, s73, 38912
    s_add_u32 s77, s74, 20480
    buffer_load_dwordx4 v40, s[52:55], s77 offen lds
    v_mfma_f32_16x16x32_bf16 a[4:7], v[48:51], v[156:159], a[4:7]
    s_add_u32 m0, s73, 39936
    s_add_u32 s77, s74, 30720
    buffer_load_dwordx4 v41, s[52:55], s77 offen lds
    v_mfma_f32_16x16x32_bf16 v[216:219], v[144:147], v[64:67], 0
    s_cmp_lt_u32 s71, 2
    s_cselect_b64 exec, -1, 1
    global_load_dwordx4 v[176:179], v[58:59], off
    s_mov_b64 exec, -1
    v_mfma_f32_16x16x32_bf16 v[236:239], v[152:155], v[64:67], 0
    v_add_co_u32 v62, vcc, s68, v58
    v_addc_co_u32 v63, vcc, 0, v59, vcc
    s_cmp_lt_u32 s71, 2
    s_cselect_b64 exec, -1, 1
    global_load_dwordx4 v[180:183], v[62:63], off
    s_mov_b64 exec, -1
    v_mfma_f32_16x16x32_bf16 v[220:223], v[144:147], v[68:71], 0
    v_add_co_u32 v60, vcc, s69, v58
    v_addc_co_u32 v61, vcc, 0, v59, vcc
    s_cmp_lt_u32 s71, 2
    s_cselect_b64 exec, -1, 1
    global_load_dwordx4 v[184:187], v[60:61], off
    s_mov_b64 exec, -1
    ds_read_b128 v[104:107], v34 offset:20480
    v_mfma_f32_16x16x32_bf16 v[240:243], v[152:155], v[68:71], 0
    s_add_u32 s80, s68, s69
    v_add_co_u32 v62, vcc, s80, v58
    v_addc_co_u32 v63, vcc, 0, v59, vcc
    s_cmp_lt_u32 s71, 2
    s_cselect_b64 exec, -1, 1
    global_load_dwordx4 v[188:191], v[62:63], off
    s_mov_b64 exec, -1
    ds_read_b128 v[108:111], v34 offset:22528
    v_mfma_f32_16x16x32_bf16 v[224:227], v[144:147], v[72:75], 0
    v_add_co_u32 v60, vcc, s70, v58
    v_addc_co_u32 v61, vcc, 0, v59, vcc
    s_cmp_lt_u32 s71, 2
    s_cselect_b64 exec, -1, 1
    global_load_dwordx4 v[192:195], v[60:61], off
    s_mov_b64 exec, -1
    ds_read_b128 v[112:115], v34 offset:24576
    v_mfma_f32_16x16x32_bf16 v[244:247], v[152:155], v[72:75], 0
    s_add_u32 s80, s68, s70
    v_add_co_u32 v62, vcc, s80, v58
    v_addc_co_u32 v63, vcc, 0, v59, vcc
    s_cmp_lt_u32 s71, 2
    s_cselect_b64 exec, -1, 1
    global_load_dwordx4 v[196:199], v[62:63], off
    s_mov_b64 exec, -1
    ds_read_b128 v[116:119], v34 offset:26624
    v_mfma_f32_16x16x32_bf16 v[228:231], v[144:147], v[76:79], 0
    s_add_u32 s80, s69, s70
    v_add_co_u32 v60, vcc, s80, v58
    v_addc_co_u32 v61, vcc, 0, v59, vcc
    s_cmp_lt_u32 s71, 2
    s_cselect_b64 exec, -1, 1
    global_load_dwordx4 v[200:203], v[60:61], off
    s_mov_b64 exec, -1
    ds_read_b128 v[120:123], v34 offset:28672
    v_mfma_f32_16x16x32_bf16 v[248:251], v[152:155], v[76:79], 0
    s_add_u32 s80, s68, s69
    s_add_u32 s80, s80, s70
    v_add_co_u32 v62, vcc, s80, v58
    v_addc_co_u32 v63, vcc, 0, v59, vcc
    s_cmp_lt_u32 s71, 2
    s_cselect_b64 exec, -1, 1
    global_load_dwordx4 v[204:207], v[62:63], off
    s_mov_b64 exec, -1
    ds_read_b128 v[124:127], v35 offset:20480
    v_mfma_f32_16x16x32_bf16 v[232:235], v[144:147], v[80:83], 0
    ds_read_b128 v[128:131], v35 offset:22528
    v_mfma_f32_16x16x32_bf16 v[252:255], v[152:155], v[80:83], 0
    ds_read_b128 v[132:135], v35 offset:24576
    v_mfma_f32_16x16x32_bf16 v[216:219], v[148:151], v[84:87], v[216:219]
    ds_read_b128 v[136:139], v35 offset:26624
    v_mfma_f32_16x16x32_bf16 v[236:239], v[156:159], v[84:87], v[236:239]
    ds_read_b128 v[140:143], v35 offset:28672
    v_mfma_f32_16x16x32_bf16 v[220:223], v[148:151], v[88:91], v[220:223]
    s_waitcnt vmcnt(30)
    ds_read_b128 v[160:163], v36 offset:0
    v_mfma_f32_16x16x32_bf16 v[240:243], v[156:159], v[88:91], v[240:243]
    ds_read_b128 v[168:171], v36 offset:512
    v_mfma_f32_16x16x32_bf16 v[224:227], v[148:151], v[92:95], v[224:227]
    ds_read_b128 v[164:167], v37 offset:0
    v_mfma_f32_16x16x32_bf16 v[244:247], v[156:159], v[92:95], v[244:247]
    ds_read_b128 v[172:175], v37 offset:512
    v_mfma_f32_16x16x32_bf16 v[228:231], v[148:151], v[96:99], v[228:231]
    v_mfma_f32_16x16x32_bf16 v[248:251], v[156:159], v[96:99], v[248:251]
    v_mfma_f32_16x16x32_bf16 v[232:235], v[148:151], v[100:103], v[232:235]
    v_mfma_f32_16x16x32_bf16 v[252:255], v[156:159], v[100:103], v[252:255]
    s_waitcnt lgkmcnt(0)
    s_waitcnt vmcnt(25)
    s_barrier
    v_mfma_f32_16x16x32_bf16 a[8:11], v[160:163], v[160:163], a[8:11]
    s_add_u32 m0, s78, 0
    s_add_u32 s77, s74, 0
    s_xor_b32 s77, s77, 128
    buffer_load_dwordx4 v40, s[52:55], s77 offen lds
    v_mfma_f32_16x16x32_bf16 a[0:3], v[48:51], v[160:163], a[0:3]
    s_add_u32 m0, s78, 1024
    s_add_u32 s77, s74, 10240
    s_xor_b32 s77, s77, 128
    buffer_load_dwordx4 v41, s[52:55], s77 offen lds
    v_mfma_f32_16x16x32_bf16 a[12:15], v[168:171], v[168:171], a[12:15]
    s_add_u32 m0, s78, 2048
    s_add_u32 s77, s74, 20480
    s_xor_b32 s77, s77, 128
    buffer_load_dwordx4 v40, s[52:55], s77 offen lds
    v_mfma_f32_16x16x32_bf16 a[4:7], v[48:51], v[168:171], a[4:7]
    s_add_u32 m0, s78, 3072
    s_add_u32 s77, s74, 30720
    s_xor_b32 s77, s77, 128
    buffer_load_dwordx4 v41, s[52:55], s77 offen lds
    v_mfma_f32_16x16x32_bf16 a[8:11], v[164:167], v[164:167], a[8:11]
    s_add_u32 m0, s85, 102400
    s_add_u32 s77, s100, 0
    buffer_load_dwordx4 v42, s[40:43], s77 offen lds
    v_mfma_f32_16x16x32_bf16 a[0:3], v[48:51], v[164:167], a[0:3]
    s_add_u32 m0, s85, 103424
    s_add_u32 s77, s100, 10240
    buffer_load_dwordx4 v42, s[40:43], s77 offen lds
    v_mfma_f32_16x16x32_bf16 a[12:15], v[172:175], v[172:175], a[12:15]
    s_add_u32 m0, s85, 104448
    s_add_u32 s77, s100, 20480
    buffer_load_dwordx4 v42, s[40:43], s77 offen lds
    v_mfma_f32_16x16x32_bf16 a[4:7], v[48:51], v[172:175], a[4:7]
    s_add_u32 m0, s85, 105472
    s_add_u32 s77, s100, 30720
    buffer_load_dwordx4 v42, s[40:43], s77 offen lds
    v_mfma_f32_16x16x32_bf16 v[216:219], v[160:163], v[104:107], v[216:219]
    s_add_u32 m0, s85, 106496
    s_add_u32 s77, s100, 40960
    buffer_load_dwordx4 v42, s[40:43], s77 offen lds
    v_mfma_f32_16x16x32_bf16 v[236:239], v[168:171], v[104:107], v[236:239]
    s_add_u32 m0, s73, 0
    s_add_u32 s77, s100, 0
    buffer_load_dwordx4 v40, s[52:55], s77 offen lds
    v_mfma_f32_16x16x32_bf16 v[220:223], v[160:163], v[108:111], v[220:223]
    s_add_u32 m0, s73, 1024
    s_add_u32 s77, s100, 10240
    buffer_load_dwordx4 v41, s[52:55], s77 offen lds
    ds_read_b128 v[64:67], v32 offset:49152
    v_mfma_f32_16x16x32_bf16 v[240:243], v[168:171], v[108:111], v[240:243]
    s_add_u32 m0, s73, 2048
    s_add_u32 s77, s100, 20480
    buffer_load_dwordx4 v40, s[52:55], s77 offen lds
    ds_read_b128 v[68:71], v32 offset:51200
    v_mfma_f32_16x16x32_bf16 v[224:227], v[160:163], v[112:115], v[224:227]
    s_add_u32 m0, s73, 3072
    s_add_u32 s77, s100, 30720
    buffer_load_dwordx4 v41, s[52:55], s77 offen lds
    ds_read_b128 v[72:75], v32 offset:53248
    v_mfma_f32_16x16x32_bf16 v[244:247], v[168:171], v[112:115], v[244:247]
    ds_read_b128 v[76:79], v32 offset:55296
    v_mfma_f32_16x16x32_bf16 v[228:231], v[160:163], v[116:119], v[228:231]
    ds_read_b128 v[80:83], v32 offset:57344
    v_mfma_f32_16x16x32_bf16 v[248:251], v[168:171], v[116:119], v[248:251]
    ds_read_b128 v[84:87], v33 offset:49152
    v_mfma_f32_16x16x32_bf16 v[232:235], v[160:163], v[120:123], v[232:235]
    ds_read_b128 v[88:91], v33 offset:51200
    v_mfma_f32_16x16x32_bf16 v[252:255], v[168:171], v[120:123], v[252:255]
    ds_read_b128 v[92:95], v33 offset:53248
    v_mfma_f32_16x16x32_bf16 v[216:219], v[164:167], v[124:127], v[216:219]
    ds_read_b128 v[96:99], v33 offset:55296
    v_mfma_f32_16x16x32_bf16 v[236:239], v[172:175], v[124:127], v[236:239]
    ds_read_b128 v[100:103], v33 offset:57344
    v_mfma_f32_16x16x32_bf16 v[220:223], v[164:167], v[128:131], v[220:223]
    s_waitcnt vmcnt(34)
    ds_read_b128 v[144:147], v36 offset:4096
    v_mfma_f32_16x16x32_bf16 v[240:243], v[172:175], v[128:131], v[240:243]
    ds_read_b128 v[152:155], v36 offset:4608
    v_mfma_f32_16x16x32_bf16 v[224:227], v[164:167], v[132:135], v[224:227]
    ds_read_b128 v[148:151], v37 offset:4096
    v_mfma_f32_16x16x32_bf16 v[244:247], v[172:175], v[132:135], v[244:247]
    ds_read_b128 v[156:159], v37 offset:4608
    v_mfma_f32_16x16x32_bf16 v[228:231], v[164:167], v[136:139], v[228:231]
    v_mfma_f32_16x16x32_bf16 v[248:251], v[172:175], v[136:139], v[248:251]
    v_mfma_f32_16x16x32_bf16 v[232:235], v[164:167], v[140:143], v[232:235]
    v_mfma_f32_16x16x32_bf16 v[252:255], v[172:175], v[140:143], v[252:255]
    s_waitcnt lgkmcnt(0)
    v_mfma_f32_16x16x32_bf16 a[16:19], v[48:51], v[64:67], a[16:19]
    s_add_u32 m0, s73, 4096
    s_add_u32 s77, s100, 0
    s_xor_b32 s77, s77, 128
    buffer_load_dwordx4 v40, s[52:55], s77 offen lds
    v_mfma_f32_16x16x32_bf16 a[20:23], v[48:51], v[68:71], a[20:23]
    s_add_u32 m0, s73, 5120
    s_add_u32 s77, s100, 10240
    s_xor_b32 s77, s77, 128
    buffer_load_dwordx4 v41, s[52:55], s77 offen lds
    v_mfma_f32_16x16x32_bf16 a[24:27], v[48:51], v[72:75], a[24:27]
    s_add_u32 m0, s73, 6144
    s_add_u32 s77, s100, 20480
    s_xor_b32 s77, s77, 128
    buffer_load_dwordx4 v40, s[52:55], s77 offen lds
    v_mfma_f32_16x16x32_bf16 a[28:31], v[48:51], v[76:79], a[28:31]
    s_add_u32 m0, s73, 7168
    s_add_u32 s77, s100, 30720
    s_xor_b32 s77, s77, 128
    buffer_load_dwordx4 v41, s[52:55], s77 offen lds
    v_mfma_f32_16x16x32_bf16 a[32:35], v[48:51], v[80:83], a[32:35]
    s_lshr_b32 s75, s7, 1
    s_lshl_b32 s75, s75, 5
    s_add_u32 s75, s75, s8
    s_lshl2_add_u32 s75, s75, s64
    s_lshl_b32 s75, s75, 14
    v_lshlrev_b32 v56, 10, v1
    v_add_u32 v56, s75, v56
    s_mov_b64 exec, 0xffff
    buffer_load_dword v57, v56, s[44:47], 0 offen offset:128
    s_mov_b64 exec, -1
    v_mfma_f32_16x16x32_bf16 a[8:11], v[144:147], v[144:147], a[8:11]
    s_mov_b64 exec, 0xffff
    buffer_load_dword v57, v56, s[44:47], 0 offen offset:256
    s_mov_b64 exec, -1
    v_mfma_f32_16x16x32_bf16 a[0:3], v[48:51], v[144:147], a[0:3]
    ds_read_b128 v[104:107], v34 offset:49152
    v_mfma_f32_16x16x32_bf16 a[12:15], v[152:155], v[152:155], a[12:15]
    ds_read_b128 v[108:111], v34 offset:51200
    v_mfma_f32_16x16x32_bf16 a[4:7], v[48:51], v[152:155], a[4:7]
    ds_read_b128 v[112:115], v34 offset:53248
    v_mfma_f32_16x16x32_bf16 a[8:11], v[148:151], v[148:151], a[8:11]
    ds_read_b128 v[116:119], v34 offset:55296
    v_mfma_f32_16x16x32_bf16 a[0:3], v[48:51], v[148:151], a[0:3]
    ds_read_b128 v[120:123], v34 offset:57344
    v_mfma_f32_16x16x32_bf16 a[12:15], v[156:159], v[156:159], a[12:15]
    ds_read_b128 v[124:127], v35 offset:49152
    v_mfma_f32_16x16x32_bf16 a[4:7], v[48:51], v[156:159], a[4:7]
    ds_read_b128 v[128:131], v35 offset:51200
    v_mfma_f32_16x16x32_bf16 v[216:219], v[144:147], v[64:67], v[216:219]
    ds_read_b128 v[132:135], v35 offset:53248
    v_mfma_f32_16x16x32_bf16 v[236:239], v[152:155], v[64:67], v[236:239]
    ds_read_b128 v[136:139], v35 offset:55296
    v_mfma_f32_16x16x32_bf16 v[220:223], v[144:147], v[68:71], v[220:223]
    ds_read_b128 v[140:143], v35 offset:57344
    v_mfma_f32_16x16x32_bf16 v[240:243], v[152:155], v[68:71], v[240:243]
    v_mfma_f32_16x16x32_bf16 v[224:227], v[144:147], v[72:75], v[224:227]
    v_mfma_f32_16x16x32_bf16 v[244:247], v[152:155], v[72:75], v[244:247]
    v_mfma_f32_16x16x32_bf16 v[228:231], v[144:147], v[76:79], v[228:231]
    v_mfma_f32_16x16x32_bf16 v[248:251], v[152:155], v[76:79], v[248:251]
    v_mfma_f32_16x16x32_bf16 v[232:235], v[144:147], v[80:83], v[232:235]
    v_mfma_f32_16x16x32_bf16 v[252:255], v[152:155], v[80:83], v[252:255]
    v_mfma_f32_16x16x32_bf16 v[216:219], v[148:151], v[84:87], v[216:219]
    v_mfma_f32_16x16x32_bf16 v[236:239], v[156:159], v[84:87], v[236:239]
    v_mfma_f32_16x16x32_bf16 v[220:223], v[148:151], v[88:91], v[220:223]
    s_waitcnt vmcnt(36)
    ds_read_b128 v[160:163], v36 offset:32768
    v_mfma_f32_16x16x32_bf16 v[240:243], v[156:159], v[88:91], v[240:243]
    ds_read_b128 v[168:171], v36 offset:33280
    v_mfma_f32_16x16x32_bf16 v[224:227], v[148:151], v[92:95], v[224:227]
    ds_read_b128 v[164:167], v37 offset:32768
    v_mfma_f32_16x16x32_bf16 v[244:247], v[156:159], v[92:95], v[244:247]
    ds_read_b128 v[172:175], v37 offset:33280
    v_mfma_f32_16x16x32_bf16 v[228:231], v[148:151], v[96:99], v[228:231]
    v_mfma_f32_16x16x32_bf16 v[248:251], v[156:159], v[96:99], v[248:251]
    v_mfma_f32_16x16x32_bf16 v[232:235], v[148:151], v[100:103], v[232:235]
    v_mfma_f32_16x16x32_bf16 v[252:255], v[156:159], v[100:103], v[252:255]
    s_cmp_eq_u32 s71, 1
    s_cbranch_scc1 k1_v_dn
    s_cmp_eq_u32 s71, 2
    s_cbranch_scc1 k1_v_no
    s_waitcnt lgkmcnt(0)
    s_waitcnt vmcnt(31)
    s_barrier
    v_mfma_f32_16x16x32_bf16 a[8:11], v[160:163], v[160:163], a[8:11]
    s_add_u32 m0, s85, 131072
    s_add_u32 s77, s101, 0
    buffer_load_dwordx4 v42, s[40:43], s77 offen lds
    v_mfma_f32_16x16x32_bf16 a[0:3], v[48:51], v[160:163], a[0:3]
    s_add_u32 m0, s85, 132096
    s_add_u32 s77, s101, 10240
    buffer_load_dwordx4 v42, s[40:43], s77 offen lds
    v_mfma_f32_16x16x32_bf16 a[12:15], v[168:171], v[168:171], a[12:15]
    s_add_u32 m0, s85, 133120
    s_add_u32 s77, s101, 20480
    buffer_load_dwordx4 v42, s[40:43], s77 offen lds
    s_waitcnt vmcnt(22)
    v_perm_b32 v208, v180, v176, s82
    v_perm_b32 v209, v188, v184, s82
    v_mfma_f32_16x16x32_bf16 a[4:7], v[48:51], v[168:171], a[4:7]
    s_add_u32 m0, s85, 134144
    s_add_u32 s77, s101, 30720
    buffer_load_dwordx4 v42, s[40:43], s77 offen lds
    v_mfma_f32_16x16x32_bf16 a[8:11], v[164:167], v[164:167], a[8:11]
    s_add_u32 m0, s85, 135168
    s_add_u32 s77, s101, 40960
    buffer_load_dwordx4 v42, s[40:43], s77 offen lds
    v_mfma_f32_16x16x32_bf16 a[0:3], v[48:51], v[164:167], a[0:3]
    s_add_u32 m0, s73, 32768
    s_add_u32 s77, s101, 0
    buffer_load_dwordx4 v40, s[52:55], s77 offen lds
    v_perm_b32 v210, v196, v192, s82
    v_perm_b32 v211, v204, v200, s82
    v_mfma_f32_16x16x32_bf16 a[12:15], v[172:175], v[172:175], a[12:15]
    s_add_u32 m0, s73, 33792
    s_add_u32 s77, s101, 10240
    buffer_load_dwordx4 v41, s[52:55], s77 offen lds
    v_mfma_f32_16x16x32_bf16 a[4:7], v[48:51], v[172:175], a[4:7]
    s_add_u32 m0, s73, 34816
    s_add_u32 s77, s101, 20480
    buffer_load_dwordx4 v40, s[52:55], s77 offen lds
    v_mfma_f32_16x16x32_bf16 v[216:219], v[160:163], v[104:107], v[216:219]
    s_add_u32 m0, s73, 35840
    s_add_u32 s77, s101, 30720
    buffer_load_dwordx4 v41, s[52:55], s77 offen lds
    s_add_u32 s80, s81, 0
    buffer_store_dwordx4 v[208:211], v17, s[48:51], s80 offen sc1
    v_mfma_f32_16x16x32_bf16 v[236:239], v[168:171], v[104:107], v[236:239]
    s_mov_b64 exec, 0xffff
    buffer_load_dword v57, v56, s[44:47], 0 offen offset:384
    s_mov_b64 exec, -1
    v_mfma_f32_16x16x32_bf16 v[220:223], v[160:163], v[108:111], v[220:223]
    ds_read_b128 v[64:67], v32 offset:0
    v_mfma_f32_16x16x32_bf16 v[240:243], v[168:171], v[108:111], v[240:243]
    ds_read_b128 v[68:71], v32 offset:2048
    v_perm_b32 v212, v180, v176, s83
    v_perm_b32 v213, v188, v184, s83
    v_mfma_f32_16x16x32_bf16 v[224:227], v[160:163], v[112:115], v[224:227]
    ds_read_b128 v[72:75], v32 offset:4096
    v_mfma_f32_16x16x32_bf16 v[244:247], v[168:171], v[112:115], v[244:247]
    ds_read_b128 v[76:79], v32 offset:6144
    v_mfma_f32_16x16x32_bf16 v[228:231], v[160:163], v[116:119], v[228:231]
    ds_read_b128 v[80:83], v32 offset:8192
    v_mfma_f32_16x16x32_bf16 v[248:251], v[168:171], v[116:119], v[248:251]
    ds_read_b128 v[84:87], v33 offset:0
    v_perm_b32 v214, v196, v192, s83
    v_perm_b32 v215, v204, v200, s83
    v_mfma_f32_16x16x32_bf16 v[232:235], v[160:163], v[120:123], v[232:235]
    ds_read_b128 v[88:91], v33 offset:2048
    v_mfma_f32_16x16x32_bf16 v[252:255], v[168:171], v[120:123], v[252:255]
    ds_read_b128 v[92:95], v33 offset:4096
    v_mfma_f32_16x16x32_bf16 v[216:219], v[164:167], v[124:127], v[216:219]
    ds_read_b128 v[96:99], v33 offset:6144
    s_add_u32 s80, s81, 40960
    buffer_store_dwordx4 v[212:215], v17, s[48:51], s80 offen sc1
    v_mfma_f32_16x16x32_bf16 v[236:239], v[172:175], v[124:127], v[236:239]
    ds_read_b128 v[100:103], v33 offset:8192
    v_mfma_f32_16x16x32_bf16 v[220:223], v[164:167], v[128:131], v[220:223]
    ds_read_b128 v[144:147], v36 offset:36864
    v_mfma_f32_16x16x32_bf16 v[240:243], v[172:175], v[128:131], v[240:243]
    ds_read_b128 v[152:155], v36 offset:37376
    v_perm_b32 v208, v181, v177, s82
    v_perm_b32 v209, v189, v185, s82
    v_mfma_f32_16x16x32_bf16 v[224:227], v[164:167], v[132:135], v[224:227]
    ds_read_b128 v[148:151], v37 offset:36864
    v_mfma_f32_16x16x32_bf16 v[244:247], v[172:175], v[132:135], v[244:247]
    ds_read_b128 v[156:159], v37 offset:37376
    v_mfma_f32_16x16x32_bf16 v[228:231], v[164:167], v[136:139], v[228:231]
    v_perm_b32 v210, v197, v193, s82
    v_perm_b32 v211, v205, v201, s82
    v_mfma_f32_16x16x32_bf16 v[248:251], v[172:175], v[136:139], v[248:251]
    v_mfma_f32_16x16x32_bf16 v[232:235], v[164:167], v[140:143], v[232:235]
    v_mfma_f32_16x16x32_bf16 v[252:255], v[172:175], v[140:143], v[252:255]
    s_waitcnt lgkmcnt(0)
    v_mfma_f32_16x16x32_bf16 a[16:19], v[48:51], v[64:67], a[16:19]
    s_add_u32 m0, s73, 36864
    s_add_u32 s77, s101, 0
    s_xor_b32 s77, s77, 128
    buffer_load_dwordx4 v40, s[52:55], s77 offen lds
    v_mfma_f32_16x16x32_bf16 a[20:23], v[48:51], v[68:71], a[20:23]
    s_add_u32 m0, s73, 37888
    s_add_u32 s77, s101, 10240
    s_xor_b32 s77, s77, 128
    buffer_load_dwordx4 v41, s[52:55], s77 offen lds
    v_mfma_f32_16x16x32_bf16 a[24:27], v[48:51], v[72:75], a[24:27]
    s_add_u32 m0, s73, 38912
    s_add_u32 s77, s101, 20480
    s_xor_b32 s77, s77, 128
    buffer_load_dwordx4 v40, s[52:55], s77 offen lds
    s_add_u32 s80, s81, 81920
    buffer_store_dwordx4 v[208:211], v17, s[48:51], s80 offen sc1
    v_mfma_f32_16x16x32_bf16 a[28:31], v[48:51], v[76:79], a[28:31]
    s_add_u32 m0, s73, 39936
    s_add_u32 s77, s101, 30720
    s_xor_b32 s77, s77, 128
    buffer_load_dwordx4 v41, s[52:55], s77 offen lds
    v_mfma_f32_16x16x32_bf16 a[32:35], v[48:51], v[80:83], a[32:35]
    buffer_load_dword v55, v31, s[48:51], 0 offen sc1
    v_mfma_f32_16x16x32_bf16 a[8:11], v[144:147], v[144:147], a[8:11]
    ds_read_b128 v[104:107], v34 offset:0
    v_perm_b32 v212, v181, v177, s83
    v_perm_b32 v213, v189, v185, s83
    v_mfma_f32_16x16x32_bf16 a[0:3], v[48:51], v[144:147], a[0:3]
    ds_read_b128 v[108:111], v34 offset:2048
    v_mfma_f32_16x16x32_bf16 a[12:15], v[152:155], v[152:155], a[12:15]
    ds_read_b128 v[112:115], v34 offset:4096
    v_mfma_f32_16x16x32_bf16 a[4:7], v[48:51], v[152:155], a[4:7]
    ds_read_b128 v[116:119], v34 offset:6144
    v_mfma_f32_16x16x32_bf16 a[8:11], v[148:151], v[148:151], a[8:11]
    ds_read_b128 v[120:123], v34 offset:8192
    v_perm_b32 v214, v197, v193, s83
    v_perm_b32 v215, v205, v201, s83
    v_mfma_f32_16x16x32_bf16 a[0:3], v[48:51], v[148:151], a[0:3]
    ds_read_b128 v[124:127], v35 offset:0
    v_mfma_f32_16x16x32_bf16 a[12:15], v[156:159], v[156:159], a[12:15]
    ds_read_b128 v[128:131], v35 offset:2048
    v_mfma_f32_16x16x32_bf16 a[4:7], v[48:51], v[156:159], a[4:7]
    ds_read_b128 v[132:135], v35 offset:4096
    v_mfma_f32_16x16x32_bf16 v[216:219], v[144:147], v[64:67], v[216:219]
    ds_read_b128 v[136:139], v35 offset:6144
    s_add_u32 s80, s81, 122880
    buffer_store_dwordx4 v[212:215], v17, s[48:51], s80 offen sc1
    v_mfma_f32_16x16x32_bf16 v[236:239], v[152:155], v[64:67], v[236:239]
    ds_read_b128 v[140:143], v35 offset:8192
    v_mfma_f32_16x16x32_bf16 v[220:223], v[144:147], v[68:71], v[220:223]
    v_mfma_f32_16x16x32_bf16 v[240:243], v[152:155], v[68:71], v[240:243]
    v_mfma_f32_16x16x32_bf16 v[224:227], v[144:147], v[72:75], v[224:227]
    v_perm_b32 v208, v182, v178, s82
    v_perm_b32 v209, v190, v186, s82
    v_mfma_f32_16x16x32_bf16 v[244:247], v[152:155], v[72:75], v[244:247]
    v_mfma_f32_16x16x32_bf16 v[228:231], v[144:147], v[76:79], v[228:231]
    v_mfma_f32_16x16x32_bf16 v[248:251], v[152:155], v[76:79], v[248:251]
    v_mfma_f32_16x16x32_bf16 v[232:235], v[144:147], v[80:83], v[232:235]
    v_perm_b32 v210, v198, v194, s82
    v_perm_b32 v211, v206, v202, s82
    v_mfma_f32_16x16x32_bf16 v[252:255], v[152:155], v[80:83], v[252:255]
    v_mfma_f32_16x16x32_bf16 v[216:219], v[148:151], v[84:87], v[216:219]
    v_mfma_f32_16x16x32_bf16 v[236:239], v[156:159], v[84:87], v[236:239]
    v_mfma_f32_16x16x32_bf16 v[220:223], v[148:151], v[88:91], v[220:223]
    s_waitcnt vmcnt(34)
    ds_read_b128 v[160:163], v38 offset:0
    s_add_u32 s80, s81, 163840
    buffer_store_dwordx4 v[208:211], v17, s[48:51], s80 offen sc1
    v_mfma_f32_16x16x32_bf16 v[240:243], v[156:159], v[88:91], v[240:243]
    ds_read_b128 v[168:171], v38 offset:512
    v_mfma_f32_16x16x32_bf16 v[224:227], v[148:151], v[92:95], v[224:227]
    ds_read_b128 v[164:167], v39 offset:0
    v_mfma_f32_16x16x32_bf16 v[244:247], v[156:159], v[92:95], v[244:247]
    ds_read_b128 v[172:175], v39 offset:512
    v_mfma_f32_16x16x32_bf16 v[228:231], v[148:151], v[96:99], v[228:231]
    v_perm_b32 v212, v182, v178, s83
    v_perm_b32 v213, v190, v186, s83
    v_mfma_f32_16x16x32_bf16 v[248:251], v[156:159], v[96:99], v[248:251]
    v_mfma_f32_16x16x32_bf16 v[232:235], v[148:151], v[100:103], v[232:235]
    v_mfma_f32_16x16x32_bf16 v[252:255], v[156:159], v[100:103], v[252:255]
    s_waitcnt lgkmcnt(0)
    s_waitcnt vmcnt(30)
    s_barrier
    v_mfma_f32_16x16x32_bf16 a[8:11], v[160:163], v[160:163], a[8:11]
    s_add_u32 s76, s3, 0
    s_and_b32 s76, s76, 0x180
    s_or_b32 s76, s76, s6
    s_add_u32 m0, s73, 65536
    s_add_u32 s77, s86, s76
    buffer_load_dwordx4 v13, s[44:47], s77 offen lds
    v_mfma_f32_16x16x32_bf16 a[0:3], v[48:51], v[160:163], a[0:3]
    s_add_u32 m0, s73, 66560
    s_nop 0
    buffer_load_dwordx4 v30, s[44:47], s77 offen lds
    v_mfma_f32_16x16x32_bf16 a[12:15], v[168:171], v[168:171], a[12:15]
    s_add_u32 m0, s73, 67584
    s_add_u32 s77, s87, s76
    buffer_load_dwordx4 v13, s[44:47], s77 offen lds
    v_perm_b32 v214, v198, v194, s83
    v_perm_b32 v215, v206, v202, s83
    v_mfma_f32_16x16x32_bf16 a[4:7], v[48:51], v[168:171], a[4:7]
    s_add_u32 m0, s73, 68608
    s_nop 0
    buffer_load_dwordx4 v30, s[44:47], s77 offen lds
    v_mfma_f32_16x16x32_bf16 a[8:11], v[164:167], v[164:167], a[8:11]
    s_add_u32 m0, s73, 69632
    s_add_u32 s77, s88, s76
    buffer_load_dwordx4 v13, s[44:47], s77 offen lds
    v_mfma_f32_16x16x32_bf16 a[0:3], v[48:51], v[164:167], a[0:3]
    s_add_u32 m0, s73, 70656
    s_nop 0
    buffer_load_dwordx4 v30, s[44:47], s77 offen lds
    s_add_u32 s80, s81, 204800
    buffer_store_dwordx4 v[212:215], v17, s[48:51], s80 offen sc1
    v_mfma_f32_16x16x32_bf16 a[12:15], v[172:175], v[172:175], a[12:15]
    s_add_u32 m0, s73, 71680
    s_add_u32 s77, s89, s76
    buffer_load_dwordx4 v13, s[44:47], s77 offen lds
    v_mfma_f32_16x16x32_bf16 a[4:7], v[48:51], v[172:175], a[4:7]
    s_add_u32 m0, s73, 72704
    s_nop 0
    buffer_load_dwordx4 v30, s[44:47], s77 offen lds
    v_mfma_f32_16x16x32_bf16 v[216:219], v[160:163], v[104:107], v[216:219]
    ds_read_b128 v[64:67], v32 offset:20480
    v_perm_b32 v208, v183, v179, s82
    v_perm_b32 v209, v191, v187, s82
    v_mfma_f32_16x16x32_bf16 v[236:239], v[168:171], v[104:107], v[236:239]
    ds_read_b128 v[68:71], v32 offset:22528
    v_mfma_f32_16x16x32_bf16 v[220:223], v[160:163], v[108:111], v[220:223]
    ds_read_b128 v[72:75], v32 offset:24576
    v_mfma_f32_16x16x32_bf16 v[240:243], v[168:171], v[108:111], v[240:243]
    ds_read_b128 v[76:79], v32 offset:26624
    v_perm_b32 v210, v199, v195, s82
    v_perm_b32 v211, v207, v203, s82
    v_mfma_f32_16x16x32_bf16 v[224:227], v[160:163], v[112:115], v[224:227]
    ds_read_b128 v[80:83], v32 offset:28672
    v_mfma_f32_16x16x32_bf16 v[244:247], v[168:171], v[112:115], v[244:247]
    ds_read_b128 v[84:87], v33 offset:20480
    v_mfma_f32_16x16x32_bf16 v[228:231], v[160:163], v[116:119], v[228:231]
    ds_read_b128 v[88:91], v33 offset:22528
    v_mfma_f32_16x16x32_bf16 v[248:251], v[168:171], v[116:119], v[248:251]
    ds_read_b128 v[92:95], v33 offset:24576
    s_add_u32 s80, s81, 245760
    buffer_store_dwordx4 v[208:211], v17, s[48:51], s80 offen sc1
    v_mfma_f32_16x16x32_bf16 v[232:235], v[160:163], v[120:123], v[232:235]
    ds_read_b128 v[96:99], v33 offset:26624
    v_mfma_f32_16x16x32_bf16 v[252:255], v[168:171], v[120:123], v[252:255]
    ds_read_b128 v[100:103], v33 offset:28672
    v_mfma_f32_16x16x32_bf16 v[216:219], v[164:167], v[124:127], v[216:219]
    v_perm_b32 v212, v183, v179, s83
    v_perm_b32 v213, v191, v187, s83
    v_mfma_f32_16x16x32_bf16 v[236:239], v[172:175], v[124:127], v[236:239]
    v_mfma_f32_16x16x32_bf16 v[220:223], v[164:167], v[128:131], v[220:223]
    s_waitcnt vmcnt(36)
    ds_read_b128 v[144:147], v36 offset:0
    v_mfma_f32_16x16x32_bf16 v[240:243], v[172:175], v[128:131], v[240:243]
    ds_read_b128 v[152:155], v36 offset:512
    v_perm_b32 v214, v199, v195, s83
    v_perm_b32 v215, v207, v203, s83
    v_mfma_f32_16x16x32_bf16 v[224:227], v[164:167], v[132:135], v[224:227]
    ds_read_b128 v[148:151], v37 offset:0
    v_mfma_f32_16x16x32_bf16 v[244:247], v[172:175], v[132:135], v[244:247]
    ds_read_b128 v[156:159], v37 offset:512
    v_mfma_f32_16x16x32_bf16 v[228:231], v[164:167], v[136:139], v[228:231]
    s_add_u32 s80, s81, 286720
    buffer_store_dwordx4 v[212:215], v17, s[48:51], s80 offen sc1
    v_mfma_f32_16x16x32_bf16 v[248:251], v[172:175], v[136:139], v[248:251]
    v_mfma_f32_16x16x32_bf16 v[232:235], v[164:167], v[140:143], v[232:235]
    v_mfma_f32_16x16x32_bf16 v[252:255], v[172:175], v[140:143], v[252:255]
    s_branch k1_v_join
k1_v_dn:
    s_waitcnt lgkmcnt(0)
    s_waitcnt vmcnt(31)
    s_barrier
    v_mfma_f32_16x16x32_bf16 a[8:11], v[160:163], v[160:163], a[8:11]
    s_add_u32 m0, s85, 131072
    s_add_u32 s77, s101, 0
    buffer_load_dwordx4 v42, s[40:43], s77 offen lds
    v_mfma_f32_16x16x32_bf16 a[0:3], v[48:51], v[160:163], a[0:3]
    s_add_u32 m0, s85, 132096
    s_add_u32 s77, s101, 10240
    buffer_load_dwordx4 v42, s[40:43], s77 offen lds
    v_mfma_f32_16x16x32_bf16 a[12:15], v[168:171], v[168:171], a[12:15]
    s_add_u32 m0, s85, 133120
    s_add_u32 s77, s101, 20480
    buffer_load_dwordx4 v42, s[40:43], s77 offen lds
    s_waitcnt vmcnt(22)
    v_perm_b32 v208, v180, v176, s82
    v_perm_b32 v209, v188, v184, s82
    v_mfma_f32_16x16x32_bf16 a[4:7], v[48:51], v[168:171], a[4:7]
    s_add_u32 m0, s85, 134144
    s_add_u32 s77, s101, 30720
    buffer_load_dwordx4 v42, s[40:43], s77 offen lds
    v_perm_b32 v210, v196, v192, s82
    v_perm_b32 v211, v204, v200, s82
    v_mfma_f32_16x16x32_bf16 a[8:11], v[164:167], v[164:167], a[8:11]
    s_add_u32 m0, s85, 135168
    s_add_u32 s77, s101, 40960
    buffer_load_dwordx4 v42, s[40:43], s77 offen lds
    v_mfma_f32_16x16x32_bf16 a[0:3], v[48:51], v[164:167], a[0:3]
    s_add_u32 m0, s73, 32768
    s_add_u32 s77, s101, 0
    buffer_load_dwordx4 v40, s[52:55], s77 offen lds
    v_xor_b32 v5, 0, v53
    ds_write_b128 v5, v[208:211]
    v_mfma_f32_16x16x32_bf16 a[12:15], v[172:175], v[172:175], a[12:15]
    s_add_u32 m0, s73, 33792
    s_add_u32 s77, s101, 10240
    buffer_load_dwordx4 v41, s[52:55], s77 offen lds
    v_mfma_f32_16x16x32_bf16 a[4:7], v[48:51], v[172:175], a[4:7]
    s_add_u32 m0, s73, 34816
    s_add_u32 s77, s101, 20480
    buffer_load_dwordx4 v40, s[52:55], s77 offen lds
    v_perm_b32 v212, v180, v176, s83
    v_perm_b32 v213, v188, v184, s83
    v_mfma_f32_16x16x32_bf16 v[216:219], v[160:163], v[104:107], v[216:219]
    s_add_u32 m0, s73, 35840
    s_add_u32 s77, s101, 30720
    buffer_load_dwordx4 v41, s[52:55], s77 offen lds
    v_mfma_f32_16x16x32_bf16 v[236:239], v[168:171], v[104:107], v[236:239]
    s_mov_b64 exec, 0xffff
    buffer_load_dword v57, v56, s[44:47], 0 offen offset:384
    s_mov_b64 exec, -1
    v_perm_b32 v214, v196, v192, s83
    v_perm_b32 v215, v204, v200, s83
    v_mfma_f32_16x16x32_bf16 v[220:223], v[160:163], v[108:111], v[220:223]
    ds_read_b128 v[64:67], v32 offset:0
    v_mfma_f32_16x16x32_bf16 v[240:243], v[168:171], v[108:111], v[240:243]
    ds_read_b128 v[68:71], v32 offset:2048
    v_xor_b32 v5, 16, v53
    ds_write_b128 v5, v[212:215]
    v_mfma_f32_16x16x32_bf16 v[224:227], v[160:163], v[112:115], v[224:227]
    ds_read_b128 v[72:75], v32 offset:4096
    v_mfma_f32_16x16x32_bf16 v[244:247], v[168:171], v[112:115], v[244:247]
    ds_read_b128 v[76:79], v32 offset:6144
    v_perm_b32 v208, v181, v177, s82
    v_perm_b32 v209, v189, v185, s82
    v_mfma_f32_16x16x32_bf16 v[228:231], v[160:163], v[116:119], v[228:231]
    ds_read_b128 v[80:83], v32 offset:8192
    v_mfma_f32_16x16x32_bf16 v[248:251], v[168:171], v[116:119], v[248:251]
    ds_read_b128 v[84:87], v33 offset:0
    v_perm_b32 v210, v197, v193, s82
    v_perm_b32 v211, v205, v201, s82
    v_mfma_f32_16x16x32_bf16 v[232:235], v[160:163], v[120:123], v[232:235]
    ds_read_b128 v[88:91], v33 offset:2048
    v_xor_b32 v5, 32, v53
    ds_write_b128 v5, v[208:211]
    v_mfma_f32_16x16x32_bf16 v[252:255], v[168:171], v[120:123], v[252:255]
    ds_read_b128 v[92:95], v33 offset:4096
    v_mfma_f32_16x16x32_bf16 v[216:219], v[164:167], v[124:127], v[216:219]
    ds_read_b128 v[96:99], v33 offset:6144
    v_perm_b32 v212, v181, v177, s83
    v_perm_b32 v213, v189, v185, s83
    v_mfma_f32_16x16x32_bf16 v[236:239], v[172:175], v[124:127], v[236:239]
    ds_read_b128 v[100:103], v33 offset:8192
    v_mfma_f32_16x16x32_bf16 v[220:223], v[164:167], v[128:131], v[220:223]
    ds_read_b128 v[144:147], v36 offset:36864
    v_perm_b32 v214, v197, v193, s83
    v_perm_b32 v215, v205, v201, s83
    v_mfma_f32_16x16x32_bf16 v[240:243], v[172:175], v[128:131], v[240:243]
    ds_read_b128 v[152:155], v36 offset:37376
    v_mfma_f32_16x16x32_bf16 v[224:227], v[164:167], v[132:135], v[224:227]
    ds_read_b128 v[148:151], v37 offset:36864
    v_xor_b32 v5, 48, v53
    ds_write_b128 v5, v[212:215]
    v_mfma_f32_16x16x32_bf16 v[244:247], v[172:175], v[132:135], v[244:247]
    ds_read_b128 v[156:159], v37 offset:37376
    v_mfma_f32_16x16x32_bf16 v[228:231], v[164:167], v[136:139], v[228:231]
    v_perm_b32 v208, v182, v178, s82
    v_perm_b32 v209, v190, v186, s82
    v_mfma_f32_16x16x32_bf16 v[248:251], v[172:175], v[136:139], v[248:251]
    v_mfma_f32_16x16x32_bf16 v[232:235], v[164:167], v[140:143], v[232:235]
    v_perm_b32 v210, v198, v194, s82
    v_perm_b32 v211, v206, v202, s82
    v_mfma_f32_16x16x32_bf16 v[252:255], v[172:175], v[140:143], v[252:255]
    s_waitcnt lgkmcnt(0)
    v_mfma_f32_16x16x32_bf16 a[16:19], v[48:51], v[64:67], a[16:19]
    s_add_u32 m0, s73, 36864
    s_add_u32 s77, s101, 0
    s_xor_b32 s77, s77, 128
    buffer_load_dwordx4 v40, s[52:55], s77 offen lds
    v_mfma_f32_16x16x32_bf16 a[20:23], v[48:51], v[68:71], a[20:23]
    s_add_u32 m0, s73, 37888
    s_add_u32 s77, s101, 10240
    s_xor_b32 s77, s77, 128
    buffer_load_dwordx4 v41, s[52:55], s77 offen lds
    v_mfma_f32_16x16x32_bf16 a[24:27], v[48:51], v[72:75], a[24:27]
    s_add_u32 m0, s73, 38912
    s_add_u32 s77, s101, 20480
    s_xor_b32 s77, s77, 128
    buffer_load_dwordx4 v40, s[52:55], s77 offen lds
    v_xor_b32 v5, 64, v53
    ds_write_b128 v5, v[208:211]
    v_mfma_f32_16x16x32_bf16 a[28:31], v[48:51], v[76:79], a[28:31]
    s_add_u32 m0, s73, 39936
    s_add_u32 s77, s101, 30720
    s_xor_b32 s77, s77, 128
    buffer_load_dwordx4 v41, s[52:55], s77 offen lds
    v_mfma_f32_16x16x32_bf16 a[32:35], v[48:51], v[80:83], a[32:35]
    buffer_load_dword v55, v31, s[48:51], 0 offen sc1
    v_perm_b32 v212, v182, v178, s83
    v_perm_b32 v213, v190, v186, s83
    v_mfma_f32_16x16x32_bf16 a[8:11], v[144:147], v[144:147], a[8:11]
    ds_read_b128 v[104:107], v34 offset:0
    v_mfma_f32_16x16x32_bf16 a[0:3], v[48:51], v[144:147], a[0:3]
    ds_read_b128 v[108:111], v34 offset:2048
    v_perm_b32 v214, v198, v194, s83
    v_perm_b32 v215, v206, v202, s83
    v_mfma_f32_16x16x32_bf16 a[12:15], v[152:155], v[152:155], a[12:15]
    ds_read_b128 v[112:115], v34 offset:4096
    v_mfma_f32_16x16x32_bf16 a[4:7], v[48:51], v[152:155], a[4:7]
    ds_read_b128 v[116:119], v34 offset:6144
    v_xor_b32 v5, 80, v53
    ds_write_b128 v5, v[212:215]
    v_mfma_f32_16x16x32_bf16 a[8:11], v[148:151], v[148:151], a[8:11]
    ds_read_b128 v[120:123], v34 offset:8192
    v_mfma_f32_16x16x32_bf16 a[0:3], v[48:51], v[148:151], a[0:3]
    ds_read_b128 v[124:127], v35 offset:0
    v_perm_b32 v208, v183, v179, s82
    v_perm_b32 v209, v191, v187, s82
    v_mfma_f32_16x16x32_bf16 a[12:15], v[156:159], v[156:159], a[12:15]
    ds_read_b128 v[128:131], v35 offset:2048
    v_mfma_f32_16x16x32_bf16 a[4:7], v[48:51], v[156:159], a[4:7]
    ds_read_b128 v[132:135], v35 offset:4096
    v_mfma_f32_16x16x32_bf16 v[216:219], v[144:147], v[64:67], v[216:219]
    ds_read_b128 v[136:139], v35 offset:6144
    v_perm_b32 v210, v199, v195, s82
    v_perm_b32 v211, v207, v203, s82
    v_mfma_f32_16x16x32_bf16 v[236:239], v[152:155], v[64:67], v[236:239]
    ds_read_b128 v[140:143], v35 offset:8192
    v_mfma_f32_16x16x32_bf16 v[220:223], v[144:147], v[68:71], v[220:223]
    v_xor_b32 v5, 96, v53
    ds_write_b128 v5, v[208:211]
    v_mfma_f32_16x16x32_bf16 v[240:243], v[152:155], v[68:71], v[240:243]
    v_mfma_f32_16x16x32_bf16 v[224:227], v[144:147], v[72:75], v[224:227]
    v_perm_b32 v212, v183, v179, s83
    v_perm_b32 v213, v191, v187, s83
    v_mfma_f32_16x16x32_bf16 v[244:247], v[152:155], v[72:75], v[244:247]
    v_mfma_f32_16x16x32_bf16 v[228:231], v[144:147], v[76:79], v[228:231]
    v_perm_b32 v214, v199, v195, s83
    v_perm_b32 v215, v207, v203, s83
    v_mfma_f32_16x16x32_bf16 v[248:251], v[152:155], v[76:79], v[248:251]
    v_mfma_f32_16x16x32_bf16 v[232:235], v[144:147], v[80:83], v[232:235]
    v_xor_b32 v5, 112, v53
    ds_write_b128 v5, v[212:215]
    v_mfma_f32_16x16x32_bf16 v[252:255], v[152:155], v[80:83], v[252:255]
    v_mfma_f32_16x16x32_bf16 v[216:219], v[148:151], v[84:87], v[216:219]
    v_mfma_f32_16x16x32_bf16 v[236:239], v[156:159], v[84:87], v[236:239]
    v_xor_b32 v5, 0, v54
    ds_read_b128 v[176:179], v5 offset:0
    v_mfma_f32_16x16x32_bf16 v[220:223], v[148:151], v[88:91], v[220:223]
    s_waitcnt vmcnt(30)
    ds_read_b128 v[160:163], v38 offset:0
    v_mfma_f32_16x16x32_bf16 v[240:243], v[156:159], v[88:91], v[240:243]
    ds_read_b128 v[168:171], v38 offset:512
    v_xor_b32 v5, 16, v54
    ds_read_b128 v[180:183], v5 offset:1024
    v_mfma_f32_16x16x32_bf16 v[224:227], v[148:151], v[92:95], v[224:227]
    ds_read_b128 v[164:167], v39 offset:0
    v_mfma_f32_16x16x32_bf16 v[244:247], v[156:159], v[92:95], v[244:247]
    ds_read_b128 v[172:175], v39 offset:512
    v_xor_b32 v5, 32, v54
    ds_read_b128 v[184:187], v5 offset:2048
    v_mfma_f32_16x16x32_bf16 v[228:231], v[148:151], v[96:99], v[228:231]
    v_mfma_f32_16x16x32_bf16 v[248:251], v[156:159], v[96:99], v[248:251]
    v_xor_b32 v5, 48, v54
    ds_read_b128 v[188:191], v5 offset:3072
    v_mfma_f32_16x16x32_bf16 v[232:235], v[148:151], v[100:103], v[232:235]
    v_mfma_f32_16x16x32_bf16 v[252:255], v[156:159], v[100:103], v[252:255]
    s_waitcnt lgkmcnt(0)
    s_waitcnt vmcnt(25)
    s_barrier
    v_mfma_f32_16x16x32_bf16 a[8:11], v[160:163], v[160:163], a[8:11]
    s_add_u32 s76, s3, 0
    s_and_b32 s76, s76, 0x180
    s_or_b32 s76, s76, s6
    s_add_u32 m0, s73, 65536
    s_add_u32 s77, s86, s76
    buffer_load_dwordx4 v13, s[44:47], s77 offen lds
    v_mfma_f32_16x16x32_bf16 a[0:3], v[48:51], v[160:163], a[0:3]
    s_add_u32 m0, s73, 66560
    s_nop 0
    buffer_load_dwordx4 v30, s[44:47], s77 offen lds
    v_mfma_f32_16x16x32_bf16 a[12:15], v[168:171], v[168:171], a[12:15]
    s_add_u32 m0, s73, 67584
    s_add_u32 s77, s87, s76
    buffer_load_dwordx4 v13, s[44:47], s77 offen lds
    v_xor_b32 v5, 64, v54
    ds_read_b128 v[192:195], v5 offset:4096
    v_mfma_f32_16x16x32_bf16 a[4:7], v[48:51], v[168:171], a[4:7]
    s_add_u32 m0, s73, 68608
    s_nop 0
    buffer_load_dwordx4 v30, s[44:47], s77 offen lds
    v_mfma_f32_16x16x32_bf16 a[8:11], v[164:167], v[164:167], a[8:11]
    s_add_u32 m0, s73, 69632
    s_add_u32 s77, s88, s76
    buffer_load_dwordx4 v13, s[44:47], s77 offen lds
    v_xor_b32 v5, 80, v54
    ds_read_b128 v[196:199], v5 offset:5120
    v_mfma_f32_16x16x32_bf16 a[0:3], v[48:51], v[164:167], a[0:3]
    s_add_u32 m0, s73, 70656
    s_nop 0
    buffer_load_dwordx4 v30, s[44:47], s77 offen lds
    v_mfma_f32_16x16x32_bf16 a[12:15], v[172:175], v[172:175], a[12:15]
    s_add_u32 m0, s73, 71680
    s_add_u32 s77, s89, s76
    buffer_load_dwordx4 v13, s[44:47], s77 offen lds
    v_xor_b32 v5, 96, v54
    ds_read_b128 v[200:203], v5 offset:6144
    v_mfma_f32_16x16x32_bf16 a[4:7], v[48:51], v[172:175], a[4:7]
    s_add_u32 m0, s73, 72704
    s_nop 0
    buffer_load_dwordx4 v30, s[44:47], s77 offen lds
    v_mfma_f32_16x16x32_bf16 v[216:219], v[160:163], v[104:107], v[216:219]
    ds_read_b128 v[64:67], v32 offset:20480
    v_xor_b32 v5, 112, v54
    ds_read_b128 v[204:207], v5 offset:7168
    v_mfma_f32_16x16x32_bf16 v[236:239], v[168:171], v[104:107], v[236:239]
    ds_read_b128 v[68:71], v32 offset:22528
    v_mfma_f32_16x16x32_bf16 v[220:223], v[160:163], v[108:111], v[220:223]
    ds_read_b128 v[72:75], v32 offset:24576
    s_add_u32 s80, s81, 0
    buffer_store_dwordx4 v[176:179], v17, s[48:51], s80 offen sc1
    v_mfma_f32_16x16x32_bf16 v[240:243], v[168:171], v[108:111], v[240:243]
    ds_read_b128 v[76:79], v32 offset:26624
    v_mfma_f32_16x16x32_bf16 v[224:227], v[160:163], v[112:115], v[224:227]
    ds_read_b128 v[80:83], v32 offset:28672
    s_add_u32 s80, s81, 49152
    buffer_store_dwordx4 v[180:183], v17, s[48:51], s80 offen sc1
    v_mfma_f32_16x16x32_bf16 v[244:247], v[168:171], v[112:115], v[244:247]
    ds_read_b128 v[84:87], v33 offset:20480
    v_mfma_f32_16x16x32_bf16 v[228:231], v[160:163], v[116:119], v[228:231]
    ds_read_b128 v[88:91], v33 offset:22528
    v_mfma_f32_16x16x32_bf16 v[248:251], v[168:171], v[116:119], v[248:251]
    ds_read_b128 v[92:95], v33 offset:24576
    s_add_u32 s80, s81, 98304
    buffer_store_dwordx4 v[184:187], v17, s[48:51], s80 offen sc1
    v_mfma_f32_16x16x32_bf16 v[232:235], v[160:163], v[120:123], v[232:235]
    ds_read_b128 v[96:99], v33 offset:26624
    v_mfma_f32_16x16x32_bf16 v[252:255], v[168:171], v[120:123], v[252:255]
    ds_read_b128 v[100:103], v33 offset:28672
    s_add_u32 s80, s81, 147456
    buffer_store_dwordx4 v[188:191], v17, s[48:51], s80 offen sc1
    v_mfma_f32_16x16x32_bf16 v[216:219], v[164:167], v[124:127], v[216:219]
    v_mfma_f32_16x16x32_bf16 v[236:239], v[172:175], v[124:127], v[236:239]
    s_waitcnt lgkmcnt(13)
    s_add_u32 s80, s81, 196608
    buffer_store_dwordx4 v[192:195], v17, s[48:51], s80 offen sc1
    v_mfma_f32_16x16x32_bf16 v[220:223], v[164:167], v[128:131], v[220:223]
    s_waitcnt vmcnt(34)
    ds_read_b128 v[144:147], v36 offset:0
    v_mfma_f32_16x16x32_bf16 v[240:243], v[172:175], v[128:131], v[240:243]
    ds_read_b128 v[152:155], v36 offset:512
    s_waitcnt lgkmcnt(14)
    s_add_u32 s80, s81, 245760
    buffer_store_dwordx4 v[196:199], v17, s[48:51], s80 offen sc1
    v_mfma_f32_16x16x32_bf16 v[224:227], v[164:167], v[132:135], v[224:227]
    ds_read_b128 v[148:151], v37 offset:0
    v_mfma_f32_16x16x32_bf16 v[244:247], v[172:175], v[132:135], v[244:247]
    ds_read_b128 v[156:159], v37 offset:512
    s_waitcnt lgkmcnt(15)
    s_add_u32 s80, s81, 294912
    buffer_store_dwordx4 v[200:203], v17, s[48:51], s80 offen sc1
    v_mfma_f32_16x16x32_bf16 v[228:231], v[164:167], v[136:139], v[228:231]
    v_mfma_f32_16x16x32_bf16 v[248:251], v[172:175], v[136:139], v[248:251]
    s_waitcnt lgkmcnt(13)
    s_add_u32 s80, s81, 344064
    buffer_store_dwordx4 v[204:207], v17, s[48:51], s80 offen sc1
    v_mfma_f32_16x16x32_bf16 v[232:235], v[164:167], v[140:143], v[232:235]
    v_mfma_f32_16x16x32_bf16 v[252:255], v[172:175], v[140:143], v[252:255]
    s_branch k1_v_join
k1_v_no:
    s_waitcnt lgkmcnt(0)
    s_waitcnt vmcnt(31)
    s_barrier
    v_mfma_f32_16x16x32_bf16 a[8:11], v[160:163], v[160:163], a[8:11]
    s_add_u32 m0, s85, 131072
    s_add_u32 s77, s101, 0
    buffer_load_dwordx4 v42, s[40:43], s77 offen lds
    v_mfma_f32_16x16x32_bf16 a[0:3], v[48:51], v[160:163], a[0:3]
    s_add_u32 m0, s85, 132096
    s_add_u32 s77, s101, 10240
    buffer_load_dwordx4 v42, s[40:43], s77 offen lds
    v_mfma_f32_16x16x32_bf16 a[12:15], v[168:171], v[168:171], a[12:15]
    s_add_u32 m0, s85, 133120
    s_add_u32 s77, s101, 20480
    buffer_load_dwordx4 v42, s[40:43], s77 offen lds
    s_waitcnt vmcnt(22)
    v_mfma_f32_16x16x32_bf16 a[4:7], v[48:51], v[168:171], a[4:7]
    s_add_u32 m0, s85, 134144
    s_add_u32 s77, s101, 30720
    buffer_load_dwordx4 v42, s[40:43], s77 offen lds
    v_mfma_f32_16x16x32_bf16 a[8:11], v[164:167], v[164:167], a[8:11]
    s_add_u32 m0, s85, 135168
    s_add_u32 s77, s101, 40960
    buffer_load_dwordx4 v42, s[40:43], s77 offen lds
    v_mfma_f32_16x16x32_bf16 a[0:3], v[48:51], v[164:167], a[0:3]
    s_add_u32 m0, s73, 32768
    s_add_u32 s77, s101, 0
    buffer_load_dwordx4 v40, s[52:55], s77 offen lds
    v_mfma_f32_16x16x32_bf16 a[12:15], v[172:175], v[172:175], a[12:15]
    s_add_u32 m0, s73, 33792
    s_add_u32 s77, s101, 10240
    buffer_load_dwordx4 v41, s[52:55], s77 offen lds
    v_mfma_f32_16x16x32_bf16 a[4:7], v[48:51], v[172:175], a[4:7]
    s_add_u32 m0, s73, 34816
    s_add_u32 s77, s101, 20480
    buffer_load_dwordx4 v40, s[52:55], s77 offen lds
    v_mfma_f32_16x16x32_bf16 v[216:219], v[160:163], v[104:107], v[216:219]
    s_add_u32 m0, s73, 35840
    s_add_u32 s77, s101, 30720
    buffer_load_dwordx4 v41, s[52:55], s77 offen lds
    v_mfma_f32_16x16x32_bf16 v[236:239], v[168:171], v[104:107], v[236:239]
    s_mov_b64 exec, 0xffff
    buffer_load_dword v57, v56, s[44:47], 0 offen offset:384
    s_mov_b64 exec, -1
    v_mfma_f32_16x16x32_bf16 v[220:223], v[160:163], v[108:111], v[220:223]
    ds_read_b128 v[64:67], v32 offset:0
    v_mfma_f32_16x16x32_bf16 v[240:243], v[168:171], v[108:111], v[240:243]
    ds_read_b128 v[68:71], v32 offset:2048
    v_mfma_f32_16x16x32_bf16 v[224:227], v[160:163], v[112:115], v[224:227]
    ds_read_b128 v[72:75], v32 offset:4096
    v_mfma_f32_16x16x32_bf16 v[244:247], v[168:171], v[112:115], v[244:247]
    ds_read_b128 v[76:79], v32 offset:6144
    v_mfma_f32_16x16x32_bf16 v[228:231], v[160:163], v[116:119], v[228:231]
    ds_read_b128 v[80:83], v32 offset:8192
    v_mfma_f32_16x16x32_bf16 v[248:251], v[168:171], v[116:119], v[248:251]
    ds_read_b128 v[84:87], v33 offset:0
    v_mfma_f32_16x16x32_bf16 v[232:235], v[160:163], v[120:123], v[232:235]
    ds_read_b128 v[88:91], v33 offset:2048
    v_mfma_f32_16x16x32_bf16 v[252:255], v[168:171], v[120:123], v[252:255]
    ds_read_b128 v[92:95], v33 offset:4096
    v_mfma_f32_16x16x32_bf16 v[216:219], v[164:167], v[124:127], v[216:219]
    ds_read_b128 v[96:99], v33 offset:6144
    v_mfma_f32_16x16x32_bf16 v[236:239], v[172:175], v[124:127], v[236:239]
    ds_read_b128 v[100:103], v33 offset:8192
    v_mfma_f32_16x16x32_bf16 v[220:223], v[164:167], v[128:131], v[220:223]
    ds_read_b128 v[144:147], v36 offset:36864
    v_mfma_f32_16x16x32_bf16 v[240:243], v[172:175], v[128:131], v[240:243]
    ds_read_b128 v[152:155], v36 offset:37376
    v_mfma_f32_16x16x32_bf16 v[224:227], v[164:167], v[132:135], v[224:227]
    ds_read_b128 v[148:151], v37 offset:36864
    v_mfma_f32_16x16x32_bf16 v[244:247], v[172:175], v[132:135], v[244:247]
    ds_read_b128 v[156:159], v37 offset:37376
    v_mfma_f32_16x16x32_bf16 v[228:231], v[164:167], v[136:139], v[228:231]
    v_mfma_f32_16x16x32_bf16 v[248:251], v[172:175], v[136:139], v[248:251]
    v_mfma_f32_16x16x32_bf16 v[232:235], v[164:167], v[140:143], v[232:235]
    v_mfma_f32_16x16x32_bf16 v[252:255], v[172:175], v[140:143], v[252:255]
    s_waitcnt lgkmcnt(0)
    v_mfma_f32_16x16x32_bf16 a[16:19], v[48:51], v[64:67], a[16:19]
    s_add_u32 m0, s73, 36864
    s_add_u32 s77, s101, 0
    s_xor_b32 s77, s77, 128
    buffer_load_dwordx4 v40, s[52:55], s77 offen lds
    v_mfma_f32_16x16x32_bf16 a[20:23], v[48:51], v[68:71], a[20:23]
    s_add_u32 m0, s73, 37888
    s_add_u32 s77, s101, 10240
    s_xor_b32 s77, s77, 128
    buffer_load_dwordx4 v41, s[52:55], s77 offen lds
    v_mfma_f32_16x16x32_bf16 a[24:27], v[48:51], v[72:75], a[24:27]
    s_add_u32 m0, s73, 38912
    s_add_u32 s77, s101, 20480
    s_xor_b32 s77, s77, 128
    buffer_load_dwordx4 v40, s[52:55], s77 offen lds
    v_mfma_f32_16x16x32_bf16 a[28:31], v[48:51], v[76:79], a[28:31]
    s_add_u32 m0, s73, 39936
    s_add_u32 s77, s101, 30720
    s_xor_b32 s77, s77, 128
    buffer_load_dwordx4 v41, s[52:55], s77 offen lds
    v_mfma_f32_16x16x32_bf16 a[32:35], v[48:51], v[80:83], a[32:35]
    buffer_load_dword v55, v31, s[48:51], 0 offen sc1
    v_mfma_f32_16x16x32_bf16 a[8:11], v[144:147], v[144:147], a[8:11]
    ds_read_b128 v[104:107], v34 offset:0
    v_mfma_f32_16x16x32_bf16 a[0:3], v[48:51], v[144:147], a[0:3]
    ds_read_b128 v[108:111], v34 offset:2048
    v_mfma_f32_16x16x32_bf16 a[12:15], v[152:155], v[152:155], a[12:15]
    ds_read_b128 v[112:115], v34 offset:4096
    v_mfma_f32_16x16x32_bf16 a[4:7], v[48:51], v[152:155], a[4:7]
    ds_read_b128 v[116:119], v34 offset:6144
    v_mfma_f32_16x16x32_bf16 a[8:11], v[148:151], v[148:151], a[8:11]
    ds_read_b128 v[120:123], v34 offset:8192
    v_mfma_f32_16x16x32_bf16 a[0:3], v[48:51], v[148:151], a[0:3]
    ds_read_b128 v[124:127], v35 offset:0
    v_mfma_f32_16x16x32_bf16 a[12:15], v[156:159], v[156:159], a[12:15]
    ds_read_b128 v[128:131], v35 offset:2048
    v_mfma_f32_16x16x32_bf16 a[4:7], v[48:51], v[156:159], a[4:7]
    ds_read_b128 v[132:135], v35 offset:4096
    v_mfma_f32_16x16x32_bf16 v[216:219], v[144:147], v[64:67], v[216:219]
    ds_read_b128 v[136:139], v35 offset:6144
    v_mfma_f32_16x16x32_bf16 v[236:239], v[152:155], v[64:67], v[236:239]
    ds_read_b128 v[140:143], v35 offset:8192
    v_mfma_f32_16x16x32_bf16 v[220:223], v[144:147], v[68:71], v[220:223]
    v_mfma_f32_16x16x32_bf16 v[240:243], v[152:155], v[68:71], v[240:243]
    v_mfma_f32_16x16x32_bf16 v[224:227], v[144:147], v[72:75], v[224:227]
    v_mfma_f32_16x16x32_bf16 v[244:247], v[152:155], v[72:75], v[244:247]
    v_mfma_f32_16x16x32_bf16 v[228:231], v[144:147], v[76:79], v[228:231]
    v_mfma_f32_16x16x32_bf16 v[248:251], v[152:155], v[76:79], v[248:251]
    v_mfma_f32_16x16x32_bf16 v[232:235], v[144:147], v[80:83], v[232:235]
    v_mfma_f32_16x16x32_bf16 v[252:255], v[152:155], v[80:83], v[252:255]
    v_mfma_f32_16x16x32_bf16 v[216:219], v[148:151], v[84:87], v[216:219]
    v_mfma_f32_16x16x32_bf16 v[236:239], v[156:159], v[84:87], v[236:239]
    v_mfma_f32_16x16x32_bf16 v[220:223], v[148:151], v[88:91], v[220:223]
    s_waitcnt vmcnt(30)
    ds_read_b128 v[160:163], v38 offset:0
    v_mfma_f32_16x16x32_bf16 v[240:243], v[156:159], v[88:91], v[240:243]
    ds_read_b128 v[168:171], v38 offset:512
    v_mfma_f32_16x16x32_bf16 v[224:227], v[148:151], v[92:95], v[224:227]
    ds_read_b128 v[164:167], v39 offset:0
    v_mfma_f32_16x16x32_bf16 v[244:247], v[156:159], v[92:95], v[244:247]
    ds_read_b128 v[172:175], v39 offset:512
    v_mfma_f32_16x16x32_bf16 v[228:231], v[148:151], v[96:99], v[228:231]
    v_mfma_f32_16x16x32_bf16 v[248:251], v[156:159], v[96:99], v[248:251]
    v_mfma_f32_16x16x32_bf16 v[232:235], v[148:151], v[100:103], v[232:235]
    v_mfma_f32_16x16x32_bf16 v[252:255], v[156:159], v[100:103], v[252:255]
    s_waitcnt lgkmcnt(0)
    s_waitcnt vmcnt(25)
    s_barrier
    v_mfma_f32_16x16x32_bf16 a[8:11], v[160:163], v[160:163], a[8:11]
    s_add_u32 s76, s3, 0
    s_and_b32 s76, s76, 0x180
    s_or_b32 s76, s76, s6
    s_add_u32 m0, s73, 65536
    s_add_u32 s77, s86, s76
    buffer_load_dwordx4 v13, s[44:47], s77 offen lds
    v_mfma_f32_16x16x32_bf16 a[0:3], v[48:51], v[160:163], a[0:3]
    s_add_u32 m0, s73, 66560
    s_nop 0
    buffer_load_dwordx4 v30, s[44:47], s77 offen lds
    v_mfma_f32_16x16x32_bf16 a[12:15], v[168:171], v[168:171], a[12:15]
    s_add_u32 m0, s73, 67584
    s_add_u32 s77, s87, s76
    buffer_load_dwordx4 v13, s[44:47], s77 offen lds
    v_mfma_f32_16x16x32_bf16 a[4:7], v[48:51], v[168:171], a[4:7]
    s_add_u32 m0, s73, 68608
    s_nop 0
    buffer_load_dwordx4 v30, s[44:47], s77 offen lds
    v_mfma_f32_16x16x32_bf16 a[8:11], v[164:167], v[164:167], a[8:11]
    s_add_u32 m0, s73, 69632
    s_add_u32 s77, s88, s76
    buffer_load_dwordx4 v13, s[44:47], s77 offen lds
    v_mfma_f32_16x16x32_bf16 a[0:3], v[48:51], v[164:167], a[0:3]
    s_add_u32 m0, s73, 70656
    s_nop 0
    buffer_load_dwordx4 v30, s[44:47], s77 offen lds
    v_mfma_f32_16x16x32_bf16 a[12:15], v[172:175], v[172:175], a[12:15]
    s_add_u32 m0, s73, 71680
    s_add_u32 s77, s89, s76
    buffer_load_dwordx4 v13, s[44:47], s77 offen lds
    v_mfma_f32_16x16x32_bf16 a[4:7], v[48:51], v[172:175], a[4:7]
    s_add_u32 m0, s73, 72704
    s_nop 0
    buffer_load_dwordx4 v30, s[44:47], s77 offen lds
    v_mfma_f32_16x16x32_bf16 v[216:219], v[160:163], v[104:107], v[216:219]
    ds_read_b128 v[64:67], v32 offset:20480
    v_mfma_f32_16x16x32_bf16 v[236:239], v[168:171], v[104:107], v[236:239]
    ds_read_b128 v[68:71], v32 offset:22528
    v_mfma_f32_16x16x32_bf16 v[220:223], v[160:163], v[108:111], v[220:223]
    ds_read_b128 v[72:75], v32 offset:24576
    v_mfma_f32_16x16x32_bf16 v[240:243], v[168:171], v[108:111], v[240:243]
    ds_read_b128 v[76:79], v32 offset:26624
    v_mfma_f32_16x16x32_bf16 v[224:227], v[160:163], v[112:115], v[224:227]
    ds_read_b128 v[80:83], v32 offset:28672
    v_mfma_f32_16x16x32_bf16 v[244:247], v[168:171], v[112:115], v[244:247]
    ds_read_b128 v[84:87], v33 offset:20480
    v_mfma_f32_16x16x32_bf16 v[228:231], v[160:163], v[116:119], v[228:231]
    ds_read_b128 v[88:91], v33 offset:22528
    v_mfma_f32_16x16x32_bf16 v[248:251], v[168:171], v[116:119], v[248:251]
    ds_read_b128 v[92:95], v33 offset:24576
    v_mfma_f32_16x16x32_bf16 v[232:235], v[160:163], v[120:123], v[232:235]
    ds_read_b128 v[96:99], v33 offset:26624
    v_mfma_f32_16x16x32_bf16 v[252:255], v[168:171], v[120:123], v[252:255]
    ds_read_b128 v[100:103], v33 offset:28672
    v_mfma_f32_16x16x32_bf16 v[216:219], v[164:167], v[124:127], v[216:219]
    v_mfma_f32_16x16x32_bf16 v[236:239], v[172:175], v[124:127], v[236:239]
    v_mfma_f32_16x16x32_bf16 v[220:223], v[164:167], v[128:131], v[220:223]
    s_waitcnt vmcnt(29)
    ds_read_b128 v[144:147], v36 offset:0
    v_mfma_f32_16x16x32_bf16 v[240:243], v[172:175], v[128:131], v[240:243]
    ds_read_b128 v[152:155], v36 offset:512
    v_mfma_f32_16x16x32_bf16 v[224:227], v[164:167], v[132:135], v[224:227]
    ds_read_b128 v[148:151], v37 offset:0
    v_mfma_f32_16x16x32_bf16 v[244:247], v[172:175], v[132:135], v[244:247]
    ds_read_b128 v[156:159], v37 offset:512
    v_mfma_f32_16x16x32_bf16 v[228:231], v[164:167], v[136:139], v[228:231]
    v_mfma_f32_16x16x32_bf16 v[248:251], v[172:175], v[136:139], v[248:251]
    v_mfma_f32_16x16x32_bf16 v[232:235], v[164:167], v[140:143], v[232:235]
    v_mfma_f32_16x16x32_bf16 v[252:255], v[172:175], v[140:143], v[252:255]
k1_v_join:
    s_waitcnt lgkmcnt(0)
    v_mfma_f32_16x16x32_bf16 a[16:19], v[48:51], v[64:67], a[16:19]
    ds_read_b128 v[104:107], v34 offset:20480
    v_mfma_f32_16x16x32_bf16 a[20:23], v[48:51], v[68:71], a[20:23]
    ds_read_b128 v[108:111], v34 offset:22528
    v_mfma_f32_16x16x32_bf16 a[24:27], v[48:51], v[72:75], a[24:27]
    ds_read_b128 v[112:115], v34 offset:24576
    v_mfma_f32_16x16x32_bf16 a[28:31], v[48:51], v[76:79], a[28:31]
    ds_read_b128 v[116:119], v34 offset:26624
    v_mfma_f32_16x16x32_bf16 a[32:35], v[48:51], v[80:83], a[32:35]
    ds_read_b128 v[120:123], v34 offset:28672
    v_mfma_f32_16x16x32_bf16 a[8:11], v[144:147], v[144:147], a[8:11]
    ds_read_b128 v[124:127], v35 offset:20480
    v_mfma_f32_16x16x32_bf16 a[0:3], v[48:51], v[144:147], a[0:3]
    ds_read_b128 v[128:131], v35 offset:22528
    v_mfma_f32_16x16x32_bf16 a[12:15], v[152:155], v[152:155], a[12:15]
    ds_read_b128 v[132:135], v35 offset:24576
    v_mfma_f32_16x16x32_bf16 a[4:7], v[48:51], v[152:155], a[4:7]
    ds_read_b128 v[136:139], v35 offset:26624
    v_mfma_f32_16x16x32_bf16 a[8:11], v[148:151], v[148:151], a[8:11]
    ds_read_b128 v[140:143], v35 offset:28672
    v_mfma_f32_16x16x32_bf16 a[0:3], v[48:51], v[148:151], a[0:3]
    v_mfma_f32_16x16x32_bf16 a[12:15], v[156:159], v[156:159], a[12:15]
    v_mfma_f32_16x16x32_bf16 a[4:7], v[48:51], v[156:159], a[4:7]
    v_mfma_f32_16x16x32_bf16 v[216:219], v[144:147], v[64:67], v[216:219]
    v_mfma_f32_16x16x32_bf16 v[236:239], v[152:155], v[64:67], v[236:239]
    v_mfma_f32_16x16x32_bf16 v[220:223], v[144:147], v[68:71], v[220:223]
    v_mfma_f32_16x16x32_bf16 v[240:243], v[152:155], v[68:71], v[240:243]
    v_mfma_f32_16x16x32_bf16 v[224:227], v[144:147], v[72:75], v[224:227]
    v_mfma_f32_16x16x32_bf16 v[244:247], v[152:155], v[72:75], v[244:247]
    v_mfma_f32_16x16x32_bf16 v[228:231], v[144:147], v[76:79], v[228:231]
    v_mfma_f32_16x16x32_bf16 v[248:251], v[152:155], v[76:79], v[248:251]
    v_mfma_f32_16x16x32_bf16 v[232:235], v[144:147], v[80:83], v[232:235]
    v_mfma_f32_16x16x32_bf16 v[252:255], v[152:155], v[80:83], v[252:255]
    v_mfma_f32_16x16x32_bf16 v[216:219], v[148:151], v[84:87], v[216:219]
    v_mfma_f32_16x16x32_bf16 v[236:239], v[156:159], v[84:87], v[236:239]
    v_mfma_f32_16x16x32_bf16 v[220:223], v[148:151], v[88:91], v[220:223]
    s_waitcnt vmcnt(0)
    ds_read_b128 v[160:163], v36 offset:4096
    v_mfma_f32_16x16x32_bf16 v[240:243], v[156:159], v[88:91], v[240:243]
    ds_read_b128 v[168:171], v36 offset:4608
    v_mfma_f32_16x16x32_bf16 v[224:227], v[148:151], v[92:95], v[224:227]
    ds_read_b128 v[164:167], v37 offset:4096
    v_mfma_f32_16x16x32_bf16 v[244:247], v[156:159], v[92:95], v[244:247]
    ds_read_b128 v[172:175], v37 offset:4608
    v_mfma_f32_16x16x32_bf16 v[228:231], v[148:151], v[96:99], v[228:231]
    v_mfma_f32_16x16x32_bf16 v[248:251], v[156:159], v[96:99], v[248:251]
    v_mfma_f32_16x16x32_bf16 v[232:235], v[148:151], v[100:103], v[232:235]
    v_mfma_f32_16x16x32_bf16 v[252:255], v[156:159], v[100:103], v[252:255]
    s_waitcnt lgkmcnt(0)
    s_barrier
    v_mfma_f32_16x16x32_bf16 a[8:11], v[160:163], v[160:163], a[8:11]
    s_add_u32 s76, s3, 0
    s_and_b32 s76, s76, 0x180
    s_or_b32 s76, s76, s6
    s_add_u32 m0, s73, 98304
    s_add_u32 s77, s90, s76
    buffer_load_dwordx4 v13, s[44:47], s77 offen lds
    v_mfma_f32_16x16x32_bf16 a[0:3], v[48:51], v[160:163], a[0:3]
    s_add_u32 m0, s73, 99328
    s_nop 0
    buffer_load_dwordx4 v30, s[44:47], s77 offen lds
    v_mfma_f32_16x16x32_bf16 a[12:15], v[168:171], v[168:171], a[12:15]
    s_add_u32 m0, s73, 100352
    s_add_u32 s77, s91, s76
    buffer_load_dwordx4 v13, s[44:47], s77 offen lds
    v_mfma_f32_16x16x32_bf16 a[4:7], v[48:51], v[168:171], a[4:7]
    s_add_u32 m0, s73, 101376
    s_nop 0
    buffer_load_dwordx4 v30, s[44:47], s77 offen lds
    v_mfma_f32_16x16x32_bf16 a[8:11], v[164:167], v[164:167], a[8:11]
    s_add_u32 m0, s73, 102400
    s_add_u32 s77, s92, s76
    buffer_load_dwordx4 v13, s[44:47], s77 offen lds
    v_mfma_f32_16x16x32_bf16 a[0:3], v[48:51], v[164:167], a[0:3]
    s_add_u32 m0, s73, 103424
    s_nop 0
    buffer_load_dwordx4 v30, s[44:47], s77 offen lds
    v_mfma_f32_16x16x32_bf16 a[12:15], v[172:175], v[172:175], a[12:15]
    s_add_u32 m0, s73, 104448
    s_add_u32 s77, s93, s76
    buffer_load_dwordx4 v13, s[44:47], s77 offen lds
    v_mfma_f32_16x16x32_bf16 a[4:7], v[48:51], v[172:175], a[4:7]
    s_add_u32 m0, s73, 105472
    s_nop 0
    buffer_load_dwordx4 v30, s[44:47], s77 offen lds
    v_mfma_f32_16x16x32_bf16 v[216:219], v[160:163], v[104:107], v[216:219]
    ds_read_b128 v[64:67], v32 offset:49152
    v_mfma_f32_16x16x32_bf16 v[236:239], v[168:171], v[104:107], v[236:239]
    ds_read_b128 v[68:71], v32 offset:51200
    v_mfma_f32_16x16x32_bf16 v[220:223], v[160:163], v[108:111], v[220:223]
    ds_read_b128 v[72:75], v32 offset:53248
    v_mfma_f32_16x16x32_bf16 v[240:243], v[168:171], v[108:111], v[240:243]
    ds_read_b128 v[76:79], v32 offset:55296
    v_mfma_f32_16x16x32_bf16 v[224:227], v[160:163], v[112:115], v[224:227]
    ds_read_b128 v[80:83], v32 offset:57344
    v_mfma_f32_16x16x32_bf16 v[244:247], v[168:171], v[112:115], v[244:247]
    ds_read_b128 v[84:87], v33 offset:49152
    v_mfma_f32_16x16x32_bf16 v[228:231], v[160:163], v[116:119], v[228:231]
    ds_read_b128 v[88:91], v33 offset:51200
    v_mfma_f32_16x16x32_bf16 v[248:251], v[168:171], v[116:119], v[248:251]
    ds_read_b128 v[92:95], v33 offset:53248
    v_mfma_f32_16x16x32_bf16 v[232:235], v[160:163], v[120:123], v[232:235]
    ds_read_b128 v[96:99], v33 offset:55296
    v_mfma_f32_16x16x32_bf16 v[252:255], v[168:171], v[120:123], v[252:255]
    ds_read_b128 v[100:103], v33 offset:57344
    v_mfma_f32_16x16x32_bf16 v[216:219], v[164:167], v[124:127], v[216:219]
    v_mfma_f32_16x16x32_bf16 v[236:239], v[172:175], v[124:127], v[236:239]
    v_mfma_f32_16x16x32_bf16 v[220:223], v[164:167], v[128:131], v[220:223]
    ds_read_b128 v[144:147], v36 offset:32768
    v_mfma_f32_16x16x32_bf16 v[240:243], v[172:175], v[128:131], v[240:243]
    ds_read_b128 v[152:155], v36 offset:33280
    v_mfma_f32_16x16x32_bf16 v[224:227], v[164:167], v[132:135], v[224:227]
    ds_read_b128 v[148:151], v37 offset:32768
    v_mfma_f32_16x16x32_bf16 v[244:247], v[172:175], v[132:135], v[244:247]
    ds_read_b128 v[156:159], v37 offset:33280
    v_mfma_f32_16x16x32_bf16 v[228:231], v[164:167], v[136:139], v[228:231]
    v_mfma_f32_16x16x32_bf16 v[248:251], v[172:175], v[136:139], v[248:251]
    v_mfma_f32_16x16x32_bf16 v[232:235], v[164:167], v[140:143], v[232:235]
    v_mfma_f32_16x16x32_bf16 v[252:255], v[172:175], v[140:143], v[252:255]
    s_waitcnt lgkmcnt(0)
    v_mfma_f32_16x16x32_bf16 a[16:19], v[48:51], v[64:67], a[16:19]
    ds_read_b128 v[104:107], v34 offset:49152
    v_mfma_f32_16x16x32_bf16 a[20:23], v[48:51], v[68:71], a[20:23]
    ds_read_b128 v[108:111], v34 offset:51200
    v_mfma_f32_16x16x32_bf16 a[24:27], v[48:51], v[72:75], a[24:27]
    ds_read_b128 v[112:115], v34 offset:53248
    v_mfma_f32_16x16x32_bf16 a[28:31], v[48:51], v[76:79], a[28:31]
    ds_read_b128 v[116:119], v34 offset:55296
    v_mfma_f32_16x16x32_bf16 a[32:35], v[48:51], v[80:83], a[32:35]
    ds_read_b128 v[120:123], v34 offset:57344
    v_mfma_f32_16x16x32_bf16 a[8:11], v[144:147], v[144:147], a[8:11]
    ds_read_b128 v[124:127], v35 offset:49152
    v_mfma_f32_16x16x32_bf16 a[0:3], v[48:51], v[144:147], a[0:3]
    ds_read_b128 v[128:131], v35 offset:51200
    v_mfma_f32_16x16x32_bf16 a[12:15], v[152:155], v[152:155], a[12:15]
    ds_read_b128 v[132:135], v35 offset:53248
    v_mfma_f32_16x16x32_bf16 a[4:7], v[48:51], v[152:155], a[4:7]
    ds_read_b128 v[136:139], v35 offset:55296
    v_mfma_f32_16x16x32_bf16 a[8:11], v[148:151], v[148:151], a[8:11]
    ds_read_b128 v[140:143], v35 offset:57344
    v_mfma_f32_16x16x32_bf16 a[0:3], v[48:51], v[148:151], a[0:3]
    v_mfma_f32_16x16x32_bf16 a[12:15], v[156:159], v[156:159], a[12:15]
    v_mfma_f32_16x16x32_bf16 a[4:7], v[48:51], v[156:159], a[4:7]
    v_mfma_f32_16x16x32_bf16 v[216:219], v[144:147], v[64:67], v[216:219]
    ds_write_b32 v44, a16 offset:0
    v_mfma_f32_16x16x32_bf16 v[236:239], v[152:155], v[64:67], v[236:239]
    ds_write_b32 v44, a20 offset:256
    v_mfma_f32_16x16x32_bf16 v[220:223], v[144:147], v[68:71], v[220:223]
    ds_write_b32 v44, a24 offset:512
    v_mfma_f32_16x16x32_bf16 v[240:243], v[152:155], v[68:71], v[240:243]
    ds_write_b32 v44, a28 offset:768
    v_mfma_f32_16x16x32_bf16 v[224:227], v[144:147], v[72:75], v[224:227]
    ds_write_b32 v44, a32 offset:1024
    v_mfma_f32_16x16x32_bf16 v[244:247], v[152:155], v[72:75], v[244:247]
    v_mfma_f32_16x16x32_bf16 v[228:231], v[144:147], v[76:79], v[228:231]
    v_mfma_f32_16x16x32_bf16 v[248:251], v[152:155], v[76:79], v[248:251]
    v_mfma_f32_16x16x32_bf16 v[232:235], v[144:147], v[80:83], v[232:235]
    v_mfma_f32_16x16x32_bf16 v[252:255], v[152:155], v[80:83], v[252:255]
    v_mfma_f32_16x16x32_bf16 v[216:219], v[148:151], v[84:87], v[216:219]
    v_mfma_f32_16x16x32_bf16 v[236:239], v[156:159], v[84:87], v[236:239]
    v_mfma_f32_16x16x32_bf16 v[220:223], v[148:151], v[88:91], v[220:223]
    ds_read_b128 v[160:163], v36 offset:36864
    v_mfma_f32_16x16x32_bf16 v[240:243], v[156:159], v[88:91], v[240:243]
    ds_read_b128 v[168:171], v36 offset:37376
    v_mfma_f32_16x16x32_bf16 v[224:227], v[148:151], v[92:95], v[224:227]
    ds_read_b128 v[164:167], v37 offset:36864
    v_mfma_f32_16x16x32_bf16 v[244:247], v[156:159], v[92:95], v[244:247]
    ds_read_b128 v[172:175], v37 offset:37376
    v_mfma_f32_16x16x32_bf16 v[228:231], v[148:151], v[96:99], v[228:231]
    v_mfma_f32_16x16x32_bf16 v[248:251], v[156:159], v[96:99], v[248:251]
    v_mfma_f32_16x16x32_bf16 v[232:235], v[148:151], v[100:103], v[232:235]
    v_mfma_f32_16x16x32_bf16 v[252:255], v[156:159], v[100:103], v[252:255]
    s_waitcnt lgkmcnt(0)
    s_barrier
    v_mfma_f32_16x16x32_bf16 a[8:11], v[160:163], v[160:163], a[8:11]
    ds_read_b128 v[144:147], v45 offset:0
    v_mfma_f32_16x16x32_bf16 a[0:3], v[48:51], v[160:163], a[0:3]
    ds_read_b128 v[148:151], v45 offset:256
    v_mfma_f32_16x16x32_bf16 a[12:15], v[168:171], v[168:171], a[12:15]
    ds_read_b128 v[152:155], v45 offset:512
    v_mfma_f32_16x16x32_bf16 a[4:7], v[48:51], v[168:171], a[4:7]
    ds_read_b128 v[156:159], v45 offset:768
    v_mfma_f32_16x16x32_bf16 a[8:11], v[164:167], v[164:167], a[8:11]
    ds_read_b128 v[96:99], v45 offset:1024
    v_mfma_f32_16x16x32_bf16 a[0:3], v[48:51], v[164:167], a[0:3]
    v_mfma_f32_16x16x32_bf16 a[12:15], v[172:175], v[172:175], a[12:15]
    s_waitcnt lgkmcnt(4)
    v_add_f32 v144, v144, v145
    v_add_f32 v146, v146, v147
    v_add_f32 v144, v144, v146
    v_mfma_f32_16x16x32_bf16 a[4:7], v[48:51], v[172:175], a[4:7]
    s_waitcnt lgkmcnt(3)
    v_add_f32 v148, v148, v149
    v_add_f32 v150, v150, v151
    v_mfma_f32_16x16x32_bf16 v[216:219], v[160:163], v[104:107], v[216:219]
    v_add_f32 v148, v148, v150
    s_waitcnt lgkmcnt(2)
    v_add_f32 v152, v152, v153
    v_add_f32 v154, v154, v155
    v_mfma_f32_16x16x32_bf16 v[236:239], v[168:171], v[104:107], v[236:239]
    v_add_f32 v152, v152, v154
    s_waitcnt lgkmcnt(1)
    v_add_f32 v156, v156, v157
    v_mfma_f32_16x16x32_bf16 v[220:223], v[160:163], v[108:111], v[220:223]
    v_add_f32 v158, v158, v159
    v_add_f32 v156, v156, v158
    s_waitcnt lgkmcnt(0)
    v_add_f32 v96, v96, v97
    v_mfma_f32_16x16x32_bf16 v[240:243], v[168:171], v[108:111], v[240:243]
    v_add_f32 v98, v98, v99
    v_add_f32 v96, v96, v98
    s_nop 1
    v_mfma_f32_16x16x32_bf16 v[224:227], v[160:163], v[112:115], v[224:227]
    v_accvgpr_read_b32 v64, a8
    v_accvgpr_read_b32 v65, a9
    v_accvgpr_read_b32 v66, a10
    v_accvgpr_read_b32 v67, a11
    v_accvgpr_read_b32 v68, a0
    v_mfma_f32_16x16x32_bf16 v[244:247], v[168:171], v[112:115], v[244:247]
    v_accvgpr_read_b32 v70, a12
    v_accvgpr_read_b32 v71, a13
    v_accvgpr_read_b32 v72, a14
    v_accvgpr_read_b32 v73, a15
    v_mfma_f32_16x16x32_bf16 v[228:231], v[160:163], v[116:119], v[228:231]
    v_accvgpr_read_b32 v74, a4
    s_mov_b32 vcc_lo, 0x22222222
    s_mov_b32 vcc_hi, 0x22222222
    v_cndmask_b32 v64, v64, v65, vcc
    v_cndmask_b32 v70, v70, v71, vcc
    v_mfma_f32_16x16x32_bf16 v[248:251], v[168:171], v[116:119], v[248:251]
    s_mov_b32 vcc_lo, 0x44444444
    s_mov_b32 vcc_hi, 0x44444444
    v_cndmask_b32 v64, v64, v66, vcc
    v_cndmask_b32 v70, v70, v72, vcc
    s_mov_b32 vcc_lo, 0x88888888
    s_mov_b32 vcc_hi, 0x88888888
    v_mfma_f32_16x16x32_bf16 v[232:235], v[160:163], v[120:123], v[232:235]
    v_cndmask_b32 v64, v64, v67, vcc
    v_cndmask_b32 v70, v70, v73, vcc
    v_mul_f32 v68, 0x3acccccd, v68
    v_mul_f32 v74, 0x3acccccd, v74
    v_mfma_f32_16x16x32_bf16 v[252:255], v[168:171], v[120:123], v[252:255]
    v_mul_f32 v64, 0x3acccccd, v64
    v_mul_f32 v70, 0x3acccccd, v70
    v_fma_f32 v64, -v68, v68, v64
    v_fma_f32 v70, -v74, v74, v70
    v_max_f32 v64, 0, v64
    v_mfma_f32_16x16x32_bf16 v[216:219], v[164:167], v[124:127], v[216:219]
    v_max_f32 v70, 0, v70
    v_cvt_pk_bf16_f32 v64, v64, v64
    v_cvt_pk_bf16_f32 v70, v70, v70
    v_lshlrev_b32 v64, 16, v64
    v_mfma_f32_16x16x32_bf16 v[236:239], v[172:175], v[124:127], v[236:239]
    v_lshlrev_b32 v70, 16, v70
    v_add_f32 v64, 0x3727c5ac, v64
    v_add_f32 v70, 0x3727c5ac, v70
    v_cvt_pk_bf16_f32 v64, v64, v64
    v_mfma_f32_16x16x32_bf16 v[220:223], v[164:167], v[128:131], v[220:223]
    v_cvt_pk_bf16_f32 v70, v70, v70
    v_lshlrev_b32 v64, 16, v64
    v_lshlrev_b32 v70, 16, v70
    v_sqrt_f32 v64, v64
    v_mfma_f32_16x16x32_bf16 v[240:243], v[172:175], v[128:131], v[240:243]
    v_sqrt_f32 v70, v70
    v_cvt_pk_bf16_f32 v76, v68, v68
    v_cvt_pk_bf16_f32 v77, v74, v74
    v_cvt_pk_bf16_f32 v64, v64, v64
    v_mfma_f32_16x16x32_bf16 v[224:227], v[164:167], v[132:135], v[224:227]
    v_cvt_pk_bf16_f32 v70, v70, v70
    v_lshlrev_b32 v64, 16, v64
    v_lshlrev_b32 v70, 16, v70
    v_rcp_f32 v78, v64
    v_rcp_f32 v79, v70
    v_mfma_f32_16x16x32_bf16 v[244:247], v[172:175], v[132:135], v[244:247]
    v_lshlrev_b32 v76, 16, v76
    v_lshlrev_b32 v77, 16, v77
    v_mul_f32 v78, s12, v78
    v_mul_f32 v79, s12, v79
    v_mfma_f32_16x16x32_bf16 v[228:231], v[164:167], v[136:139], v[228:231]
    ds_bpermute_b32 v80, v43, v76 offset:0
    ds_bpermute_b32 v81, v43, v76 offset:4
    ds_bpermute_b32 v82, v43, v76 offset:8
    ds_bpermute_b32 v83, v43, v76 offset:12
    v_mfma_f32_16x16x32_bf16 v[248:251], v[172:175], v[136:139], v[248:251]
    ds_bpermute_b32 v84, v43, v77 offset:0
    ds_bpermute_b32 v85, v43, v77 offset:4
    ds_bpermute_b32 v86, v43, v77 offset:8
    ds_bpermute_b32 v87, v43, v77 offset:12
    v_mfma_f32_16x16x32_bf16 v[232:235], v[164:167], v[140:143], v[232:235]
    ds_bpermute_b32 v88, v43, v78 offset:0
    ds_bpermute_b32 v89, v43, v78 offset:4
    ds_bpermute_b32 v90, v43, v78 offset:8
    ds_bpermute_b32 v91, v43, v78 offset:12
    v_mfma_f32_16x16x32_bf16 v[252:255], v[172:175], v[140:143], v[252:255]
    ds_bpermute_b32 v92, v43, v79 offset:0
    ds_bpermute_b32 v93, v43, v79 offset:4
    ds_bpermute_b32 v94, v43, v79 offset:8
    ds_bpermute_b32 v95, v43, v79 offset:12
    s_waitcnt lgkmcnt(0)
    v_pk_fma_f32 v[216:217], v[80:81], v[144:145], v[216:217] op_sel_hi:[1,0,1] neg_lo:[1,0,0] neg_hi:[1,0,0]
    v_pk_fma_f32 v[218:219], v[82:83], v[144:145], v[218:219] op_sel_hi:[1,0,1] neg_lo:[1,0,0] neg_hi:[1,0,0]
    v_pk_fma_f32 v[236:237], v[84:85], v[144:145], v[236:237] op_sel_hi:[1,0,1] neg_lo:[1,0,0] neg_hi:[1,0,0]
    v_pk_fma_f32 v[238:239], v[86:87], v[144:145], v[238:239] op_sel_hi:[1,0,1] neg_lo:[1,0,0] neg_hi:[1,0,0]
    v_pk_mul_f32 v[216:217], v[88:89], v[216:217]
    v_pk_mul_f32 v[218:219], v[90:91], v[218:219]
    v_pk_mul_f32 v[236:237], v[92:93], v[236:237]
    v_pk_mul_f32 v[238:239], v[94:95], v[238:239]
    v_cvt_pk_bf16_f32 v104, v216, v217
    v_cvt_pk_bf16_f32 v105, v218, v219
    v_cvt_pk_bf16_f32 v106, v236, v237
    v_cvt_pk_bf16_f32 v107, v238, v239
    s_add_u32 s77, s79, 0
    buffer_store_dwordx4 v[104:107], v17, s[48:51], s77 offen sc1
    v_pk_fma_f32 v[220:221], v[80:81], v[148:149], v[220:221] op_sel_hi:[1,0,1] neg_lo:[1,0,0] neg_hi:[1,0,0]
    v_pk_fma_f32 v[222:223], v[82:83], v[148:149], v[222:223] op_sel_hi:[1,0,1] neg_lo:[1,0,0] neg_hi:[1,0,0]
    v_pk_fma_f32 v[240:241], v[84:85], v[148:149], v[240:241] op_sel_hi:[1,0,1] neg_lo:[1,0,0] neg_hi:[1,0,0]
    v_pk_fma_f32 v[242:243], v[86:87], v[148:149], v[242:243] op_sel_hi:[1,0,1] neg_lo:[1,0,0] neg_hi:[1,0,0]
    v_pk_mul_f32 v[220:221], v[88:89], v[220:221]
    v_pk_mul_f32 v[222:223], v[90:91], v[222:223]
    v_pk_mul_f32 v[240:241], v[92:93], v[240:241]
    v_pk_mul_f32 v[242:243], v[94:95], v[242:243]
    v_cvt_pk_bf16_f32 v108, v220, v221
    v_cvt_pk_bf16_f32 v109, v222, v223
    v_cvt_pk_bf16_f32 v110, v240, v241
    v_cvt_pk_bf16_f32 v111, v242, v243
    s_add_u32 s77, s79, 65536
    buffer_store_dwordx4 v[108:111], v17, s[48:51], s77 offen sc1
    v_pk_fma_f32 v[224:225], v[80:81], v[152:153], v[224:225] op_sel_hi:[1,0,1] neg_lo:[1,0,0] neg_hi:[1,0,0]
    v_pk_fma_f32 v[226:227], v[82:83], v[152:153], v[226:227] op_sel_hi:[1,0,1] neg_lo:[1,0,0] neg_hi:[1,0,0]
    v_pk_fma_f32 v[244:245], v[84:85], v[152:153], v[244:245] op_sel_hi:[1,0,1] neg_lo:[1,0,0] neg_hi:[1,0,0]
    v_pk_fma_f32 v[246:247], v[86:87], v[152:153], v[246:247] op_sel_hi:[1,0,1] neg_lo:[1,0,0] neg_hi:[1,0,0]
    v_pk_mul_f32 v[224:225], v[88:89], v[224:225]
    v_pk_mul_f32 v[226:227], v[90:91], v[226:227]
    v_pk_mul_f32 v[244:245], v[92:93], v[244:245]
    v_pk_mul_f32 v[246:247], v[94:95], v[246:247]
    v_cvt_pk_bf16_f32 v112, v224, v225
    v_cvt_pk_bf16_f32 v113, v226, v227
    v_cvt_pk_bf16_f32 v114, v244, v245
    v_cvt_pk_bf16_f32 v115, v246, v247
    s_add_u32 s77, s79, 131072
    buffer_store_dwordx4 v[112:115], v17, s[48:51], s77 offen sc1
    v_pk_fma_f32 v[228:229], v[80:81], v[156:157], v[228:229] op_sel_hi:[1,0,1] neg_lo:[1,0,0] neg_hi:[1,0,0]
    v_pk_fma_f32 v[230:231], v[82:83], v[156:157], v[230:231] op_sel_hi:[1,0,1] neg_lo:[1,0,0] neg_hi:[1,0,0]
    v_pk_fma_f32 v[248:249], v[84:85], v[156:157], v[248:249] op_sel_hi:[1,0,1] neg_lo:[1,0,0] neg_hi:[1,0,0]
    v_pk_fma_f32 v[250:251], v[86:87], v[156:157], v[250:251] op_sel_hi:[1,0,1] neg_lo:[1,0,0] neg_hi:[1,0,0]
    v_pk_mul_f32 v[228:229], v[88:89], v[228:229]
    v_pk_mul_f32 v[230:231], v[90:91], v[230:231]
    v_pk_mul_f32 v[248:249], v[92:93], v[248:249]
    v_pk_mul_f32 v[250:251], v[94:95], v[250:251]
    v_cvt_pk_bf16_f32 v116, v228, v229
    v_cvt_pk_bf16_f32 v117, v230, v231
    v_cvt_pk_bf16_f32 v118, v248, v249
    v_cvt_pk_bf16_f32 v119, v250, v251
    s_add_u32 s77, s79, 196608
    buffer_store_dwordx4 v[116:119], v17, s[48:51], s77 offen sc1
    v_pk_fma_f32 v[232:233], v[80:81], v[96:97], v[232:233] op_sel_hi:[1,0,1] neg_lo:[1,0,0] neg_hi:[1,0,0]
    v_pk_fma_f32 v[234:235], v[82:83], v[96:97], v[234:235] op_sel_hi:[1,0,1] neg_lo:[1,0,0] neg_hi:[1,0,0]
    v_pk_fma_f32 v[252:253], v[84:85], v[96:97], v[252:253] op_sel_hi:[1,0,1] neg_lo:[1,0,0] neg_hi:[1,0,0]
    v_pk_fma_f32 v[254:255], v[86:87], v[96:97], v[254:255] op_sel_hi:[1,0,1] neg_lo:[1,0,0] neg_hi:[1,0,0]
    v_pk_mul_f32 v[232:233], v[88:89], v[232:233]
    v_pk_mul_f32 v[234:235], v[90:91], v[234:235]
    v_pk_mul_f32 v[252:253], v[92:93], v[252:253]
    v_pk_mul_f32 v[254:255], v[94:95], v[254:255]
    v_cvt_pk_bf16_f32 v120, v232, v233
    v_cvt_pk_bf16_f32 v121, v234, v235
    v_cvt_pk_bf16_f32 v122, v252, v253
    v_cvt_pk_bf16_f32 v123, v254, v255
    s_add_u32 s77, s79, 262144
    buffer_store_dwordx4 v[120:123], v17, s[48:51], s77 offen sc1
    s_add_u32 s76, s3, 128
    s_and_b32 s76, s76, 0x180
    s_or_b32 s76, s76, s6
    s_add_u32 m0, s73, 0
    s_add_u32 s77, s86, s76
    buffer_load_dwordx4 v13, s[44:47], s77 offen lds
    s_add_u32 m0, s73, 1024
    s_nop 0
    buffer_load_dwordx4 v30, s[44:47], s77 offen lds
    s_add_u32 m0, s73, 2048
    s_add_u32 s77, s87, s76
    buffer_load_dwordx4 v13, s[44:47], s77 offen lds
    s_add_u32 m0, s73, 3072
    s_nop 0
    buffer_load_dwordx4 v30, s[44:47], s77 offen lds
    s_add_u32 m0, s73, 4096
    s_add_u32 s77, s88, s76
    buffer_load_dwordx4 v13, s[44:47], s77 offen lds
    s_add_u32 m0, s73, 5120
    s_nop 0
    buffer_load_dwordx4 v30, s[44:47], s77 offen lds
    s_add_u32 m0, s73, 6144
    s_add_u32 s77, s89, s76
    buffer_load_dwordx4 v13, s[44:47], s77 offen lds
    s_add_u32 m0, s73, 7168
    s_nop 0
    buffer_load_dwordx4 v30, s[44:47], s77 offen lds
    s_add_u32 s76, s3, 128
    s_and_b32 s76, s76, 0x180
    s_or_b32 s76, s76, s6
    s_add_u32 m0, s73, 32768
    s_add_u32 s77, s90, s76
    buffer_load_dwordx4 v13, s[44:47], s77 offen lds
    s_add_u32 m0, s73, 33792
    s_nop 0
    buffer_load_dwordx4 v30, s[44:47], s77 offen lds
    s_add_u32 m0, s73, 34816
    s_add_u32 s77, s91, s76
    buffer_load_dwordx4 v13, s[44:47], s77 offen lds
    s_add_u32 m0, s73, 35840
    s_nop 0
    buffer_load_dwordx4 v30, s[44:47], s77 offen lds
    s_add_u32 m0, s73, 36864
    s_add_u32 s77, s92, s76
    buffer_load_dwordx4 v13, s[44:47], s77 offen lds
    s_add_u32 m0, s73, 37888
    s_nop 0
    buffer_load_dwordx4 v30, s[44:47], s77 offen lds
    s_add_u32 m0, s73, 38912
    s_add_u32 s77, s93, s76
    buffer_load_dwordx4 v13, s[44:47], s77 offen lds
    s_add_u32 m0, s73, 39936
    s_nop 0
    buffer_load_dwordx4 v30, s[44:47], s77 offen lds
    s_cmp_eq_u32 s64, 0
    s_cbranch_scc1 kf_pw_k0
    s_cmp_eq_u32 s64, 1
    s_cbranch_scc1 kf_pw_k1
    s_cmp_eq_u32 s64, 2
    s_cbranch_scc1 kf_pw_k2
    s_cmp_eq_u32 s64, 3
    s_cbranch_scc1 kf_pw_k3
kf_pw_k_ret:
    s_waitcnt vmcnt(16)
    v_cmp_ne_u32 vcc, 1511506921, v55
    v_mov_b32 v5, 1
    s_cbranch_vccnz kf_sg_slow
kf_sg_go:
    s_mov_b64 exec, 0xffff
    buffer_store_dword v5, v31, s[48:51], 0 offen sc1
    s_mov_b64 exec, -1
    buffer_load_dwordx2 v[18:19], v16, s[52:55], 0 offen offset:0
    buffer_load_dwordx2 v[20:21], v16, s[52:55], 0 offen offset:32
    buffer_load_dwordx2 v[22:23], v16, s[52:55], 0 offen offset:64
    buffer_load_dwordx2 v[24:25], v16, s[52:55], 0 offen offset:96
    buffer_load_dwordx2 v[26:27], v16, s[52:55], 0 offen offset:128
    ds_read_b128 a[220:223], v28 offset:0
    ds_read_b128 a[224:227], v28 offset:2048
    ds_read_b128 a[228:231], v28 offset:4096
    ds_read_b128 a[232:235], v28 offset:6144
    ds_read_b128 a[236:239], v29 offset:0
    ds_read_b128 a[240:243], v29 offset:2048
    ds_read_b128 a[244:247], v29 offset:4096
    ds_read_b128 a[248:251], v29 offset:6144
    s_waitcnt lgkmcnt(0)
    s_add_u32 s76, s3, 256
    s_and_b32 s76, s76, 0x180
    s_or_b32 s76, s76, s6
    s_add_u32 m0, s73, 65536
    s_add_u32 s77, s86, s76
    buffer_load_dwordx4 v13, s[44:47], s77 offen lds
    s_add_u32 m0, s73, 66560
    s_nop 0
    buffer_load_dwordx4 v30, s[44:47], s77 offen lds
    s_add_u32 m0, s73, 67584
    s_add_u32 s77, s87, s76
    buffer_load_dwordx4 v13, s[44:47], s77 offen lds
    s_add_u32 m0, s73, 68608
    s_nop 0
    buffer_load_dwordx4 v30, s[44:47], s77 offen lds
    s_add_u32 m0, s73, 69632
    s_add_u32 s77, s88, s76
    buffer_load_dwordx4 v13, s[44:47], s77 offen lds
    s_add_u32 m0, s73, 70656
    s_nop 0
    buffer_load_dwordx4 v30, s[44:47], s77 offen lds
    s_add_u32 m0, s73, 71680
    s_add_u32 s77, s89, s76
    buffer_load_dwordx4 v13, s[44:47], s77 offen lds
    s_add_u32 m0, s73, 72704
    s_nop 0
    buffer_load_dwordx4 v30, s[44:47], s77 offen lds
    ds_read_b128 a[188:191], v28 offset:32768
    ds_read_b128 a[192:195], v28 offset:34816
    ds_read_b128 a[196:199], v28 offset:36864
    ds_read_b128 a[200:203], v28 offset:38912
    ds_read_b128 a[204:207], v29 offset:32768
    ds_read_b128 a[208:211], v29 offset:34816
    ds_read_b128 a[212:215], v29 offset:36864
    ds_read_b128 a[216:219], v29 offset:38912
    s_waitcnt lgkmcnt(0)
    s_add_u32 s76, s3, 256
    s_and_b32 s76, s76, 0x180
    s_or_b32 s76, s76, s6
    s_add_u32 m0, s73, 98304
    s_add_u32 s77, s90, s76
    buffer_load_dwordx4 v13, s[44:47], s77 offen lds
    s_add_u32 m0, s73, 99328
    s_nop 0
    buffer_load_dwordx4 v30, s[44:47], s77 offen lds
    s_add_u32 m0, s73, 100352
    s_add_u32 s77, s91, s76
    buffer_load_dwordx4 v13, s[44:47], s77 offen lds
    s_add_u32 m0, s73, 101376
    s_nop 0
    buffer_load_dwordx4 v30, s[44:47], s77 offen lds
    s_add_u32 m0, s73, 102400
    s_add_u32 s77, s92, s76
    buffer_load_dwordx4 v13, s[44:47], s77 offen lds
    s_add_u32 m0, s73, 103424
    s_nop 0
    buffer_load_dwordx4 v30, s[44:47], s77 offen lds
    s_add_u32 m0, s73, 104448
    s_add_u32 s77, s93, s76
    buffer_load_dwordx4 v13, s[44:47], s77 offen lds
    s_add_u32 m0, s73, 105472
    s_nop 0
    buffer_load_dwordx4 v30, s[44:47], s77 offen lds
    s_waitcnt vmcnt(30)
    ds_read_b128 a[156:159], v14 offset:0
    ds_read_b128 a[160:163], v14 offset:2048
    ds_read_b128 a[164:167], v14 offset:4096
    ds_read_b128 a[168:171], v14 offset:6144
    ds_read_b128 a[172:175], v15 offset:0
    ds_read_b128 a[176:179], v15 offset:2048
    ds_read_b128 a[180:183], v15 offset:4096
    ds_read_b128 a[184:187], v15 offset:6144
    s_waitcnt lgkmcnt(0)
    s_add_u32 s76, s3, 384
    s_and_b32 s76, s76, 0x180
    s_or_b32 s76, s76, s6
    s_add_u32 m0, s73, 0
    s_add_u32 s77, s86, s76
    buffer_load_dwordx4 v13, s[44:47], s77 offen lds
    s_add_u32 m0, s73, 1024
    s_nop 0
    buffer_load_dwordx4 v30, s[44:47], s77 offen lds
    s_add_u32 m0, s73, 2048
    s_add_u32 s77, s87, s76
    buffer_load_dwordx4 v13, s[44:47], s77 offen lds
    s_add_u32 m0, s73, 3072
    s_nop 0
    buffer_load_dwordx4 v30, s[44:47], s77 offen lds
    s_add_u32 m0, s73, 4096
    s_add_u32 s77, s88, s76
    buffer_load_dwordx4 v13, s[44:47], s77 offen lds
    s_add_u32 m0, s73, 5120
    s_nop 0
    buffer_load_dwordx4 v30, s[44:47], s77 offen lds
    s_add_u32 m0, s73, 6144
    s_add_u32 s77, s89, s76
    buffer_load_dwordx4 v13, s[44:47], s77 offen lds
    s_add_u32 m0, s73, 7168
    s_nop 0
    buffer_load_dwordx4 v30, s[44:47], s77 offen lds
    s_waitcnt vmcnt(30)
    ds_read_b128 a[124:127], v14 offset:32768
    ds_read_b128 a[128:131], v14 offset:34816
    ds_read_b128 a[132:135], v14 offset:36864
    ds_read_b128 a[136:139], v14 offset:38912
    ds_read_b128 a[140:143], v15 offset:32768
    ds_read_b128 a[144:147], v15 offset:34816
    ds_read_b128 a[148:151], v15 offset:36864
    ds_read_b128 a[152:155], v15 offset:38912
    s_waitcnt lgkmcnt(0)
    s_add_u32 s76, s3, 384
    s_and_b32 s76, s76, 0x180
    s_or_b32 s76, s76, s6
    s_add_u32 m0, s73, 32768
    s_add_u32 s77, s90, s76
    buffer_load_dwordx4 v13, s[44:47], s77 offen lds
    s_add_u32 m0, s73, 33792
    s_nop 0
    buffer_load_dwordx4 v30, s[44:47], s77 offen lds
    s_add_u32 m0, s73, 34816
    s_add_u32 s77, s91, s76
    buffer_load_dwordx4 v13, s[44:47], s77 offen lds
    s_add_u32 m0, s73, 35840
    s_nop 0
    buffer_load_dwordx4 v30, s[44:47], s77 offen lds
    s_add_u32 m0, s73, 36864
    s_add_u32 s77, s92, s76
    buffer_load_dwordx4 v13, s[44:47], s77 offen lds
    s_add_u32 m0, s73, 37888
    s_nop 0
    buffer_load_dwordx4 v30, s[44:47], s77 offen lds
    s_add_u32 m0, s73, 38912
    s_add_u32 s77, s93, s76
    buffer_load_dwordx4 v13, s[44:47], s77 offen lds
    s_add_u32 m0, s73, 39936
    s_nop 0
    buffer_load_dwordx4 v30, s[44:47], s77 offen lds
    s_waitcnt vmcnt(24)
    ds_read_b128 v[152:155], v28 offset:0
    ds_read_b128 v[156:159], v28 offset:2048
    ds_read_b128 v[160:163], v28 offset:4096
    ds_read_b128 v[164:167], v28 offset:6144
    ds_read_b128 v[168:171], v29 offset:0
    ds_read_b128 v[172:175], v29 offset:2048
    ds_read_b128 v[176:179], v29 offset:4096
    ds_read_b128 v[180:183], v29 offset:6144
    s_waitcnt lgkmcnt(0)
    s_add_u32 s76, s3, 0
    s_and_b32 s76, s76, 0x180
    s_or_b32 s76, s76, s9
    s_add_u32 m0, s73, 65536
    s_add_u32 s77, s86, s76
    buffer_load_dwordx4 v13, s[44:47], s77 offen lds
    s_add_u32 m0, s73, 66560
    s_nop 0
    buffer_load_dwordx4 v30, s[44:47], s77 offen lds
    s_add_u32 m0, s73, 67584
    s_add_u32 s77, s87, s76
    buffer_load_dwordx4 v13, s[44:47], s77 offen lds
    s_add_u32 m0, s73, 68608
    s_nop 0
    buffer_load_dwordx4 v30, s[44:47], s77 offen lds
    s_add_u32 m0, s73, 69632
    s_add_u32 s77, s88, s76
    buffer_load_dwordx4 v13, s[44:47], s77 offen lds
    s_add_u32 m0, s73, 70656
    s_nop 0
    buffer_load_dwordx4 v30, s[44:47], s77 offen lds
    s_add_u32 m0, s73, 71680
    s_add_u32 s77, s89, s76
    buffer_load_dwordx4 v13, s[44:47], s77 offen lds
    s_add_u32 m0, s73, 72704
    s_nop 0
    buffer_load_dwordx4 v30, s[44:47], s77 offen lds
    s_waitcnt vmcnt(24)
    ds_read_b128 v[184:187], v28 offset:32768
    ds_read_b128 v[188:191], v28 offset:34816
    ds_read_b128 v[192:195], v28 offset:36864
    ds_read_b128 v[196:199], v28 offset:38912
    ds_read_b128 v[200:203], v29 offset:32768
    ds_read_b128 v[204:207], v29 offset:34816
    ds_read_b128 v[208:211], v29 offset:36864
    ds_read_b128 v[212:215], v29 offset:38912
    s_waitcnt lgkmcnt(0)
    s_load_dwordx16 s[16:31], s[38:39], s95 offset:0 glc
    s_add_u32 s76, s3, 0
    s_and_b32 s76, s76, 0x180
    s_or_b32 s76, s76, s9
    s_add_u32 m0, s73, 98304
    s_add_u32 s77, s90, s76
    buffer_load_dwordx4 v13, s[44:47], s77 offen lds
    s_add_u32 m0, s73, 99328
    s_nop 0
    buffer_load_dwordx4 v30, s[44:47], s77 offen lds
    s_add_u32 m0, s73, 100352
    s_add_u32 s77, s91, s76
    buffer_load_dwordx4 v13, s[44:47], s77 offen lds
    s_add_u32 m0, s73, 101376
    s_nop 0
    buffer_load_dwordx4 v30, s[44:47], s77 offen lds
    s_add_u32 m0, s73, 102400
    s_add_u32 s77, s92, s76
    buffer_load_dwordx4 v13, s[44:47], s77 offen lds
    s_add_u32 m0, s73, 103424
    s_nop 0
    buffer_load_dwordx4 v30, s[44:47], s77 offen lds
    s_add_u32 m0, s73, 104448
    s_add_u32 s77, s93, s76
    buffer_load_dwordx4 v13, s[44:47], s77 offen lds
    s_add_u32 m0, s73, 105472
    s_nop 0
    buffer_load_dwordx4 v30, s[44:47], s77 offen lds
    s_waitcnt lgkmcnt(0)
    s_or_b64 s[16:17], s[16:17], s[18:19]
    s_or_b64 s[20:21], s[20:21], s[22:23]
    s_or_b64 s[24:25], s[24:25], s[26:27]
    s_or_b64 s[28:29], s[28:29], s[30:31]
    s_or_b64 s[16:17], s[16:17], s[20:21]
    s_or_b64 s[24:25], s[24:25], s[28:29]
    s_or_b64 s[16:17], s[16:17], s[24:25]
    s_or_b32 s16, s16, s17
    s_cmp_eq_u32 s16, 1
    s_cbranch_scc1 kf_ab_done
    s_mov_b32 s7, 0
kf_ab_poll:
    s_load_dwordx16 s[16:31], s[38:39], s95 offset:0 glc
    s_waitcnt lgkmcnt(0)
    s_or_b64 s[16:17], s[16:17], s[18:19]
    s_or_b64 s[20:21], s[20:21], s[22:23]
    s_or_b64 s[24:25], s[24:25], s[26:27]
    s_or_b64 s[28:29], s[28:29], s[30:31]
    s_or_b64 s[16:17], s[16:17], s[20:21]
    s_or_b64 s[24:25], s[24:25], s[28:29]
    s_or_b64 s[16:17], s[16:17], s[24:25]
    s_or_b32 s16, s16, s17
    s_cmp_eq_u32 s16, 1
    s_cbranch_scc1 kf_ab_done
    s_add_u32 s7, s7, 1
    s_cmp_lt_u32 s7, 65536
    s_cbranch_scc1 kf_ab_poll
kf_ab_done:
    s_add_u32 s80, s3, 0
    s_and_b32 s80, s80, 0x180
    s_or_b32 s80, s80, s6
    s_lshl_b32 s80, s80, 4
    buffer_load_dwordx4 v[32:35], v8, s[48:51], s80 offen offset:0 sc1
    buffer_load_dwordx4 v[36:39], v9, s[48:51], s80 offen offset:0 sc1
    buffer_load_dwordx4 v[40:43], v10, s[48:51], s80 offen offset:0 sc1
    buffer_load_dwordx4 v[44:47], v11, s[48:51], s80 offen offset:0 sc1
    buffer_load_dwordx4 v[48:51], v12, s[48:51], s80 offen offset:0 sc1
    s_add_u32 s80, s3, 0
    s_and_b32 s80, s80, 0x180
    s_or_b32 s80, s80, s6
    s_lshl_b32 s80, s80, 4
    buffer_load_dwordx4 v[52:55], v8, s[48:51], s80 offen offset:1024 sc1
    buffer_load_dwordx4 v[56:59], v9, s[48:51], s80 offen offset:1024 sc1
    buffer_load_dwordx4 v[60:63], v10, s[48:51], s80 offen offset:1024 sc1
    buffer_load_dwordx4 v[64:67], v11, s[48:51], s80 offen offset:1024 sc1
    buffer_load_dwordx4 v[68:71], v12, s[48:51], s80 offen offset:1024 sc1
    s_add_u32 s80, s3, 128
    s_and_b32 s80, s80, 0x180
    s_or_b32 s80, s80, s6
    s_lshl_b32 s80, s80, 4
    buffer_load_dwordx4 v[72:75], v8, s[48:51], s80 offen offset:0 sc1
    buffer_load_dwordx4 v[76:79], v9, s[48:51], s80 offen offset:0 sc1
    buffer_load_dwordx4 v[80:83], v10, s[48:51], s80 offen offset:0 sc1
    buffer_load_dwordx4 v[84:87], v11, s[48:51], s80 offen offset:0 sc1
    buffer_load_dwordx4 v[88:91], v12, s[48:51], s80 offen offset:0 sc1
    s_add_u32 s80, s3, 128
    s_and_b32 s80, s80, 0x180
    s_or_b32 s80, s80, s6
    s_lshl_b32 s80, s80, 4
    buffer_load_dwordx4 v[92:95], v8, s[48:51], s80 offen offset:1024 sc1
    buffer_load_dwordx4 v[96:99], v9, s[48:51], s80 offen offset:1024 sc1
    buffer_load_dwordx4 v[100:103], v10, s[48:51], s80 offen offset:1024 sc1
    buffer_load_dwordx4 v[104:107], v11, s[48:51], s80 offen offset:1024 sc1
    buffer_load_dwordx4 v[108:111], v12, s[48:51], s80 offen offset:1024 sc1
    s_waitcnt lgkmcnt(0)
    s_waitcnt vmcnt(15)
    v_mfma_f32_16x16x32_bf16 v[216:219], v[32:35], a[220:223], 0
    s_add_u32 s80, s3, 256
    s_and_b32 s80, s80, 0x180
    s_or_b32 s80, s80, s6
    s_lshl_b32 s80, s80, 4
    buffer_load_dwordx4 v[112:115], v8, s[48:51], s80 offen offset:0 sc1
    v_mfma_f32_16x16x32_bf16 a[64:67], v[32:35], a[224:227], 0
    v_mov_b32 v5, s96
    s_mov_b32 exec_lo, 0
    s_mov_b32 exec_hi, 0xffff
    buffer_store_dword v5, v31, s[48:51], 0 offen sc1
    s_mov_b64 exec, -1
    v_mfma_f32_16x16x32_bf16 a[84:87], v[32:35], a[228:231], 0
    v_mfma_f32_16x16x32_bf16 a[104:107], v[32:35], a[232:235], 0
    v_mfma_f32_16x16x32_bf16 v[220:223], v[36:39], a[220:223], 0
    v_mfma_f32_16x16x32_bf16 a[68:71], v[36:39], a[224:227], 0
    v_mfma_f32_16x16x32_bf16 a[88:91], v[36:39], a[228:231], 0
    v_mfma_f32_16x16x32_bf16 a[108:111], v[36:39], a[232:235], 0
    v_mfma_f32_16x16x32_bf16 v[224:227], v[40:43], a[220:223], 0
    buffer_load_dwordx4 v[116:119], v9, s[48:51], s80 offen offset:0 sc1
    v_mfma_f32_16x16x32_bf16 a[72:75], v[40:43], a[224:227], 0
    v_mfma_f32_16x16x32_bf16 a[92:95], v[40:43], a[228:231], 0
    v_mfma_f32_16x16x32_bf16 a[112:115], v[40:43], a[232:235], 0
    v_mfma_f32_16x16x32_bf16 v[228:231], v[44:47], a[220:223], 0
    v_mfma_f32_16x16x32_bf16 a[76:79], v[44:47], a[224:227], 0
    v_mfma_f32_16x16x32_bf16 a[96:99], v[44:47], a[228:231], 0
    v_mfma_f32_16x16x32_bf16 a[116:119], v[44:47], a[232:235], 0
    v_mfma_f32_16x16x32_bf16 v[232:235], v[48:51], a[220:223], 0
    buffer_load_dwordx4 v[120:123], v10, s[48:51], s80 offen offset:0 sc1
    v_mfma_f32_16x16x32_bf16 a[80:83], v[48:51], a[224:227], 0
    v_mfma_f32_16x16x32_bf16 a[100:103], v[48:51], a[228:231], 0
    v_mfma_f32_16x16x32_bf16 a[120:123], v[48:51], a[232:235], 0
    s_waitcnt vmcnt(14)
    v_mfma_f32_16x16x32_bf16 v[216:219], v[52:55], a[236:239], v[216:219]
    v_mfma_f32_16x16x32_bf16 a[64:67], v[52:55], a[240:243], a[64:67]
    v_mfma_f32_16x16x32_bf16 a[84:87], v[52:55], a[244:247], a[84:87]
    v_mfma_f32_16x16x32_bf16 a[104:107], v[52:55], a[248:251], a[104:107]
    v_mfma_f32_16x16x32_bf16 v[220:223], v[56:59], a[236:239], v[220:223]
    buffer_load_dwordx4 v[124:127], v11, s[48:51], s80 offen offset:0 sc1
    v_mfma_f32_16x16x32_bf16 a[68:71], v[56:59], a[240:243], a[68:71]
    v_mfma_f32_16x16x32_bf16 a[88:91], v[56:59], a[244:247], a[88:91]
    v_mfma_f32_16x16x32_bf16 a[108:111], v[56:59], a[248:251], a[108:111]
    v_mfma_f32_16x16x32_bf16 v[224:227], v[60:63], a[236:239], v[224:227]
    v_mfma_f32_16x16x32_bf16 a[72:75], v[60:63], a[240:243], a[72:75]
    v_mfma_f32_16x16x32_bf16 a[92:95], v[60:63], a[244:247], a[92:95]
    v_mfma_f32_16x16x32_bf16 a[112:115], v[60:63], a[248:251], a[112:115]
    v_mfma_f32_16x16x32_bf16 v[228:231], v[64:67], a[236:239], v[228:231]
    buffer_load_dwordx4 v[128:131], v12, s[48:51], s80 offen offset:0 sc1
    v_mfma_f32_16x16x32_bf16 a[76:79], v[64:67], a[240:243], a[76:79]
    v_mfma_f32_16x16x32_bf16 a[96:99], v[64:67], a[244:247], a[96:99]
    v_mfma_f32_16x16x32_bf16 a[116:119], v[64:67], a[248:251], a[116:119]
    v_mfma_f32_16x16x32_bf16 v[232:235], v[68:71], a[236:239], v[232:235]
    v_mfma_f32_16x16x32_bf16 a[80:83], v[68:71], a[240:243], a[80:83]
    v_mfma_f32_16x16x32_bf16 a[100:103], v[68:71], a[244:247], a[100:103]
    v_mfma_f32_16x16x32_bf16 a[120:123], v[68:71], a[248:251], a[120:123]
    s_waitcnt lgkmcnt(0)
    v_mfma_f32_16x16x32_bf16 v[236:239], v[32:35], a[188:191], 0
    s_add_u32 s80, s3, 256
    s_and_b32 s80, s80, 0x180
    s_or_b32 s80, s80, s6
    s_lshl_b32 s80, s80, 4
    buffer_load_dwordx4 v[132:135], v8, s[48:51], s80 offen offset:1024 sc1
    v_mfma_f32_16x16x32_bf16 a[0:3], v[32:35], a[192:195], 0
    v_mfma_f32_16x16x32_bf16 a[20:23], v[32:35], a[196:199], 0
    v_mfma_f32_16x16x32_bf16 a[40:43], v[32:35], a[200:203], 0
    v_mfma_f32_16x16x32_bf16 v[240:243], v[36:39], a[188:191], 0
    v_mfma_f32_16x16x32_bf16 a[4:7], v[36:39], a[192:195], 0
    v_mfma_f32_16x16x32_bf16 a[24:27], v[36:39], a[196:199], 0
    v_mfma_f32_16x16x32_bf16 a[44:47], v[36:39], a[200:203], 0
    v_mfma_f32_16x16x32_bf16 v[244:247], v[40:43], a[188:191], 0
    buffer_load_dwordx4 v[136:139], v9, s[48:51], s80 offen offset:1024 sc1
    v_mfma_f32_16x16x32_bf16 a[8:11], v[40:43], a[192:195], 0
    v_mfma_f32_16x16x32_bf16 a[28:31], v[40:43], a[196:199], 0
    v_mfma_f32_16x16x32_bf16 a[48:51], v[40:43], a[200:203], 0
    v_mfma_f32_16x16x32_bf16 v[248:251], v[44:47], a[188:191], 0
    v_mfma_f32_16x16x32_bf16 a[12:15], v[44:47], a[192:195], 0
    v_mfma_f32_16x16x32_bf16 a[32:35], v[44:47], a[196:199], 0
    s_branch kf_pw_k0_o
kf_pw_k0:
    s_branch kf_pw_k4
kf_pw_k0_o:
    v_mfma_f32_16x16x32_bf16 a[52:55], v[44:47], a[200:203], 0
    v_mfma_f32_16x16x32_bf16 v[252:255], v[48:51], a[188:191], 0
    buffer_load_dwordx4 v[140:143], v10, s[48:51], s80 offen offset:1024 sc1
    v_mfma_f32_16x16x32_bf16 a[16:19], v[48:51], a[192:195], 0
    v_mfma_f32_16x16x32_bf16 a[36:39], v[48:51], a[196:199], 0
    v_mfma_f32_16x16x32_bf16 a[56:59], v[48:51], a[200:203], 0
    v_mfma_f32_16x16x32_bf16 v[236:239], v[52:55], a[204:207], v[236:239]
    ds_read_b128 a[220:223], v14 offset:0
    v_mfma_f32_16x16x32_bf16 a[0:3], v[52:55], a[208:211], a[0:3]
    ds_read_b128 a[224:227], v14 offset:2048
    v_mfma_f32_16x16x32_bf16 a[20:23], v[52:55], a[212:215], a[20:23]
    ds_read_b128 a[228:231], v14 offset:4096
    v_mfma_f32_16x16x32_bf16 a[40:43], v[52:55], a[216:219], a[40:43]
    ds_read_b128 a[232:235], v14 offset:6144
    v_mfma_f32_16x16x32_bf16 v[240:243], v[56:59], a[204:207], v[240:243]
    buffer_load_dwordx4 v[144:147], v11, s[48:51], s80 offen offset:1024 sc1
    v_mfma_f32_16x16x32_bf16 a[4:7], v[56:59], a[208:211], a[4:7]
    ds_read_b128 a[236:239], v15 offset:0
    v_mfma_f32_16x16x32_bf16 a[24:27], v[56:59], a[212:215], a[24:27]
    ds_read_b128 a[240:243], v15 offset:2048
    v_mfma_f32_16x16x32_bf16 a[44:47], v[56:59], a[216:219], a[44:47]
    ds_read_b128 a[244:247], v15 offset:4096
    v_mfma_f32_16x16x32_bf16 v[244:247], v[60:63], a[204:207], v[244:247]
    ds_read_b128 a[248:251], v15 offset:6144
    v_mfma_f32_16x16x32_bf16 a[8:11], v[60:63], a[208:211], a[8:11]
    v_mfma_f32_16x16x32_bf16 a[28:31], v[60:63], a[212:215], a[28:31]
    v_mfma_f32_16x16x32_bf16 a[48:51], v[60:63], a[216:219], a[48:51]
    v_mfma_f32_16x16x32_bf16 v[248:251], v[64:67], a[204:207], v[248:251]
    buffer_load_dwordx4 v[148:151], v12, s[48:51], s80 offen offset:1024 sc1
    v_mfma_f32_16x16x32_bf16 a[12:15], v[64:67], a[208:211], a[12:15]
    v_mfma_f32_16x16x32_bf16 a[32:35], v[64:67], a[212:215], a[32:35]
    v_mfma_f32_16x16x32_bf16 a[52:55], v[64:67], a[216:219], a[52:55]
    v_mfma_f32_16x16x32_bf16 v[252:255], v[68:71], a[204:207], v[252:255]
    v_mfma_f32_16x16x32_bf16 a[16:19], v[68:71], a[208:211], a[16:19]
    v_mfma_f32_16x16x32_bf16 a[36:39], v[68:71], a[212:215], a[36:39]
    v_mfma_f32_16x16x32_bf16 a[56:59], v[68:71], a[216:219], a[56:59]
    s_waitcnt lgkmcnt(0)
    s_waitcnt vmcnt(16)
    v_mfma_f32_16x16x32_bf16 v[216:219], v[72:75], a[156:159], v[216:219]
    s_add_u32 s80, s3, 384
    s_and_b32 s80, s80, 0x180
    s_or_b32 s80, s80, s6
    s_lshl_b32 s80, s80, 4
    buffer_load_dwordx4 v[32:35], v8, s[48:51], s80 offen offset:0 sc1
    v_mfma_f32_16x16x32_bf16 a[64:67], v[72:75], a[160:163], a[64:67]
    v_mfma_f32_16x16x32_bf16 a[84:87], v[72:75], a[164:167], a[84:87]
    v_mfma_f32_16x16x32_bf16 a[104:107], v[72:75], a[168:171], a[104:107]
    v_mfma_f32_16x16x32_bf16 v[220:223], v[76:79], a[156:159], v[220:223]
    buffer_load_dwordx4 v[36:39], v9, s[48:51], s80 offen offset:0 sc1
    v_mfma_f32_16x16x32_bf16 a[68:71], v[76:79], a[160:163], a[68:71]
    v_mfma_f32_16x16x32_bf16 a[88:91], v[76:79], a[164:167], a[88:91]
    v_mfma_f32_16x16x32_bf16 a[108:111], v[76:79], a[168:171], a[108:111]
    v_mfma_f32_16x16x32_bf16 v[224:227], v[80:83], a[156:159], v[224:227]
    buffer_load_dwordx4 v[40:43], v10, s[48:51], s80 offen offset:0 sc1
    v_mfma_f32_16x16x32_bf16 a[72:75], v[80:83], a[160:163], a[72:75]
    v_mfma_f32_16x16x32_bf16 a[92:95], v[80:83], a[164:167], a[92:95]
    v_mfma_f32_16x16x32_bf16 a[112:115], v[80:83], a[168:171], a[112:115]
    v_mfma_f32_16x16x32_bf16 v[228:231], v[84:87], a[156:159], v[228:231]
    v_mfma_f32_16x16x32_bf16 a[76:79], v[84:87], a[160:163], a[76:79]
    buffer_load_dwordx4 v[44:47], v11, s[48:51], s80 offen offset:0 sc1
    v_mfma_f32_16x16x32_bf16 a[96:99], v[84:87], a[164:167], a[96:99]
    v_mfma_f32_16x16x32_bf16 a[116:119], v[84:87], a[168:171], a[116:119]
    v_mfma_f32_16x16x32_bf16 v[232:235], v[88:91], a[156:159], v[232:235]
    v_mfma_f32_16x16x32_bf16 a[80:83], v[88:91], a[160:163], a[80:83]
    buffer_load_dwordx4 v[48:51], v12, s[48:51], s80 offen offset:0 sc1
    v_mfma_f32_16x16x32_bf16 a[100:103], v[88:91], a[164:167], a[100:103]
    v_mfma_f32_16x16x32_bf16 a[120:123], v[88:91], a[168:171], a[120:123]
    s_waitcnt vmcnt(16)
    v_mfma_f32_16x16x32_bf16 v[216:219], v[92:95], a[172:175], v[216:219]
    v_mfma_f32_16x16x32_bf16 a[64:67], v[92:95], a[176:179], a[64:67]
    v_mfma_f32_16x16x32_bf16 a[84:87], v[92:95], a[180:183], a[84:87]
    s_add_u32 s76, s3, 128
    s_and_b32 s76, s76, 0x180
    s_or_b32 s76, s76, s9
    s_add_u32 m0, s73, 0
    s_add_u32 s77, s86, s76
    buffer_load_dwordx4 v13, s[44:47], s77 offen lds
    v_mfma_f32_16x16x32_bf16 a[104:107], v[92:95], a[184:187], a[104:107]
    v_mfma_f32_16x16x32_bf16 v[220:223], v[96:99], a[172:175], v[220:223]
    v_mfma_f32_16x16x32_bf16 a[68:71], v[96:99], a[176:179], a[68:71]
    v_mfma_f32_16x16x32_bf16 a[88:91], v[96:99], a[180:183], a[88:91]
    s_add_u32 m0, s73, 1024
    s_nop 0
    buffer_load_dwordx4 v30, s[44:47], s77 offen lds
    v_mfma_f32_16x16x32_bf16 a[108:111], v[96:99], a[184:187], a[108:111]
    v_mfma_f32_16x16x32_bf16 v[224:227], v[100:103], a[172:175], v[224:227]
    v_mfma_f32_16x16x32_bf16 a[72:75], v[100:103], a[176:179], a[72:75]
    v_mfma_f32_16x16x32_bf16 a[92:95], v[100:103], a[180:183], a[92:95]
    v_mfma_f32_16x16x32_bf16 a[112:115], v[100:103], a[184:187], a[112:115]
    s_add_u32 m0, s73, 2048
    s_add_u32 s77, s87, s76
    buffer_load_dwordx4 v13, s[44:47], s77 offen lds
    v_mfma_f32_16x16x32_bf16 v[228:231], v[104:107], a[172:175], v[228:231]
    v_mfma_f32_16x16x32_bf16 a[76:79], v[104:107], a[176:179], a[76:79]
    v_mfma_f32_16x16x32_bf16 a[96:99], v[104:107], a[180:183], a[96:99]
    v_mfma_f32_16x16x32_bf16 a[116:119], v[104:107], a[184:187], a[116:119]
    s_add_u32 m0, s73, 3072
    s_nop 0
    buffer_load_dwordx4 v30, s[44:47], s77 offen lds
    v_mfma_f32_16x16x32_bf16 v[232:235], v[108:111], a[172:175], v[232:235]
    v_mfma_f32_16x16x32_bf16 a[80:83], v[108:111], a[176:179], a[80:83]
    v_mfma_f32_16x16x32_bf16 a[100:103], v[108:111], a[180:183], a[100:103]
    v_mfma_f32_16x16x32_bf16 a[120:123], v[108:111], a[184:187], a[120:123]
    s_waitcnt lgkmcnt(0)
    v_mfma_f32_16x16x32_bf16 v[236:239], v[72:75], a[124:127], v[236:239]
    s_add_u32 s80, s3, 384
    s_and_b32 s80, s80, 0x180
    s_or_b32 s80, s80, s6
    s_lshl_b32 s80, s80, 4
    buffer_load_dwordx4 v[52:55], v8, s[48:51], s80 offen offset:1024 sc1
    v_mfma_f32_16x16x32_bf16 a[0:3], v[72:75], a[128:131], a[0:3]
    v_mfma_f32_16x16x32_bf16 a[20:23], v[72:75], a[132:135], a[20:23]
    v_mfma_f32_16x16x32_bf16 a[40:43], v[72:75], a[136:139], a[40:43]
    v_mfma_f32_16x16x32_bf16 v[240:243], v[76:79], a[124:127], v[240:243]
    buffer_load_dwordx4 v[56:59], v9, s[48:51], s80 offen offset:1024 sc1
    v_mfma_f32_16x16x32_bf16 a[4:7], v[76:79], a[128:131], a[4:7]
    v_mfma_f32_16x16x32_bf16 a[24:27], v[76:79], a[132:135], a[24:27]
    v_mfma_f32_16x16x32_bf16 a[44:47], v[76:79], a[136:139], a[44:47]
    v_mfma_f32_16x16x32_bf16 v[244:247], v[80:83], a[124:127], v[244:247]
    buffer_load_dwordx4 v[60:63], v10, s[48:51], s80 offen offset:1024 sc1
    v_mfma_f32_16x16x32_bf16 a[8:11], v[80:83], a[128:131], a[8:11]
    v_mfma_f32_16x16x32_bf16 a[28:31], v[80:83], a[132:135], a[28:31]
    v_mfma_f32_16x16x32_bf16 a[48:51], v[80:83], a[136:139], a[48:51]
    v_mfma_f32_16x16x32_bf16 v[248:251], v[84:87], a[124:127], v[248:251]
    v_mfma_f32_16x16x32_bf16 a[12:15], v[84:87], a[128:131], a[12:15]
    buffer_load_dwordx4 v[64:67], v11, s[48:51], s80 offen offset:1024 sc1
    v_mfma_f32_16x16x32_bf16 a[32:35], v[84:87], a[132:135], a[32:35]
    v_mfma_f32_16x16x32_bf16 a[52:55], v[84:87], a[136:139], a[52:55]
    v_mfma_f32_16x16x32_bf16 v[252:255], v[88:91], a[124:127], v[252:255]
    v_mfma_f32_16x16x32_bf16 a[16:19], v[88:91], a[128:131], a[16:19]
    buffer_load_dwordx4 v[68:71], v12, s[48:51], s80 offen offset:1024 sc1
    v_mfma_f32_16x16x32_bf16 a[36:39], v[88:91], a[132:135], a[36:39]
    v_mfma_f32_16x16x32_bf16 a[56:59], v[88:91], a[136:139], a[56:59]
    v_mfma_f32_16x16x32_bf16 v[236:239], v[92:95], a[140:143], v[236:239]
    ds_read_b128 a[188:191], v14 offset:32768
    v_mfma_f32_16x16x32_bf16 a[0:3], v[92:95], a[144:147], a[0:3]
    ds_read_b128 a[192:195], v14 offset:34816
    v_mfma_f32_16x16x32_bf16 a[20:23], v[92:95], a[148:151], a[20:23]
    s_add_u32 s76, s3, 128
    s_and_b32 s76, s76, 0x180
    s_or_b32 s76, s76, s9
    s_add_u32 m0, s73, 4096
    s_add_u32 s77, s88, s76
    buffer_load_dwordx4 v13, s[44:47], s77 offen lds
    v_mfma_f32_16x16x32_bf16 a[40:43], v[92:95], a[152:155], a[40:43]
    ds_read_b128 a[196:199], v14 offset:36864
    v_mfma_f32_16x16x32_bf16 v[240:243], v[96:99], a[140:143], v[240:243]
    ds_read_b128 a[200:203], v14 offset:38912
    v_mfma_f32_16x16x32_bf16 a[4:7], v[96:99], a[144:147], a[4:7]
    ds_read_b128 a[204:207], v15 offset:32768
    v_mfma_f32_16x16x32_bf16 a[24:27], v[96:99], a[148:151], a[24:27]
    s_add_u32 m0, s73, 5120
    s_nop 0
    buffer_load_dwordx4 v30, s[44:47], s77 offen lds
    v_mfma_f32_16x16x32_bf16 a[44:47], v[96:99], a[152:155], a[44:47]
    ds_read_b128 a[208:211], v15 offset:34816
    v_mfma_f32_16x16x32_bf16 v[244:247], v[100:103], a[140:143], v[244:247]
    ds_read_b128 a[212:215], v15 offset:36864
    v_mfma_f32_16x16x32_bf16 a[8:11], v[100:103], a[144:147], a[8:11]
    ds_read_b128 a[216:219], v15 offset:38912
    v_mfma_f32_16x16x32_bf16 a[28:31], v[100:103], a[148:151], a[28:31]
    v_mfma_f32_16x16x32_bf16 a[48:51], v[100:103], a[152:155], a[48:51]
    s_add_u32 m0, s73, 6144
    s_add_u32 s77, s89, s76
    buffer_load_dwordx4 v13, s[44:47], s77 offen lds
    v_mfma_f32_16x16x32_bf16 v[248:251], v[104:107], a[140:143], v[248:251]
    v_mfma_f32_16x16x32_bf16 a[12:15], v[104:107], a[144:147], a[12:15]
    v_mfma_f32_16x16x32_bf16 a[32:35], v[104:107], a[148:151], a[32:35]
    v_mfma_f32_16x16x32_bf16 a[52:55], v[104:107], a[152:155], a[52:55]
    s_add_u32 m0, s73, 7168
    s_nop 0
    buffer_load_dwordx4 v30, s[44:47], s77 offen lds
    v_mfma_f32_16x16x32_bf16 v[252:255], v[108:111], a[140:143], v[252:255]
    v_mfma_f32_16x16x32_bf16 a[16:19], v[108:111], a[144:147], a[16:19]
    v_mfma_f32_16x16x32_bf16 a[36:39], v[108:111], a[148:151], a[36:39]
    v_mfma_f32_16x16x32_bf16 a[56:59], v[108:111], a[152:155], a[56:59]
    s_waitcnt lgkmcnt(0)
    s_waitcnt vmcnt(23)
    v_mfma_f32_16x16x32_bf16 v[216:219], v[112:115], v[152:155], v[216:219]
    s_add_u32 s80, s3, 0
    s_and_b32 s80, s80, 0x180
    s_or_b32 s80, s80, s9
    s_lshl_b32 s80, s80, 4
    buffer_load_dwordx4 v[72:75], v8, s[48:51], s80 offen offset:0 sc1
    v_mfma_f32_16x16x32_bf16 a[64:67], v[112:115], v[156:159], a[64:67]
    v_mfma_f32_16x16x32_bf16 a[84:87], v[112:115], v[160:163], a[84:87]
    v_mfma_f32_16x16x32_bf16 a[104:107], v[112:115], v[164:167], a[104:107]
    v_mfma_f32_16x16x32_bf16 v[220:223], v[116:119], v[152:155], v[220:223]
    buffer_load_dwordx4 v[76:79], v9, s[48:51], s80 offen offset:0 sc1
    v_mfma_f32_16x16x32_bf16 a[68:71], v[116:119], v[156:159], a[68:71]
    v_mfma_f32_16x16x32_bf16 a[88:91], v[116:119], v[160:163], a[88:91]
    v_mfma_f32_16x16x32_bf16 a[108:111], v[116:119], v[164:167], a[108:111]
    v_mfma_f32_16x16x32_bf16 v[224:227], v[120:123], v[152:155], v[224:227]
    buffer_load_dwordx4 v[80:83], v10, s[48:51], s80 offen offset:0 sc1
    v_mfma_f32_16x16x32_bf16 a[72:75], v[120:123], v[156:159], a[72:75]
    v_mfma_f32_16x16x32_bf16 a[92:95], v[120:123], v[160:163], a[92:95]
    v_mfma_f32_16x16x32_bf16 a[112:115], v[120:123], v[164:167], a[112:115]
    v_mfma_f32_16x16x32_bf16 v[228:231], v[124:127], v[152:155], v[228:231]
    v_mfma_f32_16x16x32_bf16 a[76:79], v[124:127], v[156:159], a[76:79]
    buffer_load_dwordx4 v[84:87], v11, s[48:51], s80 offen offset:0 sc1
    v_mfma_f32_16x16x32_bf16 a[96:99], v[124:127], v[160:163], a[96:99]
    v_mfma_f32_16x16x32_bf16 a[116:119], v[124:127], v[164:167], a[116:119]
    v_mfma_f32_16x16x32_bf16 v[232:235], v[128:131], v[152:155], v[232:235]
    v_mfma_f32_16x16x32_bf16 a[80:83], v[128:131], v[156:159], a[80:83]
    buffer_load_dwordx4 v[88:91], v12, s[48:51], s80 offen offset:0 sc1
    v_mfma_f32_16x16x32_bf16 a[100:103], v[128:131], v[160:163], a[100:103]
    v_mfma_f32_16x16x32_bf16 a[120:123], v[128:131], v[164:167], a[120:123]
    s_waitcnt vmcnt(23)
    v_mfma_f32_16x16x32_bf16 v[216:219], v[132:135], v[168:171], v[216:219]
    v_mfma_f32_16x16x32_bf16 a[64:67], v[132:135], v[172:175], a[64:67]
    v_mfma_f32_16x16x32_bf16 a[84:87], v[132:135], v[176:179], a[84:87]
    s_add_u32 s76, s3, 256
    s_and_b32 s76, s76, 0x180
    s_or_b32 s76, s76, s9
    s_add_u32 m0, s73, 32768
    s_add_u32 s77, s86, s76
    buffer_load_dwordx4 v13, s[44:47], s77 offen lds
    v_mfma_f32_16x16x32_bf16 a[104:107], v[132:135], v[180:183], a[104:107]
    v_mfma_f32_16x16x32_bf16 v[220:223], v[136:139], v[168:171], v[220:223]
    v_mfma_f32_16x16x32_bf16 a[68:71], v[136:139], v[172:175], a[68:71]
    v_mfma_f32_16x16x32_bf16 a[88:91], v[136:139], v[176:179], a[88:91]
    s_add_u32 m0, s73, 33792
    s_nop 0
    buffer_load_dwordx4 v30, s[44:47], s77 offen lds
    v_mfma_f32_16x16x32_bf16 a[108:111], v[136:139], v[180:183], a[108:111]
    v_mfma_f32_16x16x32_bf16 v[224:227], v[140:143], v[168:171], v[224:227]
    v_mfma_f32_16x16x32_bf16 a[72:75], v[140:143], v[172:175], a[72:75]
    v_mfma_f32_16x16x32_bf16 a[92:95], v[140:143], v[176:179], a[92:95]
    v_mfma_f32_16x16x32_bf16 a[112:115], v[140:143], v[180:183], a[112:115]
    s_add_u32 m0, s73, 34816
    s_add_u32 s77, s87, s76
    buffer_load_dwordx4 v13, s[44:47], s77 offen lds
    v_mfma_f32_16x16x32_bf16 v[228:231], v[144:147], v[168:171], v[228:231]
    v_mfma_f32_16x16x32_bf16 a[76:79], v[144:147], v[172:175], a[76:79]
    v_mfma_f32_16x16x32_bf16 a[96:99], v[144:147], v[176:179], a[96:99]
    v_mfma_f32_16x16x32_bf16 a[116:119], v[144:147], v[180:183], a[116:119]
    s_add_u32 m0, s73, 35840
    s_nop 0
    buffer_load_dwordx4 v30, s[44:47], s77 offen lds
    v_mfma_f32_16x16x32_bf16 v[232:235], v[148:151], v[168:171], v[232:235]
    v_mfma_f32_16x16x32_bf16 a[80:83], v[148:151], v[172:175], a[80:83]
    v_mfma_f32_16x16x32_bf16 a[100:103], v[148:151], v[176:179], a[100:103]
    v_mfma_f32_16x16x32_bf16 a[120:123], v[148:151], v[180:183], a[120:123]
    s_waitcnt lgkmcnt(0)
    v_mfma_f32_16x16x32_bf16 v[236:239], v[112:115], v[184:187], v[236:239]
    s_add_u32 s80, s3, 0
    s_and_b32 s80, s80, 0x180
    s_or_b32 s80, s80, s9
    s_lshl_b32 s80, s80, 4
    buffer_load_dwordx4 v[92:95], v8, s[48:51], s80 offen offset:1024 sc1
    v_mfma_f32_16x16x32_bf16 a[0:3], v[112:115], v[188:191], a[0:3]
    v_mfma_f32_16x16x32_bf16 a[20:23], v[112:115], v[192:195], a[20:23]
    v_mfma_f32_16x16x32_bf16 a[40:43], v[112:115], v[196:199], a[40:43]
    v_mfma_f32_16x16x32_bf16 v[240:243], v[116:119], v[184:187], v[240:243]
    buffer_load_dwordx4 v[96:99], v9, s[48:51], s80 offen offset:1024 sc1
    v_mfma_f32_16x16x32_bf16 a[4:7], v[116:119], v[188:191], a[4:7]
    v_mfma_f32_16x16x32_bf16 a[24:27], v[116:119], v[192:195], a[24:27]
    v_mfma_f32_16x16x32_bf16 a[44:47], v[116:119], v[196:199], a[44:47]
    v_mfma_f32_16x16x32_bf16 v[244:247], v[120:123], v[184:187], v[244:247]
    buffer_load_dwordx4 v[100:103], v10, s[48:51], s80 offen offset:1024 sc1
    v_mfma_f32_16x16x32_bf16 a[8:11], v[120:123], v[188:191], a[8:11]
    v_mfma_f32_16x16x32_bf16 a[28:31], v[120:123], v[192:195], a[28:31]
    v_mfma_f32_16x16x32_bf16 a[48:51], v[120:123], v[196:199], a[48:51]
    v_mfma_f32_16x16x32_bf16 v[248:251], v[124:127], v[184:187], v[248:251]
    v_mfma_f32_16x16x32_bf16 a[12:15], v[124:127], v[188:191], a[12:15]
    buffer_load_dwordx4 v[104:107], v11, s[48:51], s80 offen offset:1024 sc1
    v_mfma_f32_16x16x32_bf16 a[32:35], v[124:127], v[192:195], a[32:35]
    v_mfma_f32_16x16x32_bf16 a[52:55], v[124:127], v[196:199], a[52:55]
    v_mfma_f32_16x16x32_bf16 v[252:255], v[128:131], v[184:187], v[252:255]
    v_mfma_f32_16x16x32_bf16 a[16:19], v[128:131], v[188:191], a[16:19]
    buffer_load_dwordx4 v[108:111], v12, s[48:51], s80 offen offset:1024 sc1
    v_mfma_f32_16x16x32_bf16 a[36:39], v[128:131], v[192:195], a[36:39]
    v_mfma_f32_16x16x32_bf16 a[56:59], v[128:131], v[196:199], a[56:59]
    v_mfma_f32_16x16x32_bf16 v[236:239], v[132:135], v[200:203], v[236:239]
    ds_read_b128 v[152:155], v28 offset:0
    v_mfma_f32_16x16x32_bf16 a[0:3], v[132:135], v[204:207], a[0:3]
    ds_read_b128 v[156:159], v28 offset:2048
    v_mfma_f32_16x16x32_bf16 a[20:23], v[132:135], v[208:211], a[20:23]
    s_add_u32 s76, s3, 256
    s_and_b32 s76, s76, 0x180
    s_or_b32 s76, s76, s9
    s_add_u32 m0, s73, 36864
    s_add_u32 s77, s88, s76
    buffer_load_dwordx4 v13, s[44:47], s77 offen lds
    v_mfma_f32_16x16x32_bf16 a[40:43], v[132:135], v[212:215], a[40:43]
    ds_read_b128 v[160:163], v28 offset:4096
    v_mfma_f32_16x16x32_bf16 v[240:243], v[136:139], v[200:203], v[240:243]
    ds_read_b128 v[164:167], v28 offset:6144
    v_mfma_f32_16x16x32_bf16 a[4:7], v[136:139], v[204:207], a[4:7]
    ds_read_b128 v[168:171], v29 offset:0
    v_mfma_f32_16x16x32_bf16 a[24:27], v[136:139], v[208:211], a[24:27]
    s_add_u32 m0, s73, 37888
    s_nop 0
    buffer_load_dwordx4 v30, s[44:47], s77 offen lds
    v_mfma_f32_16x16x32_bf16 a[44:47], v[136:139], v[212:215], a[44:47]
    ds_read_b128 v[172:175], v29 offset:2048
    v_mfma_f32_16x16x32_bf16 v[244:247], v[140:143], v[200:203], v[244:247]
    ds_read_b128 v[176:179], v29 offset:4096
    v_mfma_f32_16x16x32_bf16 a[8:11], v[140:143], v[204:207], a[8:11]
    ds_read_b128 v[180:183], v29 offset:6144
    v_mfma_f32_16x16x32_bf16 a[28:31], v[140:143], v[208:211], a[28:31]
    v_mfma_f32_16x16x32_bf16 a[48:51], v[140:143], v[212:215], a[48:51]
    s_add_u32 m0, s73, 38912
    s_add_u32 s77, s89, s76
    buffer_load_dwordx4 v13, s[44:47], s77 offen lds
    v_mfma_f32_16x16x32_bf16 v[248:251], v[144:147], v[200:203], v[248:251]
    v_mfma_f32_16x16x32_bf16 a[12:15], v[144:147], v[204:207], a[12:15]
    v_mfma_f32_16x16x32_bf16 a[32:35], v[144:147], v[208:211], a[32:35]
    v_mfma_f32_16x16x32_bf16 a[52:55], v[144:147], v[212:215], a[52:55]
    s_add_u32 m0, s73, 39936
    s_nop 0
    buffer_load_dwordx4 v30, s[44:47], s77 offen lds
    v_mfma_f32_16x16x32_bf16 v[252:255], v[148:151], v[200:203], v[252:255]
    v_mfma_f32_16x16x32_bf16 a[16:19], v[148:151], v[204:207], a[16:19]
    v_mfma_f32_16x16x32_bf16 a[36:39], v[148:151], v[208:211], a[36:39]
    v_mfma_f32_16x16x32_bf16 a[56:59], v[148:151], v[212:215], a[56:59]
    s_waitcnt lgkmcnt(0)
    s_waitcnt vmcnt(31)
    v_mfma_f32_16x16x32_bf16 v[216:219], v[32:35], a[220:223], v[216:219]
    s_add_u32 s80, s3, 128
    s_and_b32 s80, s80, 0x180
    s_or_b32 s80, s80, s9
    s_lshl_b32 s80, s80, 4
    buffer_load_dwordx4 v[112:115], v8, s[48:51], s80 offen offset:0 sc1
    v_mfma_f32_16x16x32_bf16 a[64:67], v[32:35], a[224:227], a[64:67]
    v_mfma_f32_16x16x32_bf16 a[84:87], v[32:35], a[228:231], a[84:87]
    v_mfma_f32_16x16x32_bf16 a[104:107], v[32:35], a[232:235], a[104:107]
    v_mfma_f32_16x16x32_bf16 v[220:223], v[36:39], a[220:223], v[220:223]
    buffer_load_dwordx4 v[116:119], v9, s[48:51], s80 offen offset:0 sc1
    v_mfma_f32_16x16x32_bf16 a[68:71], v[36:39], a[224:227], a[68:71]
    v_mfma_f32_16x16x32_bf16 a[88:91], v[36:39], a[228:231], a[88:91]
    v_mfma_f32_16x16x32_bf16 a[108:111], v[36:39], a[232:235], a[108:111]
    v_mfma_f32_16x16x32_bf16 v[224:227], v[40:43], a[220:223], v[224:227]
    buffer_load_dwordx4 v[120:123], v10, s[48:51], s80 offen offset:0 sc1
    v_mfma_f32_16x16x32_bf16 a[72:75], v[40:43], a[224:227], a[72:75]
    v_mfma_f32_16x16x32_bf16 a[92:95], v[40:43], a[228:231], a[92:95]
    v_mfma_f32_16x16x32_bf16 a[112:115], v[40:43], a[232:235], a[112:115]
    v_mfma_f32_16x16x32_bf16 v[228:231], v[44:47], a[220:223], v[228:231]
    v_mfma_f32_16x16x32_bf16 a[76:79], v[44:47], a[224:227], a[76:79]
    buffer_load_dwordx4 v[124:127], v11, s[48:51], s80 offen offset:0 sc1
    v_mfma_f32_16x16x32_bf16 a[96:99], v[44:47], a[228:231], a[96:99]
    v_mfma_f32_16x16x32_bf16 a[116:119], v[44:47], a[232:235], a[116:119]
    v_mfma_f32_16x16x32_bf16 v[232:235], v[48:51], a[220:223], v[232:235]
    v_mfma_f32_16x16x32_bf16 a[80:83], v[48:51], a[224:227], a[80:83]
    buffer_load_dwordx4 v[128:131], v12, s[48:51], s80 offen offset:0 sc1
    v_mfma_f32_16x16x32_bf16 a[100:103], v[48:51], a[228:231], a[100:103]
    v_mfma_f32_16x16x32_bf16 a[120:123], v[48:51], a[232:235], a[120:123]
    s_waitcnt vmcnt(27)
    v_mfma_f32_16x16x32_bf16 v[216:219], v[52:55], a[236:239], v[216:219]
    v_mfma_f32_16x16x32_bf16 a[64:67], v[52:55], a[240:243], a[64:67]
    v_mfma_f32_16x16x32_bf16 a[84:87], v[52:55], a[244:247], a[84:87]
    s_add_u32 s76, s3, 384
    s_and_b32 s76, s76, 0x180
    s_or_b32 s76, s76, s9
    s_add_u32 m0, s73, 65536
    s_add_u32 s77, s86, s76
    buffer_load_dwordx4 v13, s[44:47], s77 offen lds
    v_mfma_f32_16x16x32_bf16 a[104:107], v[52:55], a[248:251], a[104:107]
    v_mfma_f32_16x16x32_bf16 v[220:223], v[56:59], a[236:239], v[220:223]
    v_mfma_f32_16x16x32_bf16 a[68:71], v[56:59], a[240:243], a[68:71]
    v_mfma_f32_16x16x32_bf16 a[88:91], v[56:59], a[244:247], a[88:91]
    s_add_u32 m0, s73, 66560
    s_nop 0
    buffer_load_dwordx4 v30, s[44:47], s77 offen lds
    v_mfma_f32_16x16x32_bf16 a[108:111], v[56:59], a[248:251], a[108:111]
    v_mfma_f32_16x16x32_bf16 v[224:227], v[60:63], a[236:239], v[224:227]
    v_mfma_f32_16x16x32_bf16 a[72:75], v[60:63], a[240:243], a[72:75]
    v_mfma_f32_16x16x32_bf16 a[92:95], v[60:63], a[244:247], a[92:95]
    v_mfma_f32_16x16x32_bf16 a[112:115], v[60:63], a[248:251], a[112:115]
    s_add_u32 m0, s73, 67584
    s_add_u32 s77, s87, s76
    buffer_load_dwordx4 v13, s[44:47], s77 offen lds
    v_mfma_f32_16x16x32_bf16 v[228:231], v[64:67], a[236:239], v[228:231]
    v_mfma_f32_16x16x32_bf16 a[76:79], v[64:67], a[240:243], a[76:79]
    v_mfma_f32_16x16x32_bf16 a[96:99], v[64:67], a[244:247], a[96:99]
    v_mfma_f32_16x16x32_bf16 a[116:119], v[64:67], a[248:251], a[116:119]
    s_add_u32 m0, s73, 68608
    s_nop 0
    buffer_load_dwordx4 v30, s[44:47], s77 offen lds
    v_mfma_f32_16x16x32_bf16 v[232:235], v[68:71], a[236:239], v[232:235]
    v_mfma_f32_16x16x32_bf16 a[80:83], v[68:71], a[240:243], a[80:83]
    v_mfma_f32_16x16x32_bf16 a[100:103], v[68:71], a[244:247], a[100:103]
    v_mfma_f32_16x16x32_bf16 a[120:123], v[68:71], a[248:251], a[120:123]
    s_waitcnt lgkmcnt(0)
    v_mfma_f32_16x16x32_bf16 v[236:239], v[32:35], a[188:191], v[236:239]
    s_add_u32 s80, s3, 128
    s_and_b32 s80, s80, 0x180
    s_or_b32 s80, s80, s9
    s_lshl_b32 s80, s80, 4
    buffer_load_dwordx4 v[132:135], v8, s[48:51], s80 offen offset:1024 sc1
    v_mfma_f32_16x16x32_bf16 a[0:3], v[32:35], a[192:195], a[0:3]
    v_mfma_f32_16x16x32_bf16 a[20:23], v[32:35], a[196:199], a[20:23]
    v_mfma_f32_16x16x32_bf16 a[40:43], v[32:35], a[200:203], a[40:43]
    v_mfma_f32_16x16x32_bf16 v[240:243], v[36:39], a[188:191], v[240:243]
    buffer_load_dwordx4 v[136:139], v9, s[48:51], s80 offen offset:1024 sc1
    v_mfma_f32_16x16x32_bf16 a[4:7], v[36:39], a[192:195], a[4:7]
    v_mfma_f32_16x16x32_bf16 a[24:27], v[36:39], a[196:199], a[24:27]
    v_mfma_f32_16x16x32_bf16 a[44:47], v[36:39], a[200:203], a[44:47]
    v_mfma_f32_16x16x32_bf16 v[244:247], v[40:43], a[188:191], v[244:247]
    buffer_load_dwordx4 v[140:143], v10, s[48:51], s80 offen offset:1024 sc1
    v_mfma_f32_16x16x32_bf16 a[8:11], v[40:43], a[192:195], a[8:11]
    v_mfma_f32_16x16x32_bf16 a[28:31], v[40:43], a[196:199], a[28:31]
    v_mfma_f32_16x16x32_bf16 a[48:51], v[40:43], a[200:203], a[48:51]
    v_mfma_f32_16x16x32_bf16 v[248:251], v[44:47], a[188:191], v[248:251]
    v_mfma_f32_16x16x32_bf16 a[12:15], v[44:47], a[192:195], a[12:15]
    buffer_load_dwordx4 v[144:147], v11, s[48:51], s80 offen offset:1024 sc1
    v_mfma_f32_16x16x32_bf16 a[32:35], v[44:47], a[196:199], a[32:35]
    v_mfma_f32_16x16x32_bf16 a[52:55], v[44:47], a[200:203], a[52:55]
    v_mfma_f32_16x16x32_bf16 v[252:255], v[48:51], a[188:191], v[252:255]
    v_mfma_f32_16x16x32_bf16 a[16:19], v[48:51], a[192:195], a[16:19]
    buffer_load_dwordx4 v[148:151], v12, s[48:51], s80 offen offset:1024 sc1
    v_mfma_f32_16x16x32_bf16 a[36:39], v[48:51], a[196:199], a[36:39]
    v_mfma_f32_16x16x32_bf16 a[56:59], v[48:51], a[200:203], a[56:59]
    v_mfma_f32_16x16x32_bf16 v[236:239], v[52:55], a[204:207], v[236:239]
    ds_read_b128 v[184:187], v28 offset:32768
    v_mfma_f32_16x16x32_bf16 a[0:3], v[52:55], a[208:211], a[0:3]
    ds_read_b128 v[188:191], v28 offset:34816
    v_mfma_f32_16x16x32_bf16 a[20:23], v[52:55], a[212:215], a[20:23]
    s_add_u32 s76, s3, 384
    s_and_b32 s76, s76, 0x180
    s_or_b32 s76, s76, s9
    s_add_u32 m0, s73, 69632
    s_add_u32 s77, s88, s76
    buffer_load_dwordx4 v13, s[44:47], s77 offen lds
    v_mfma_f32_16x16x32_bf16 a[40:43], v[52:55], a[216:219], a[40:43]
    ds_read_b128 v[192:195], v28 offset:36864
    v_mfma_f32_16x16x32_bf16 v[240:243], v[56:59], a[204:207], v[240:243]
    ds_read_b128 v[196:199], v28 offset:38912
    v_mfma_f32_16x16x32_bf16 a[4:7], v[56:59], a[208:211], a[4:7]
    ds_read_b128 v[200:203], v29 offset:32768
    v_mfma_f32_16x16x32_bf16 a[24:27], v[56:59], a[212:215], a[24:27]
    s_add_u32 m0, s73, 70656
    s_nop 0
    buffer_load_dwordx4 v30, s[44:47], s77 offen lds
    v_mfma_f32_16x16x32_bf16 a[44:47], v[56:59], a[216:219], a[44:47]
    ds_read_b128 v[204:207], v29 offset:34816
    v_mfma_f32_16x16x32_bf16 v[244:247], v[60:63], a[204:207], v[244:247]
    ds_read_b128 v[208:211], v29 offset:36864
    v_mfma_f32_16x16x32_bf16 a[8:11], v[60:63], a[208:211], a[8:11]
    ds_read_b128 v[212:215], v29 offset:38912
    v_mfma_f32_16x16x32_bf16 a[28:31], v[60:63], a[212:215], a[28:31]
    v_mfma_f32_16x16x32_bf16 a[48:51], v[60:63], a[216:219], a[48:51]
    s_add_u32 m0, s73, 71680
    s_add_u32 s77, s89, s76
    buffer_load_dwordx4 v13, s[44:47], s77 offen lds
    v_mfma_f32_16x16x32_bf16 v[248:251], v[64:67], a[204:207], v[248:251]
    v_mfma_f32_16x16x32_bf16 a[12:15], v[64:67], a[208:211], a[12:15]
    v_mfma_f32_16x16x32_bf16 a[32:35], v[64:67], a[212:215], a[32:35]
    v_mfma_f32_16x16x32_bf16 a[52:55], v[64:67], a[216:219], a[52:55]
    s_add_u32 m0, s73, 72704
    s_nop 0
    buffer_load_dwordx4 v30, s[44:47], s77 offen lds
    v_mfma_f32_16x16x32_bf16 v[252:255], v[68:71], a[204:207], v[252:255]
    v_mfma_f32_16x16x32_bf16 a[16:19], v[68:71], a[208:211], a[16:19]
    v_mfma_f32_16x16x32_bf16 a[36:39], v[68:71], a[212:215], a[36:39]
    v_mfma_f32_16x16x32_bf16 a[56:59], v[68:71], a[216:219], a[56:59]
    s_waitcnt lgkmcnt(0)
    s_waitcnt vmcnt(31)
    v_mfma_f32_16x16x32_bf16 v[216:219], v[72:75], v[152:155], v[216:219]
    s_add_u32 s80, s3, 256
    s_and_b32 s80, s80, 0x180
    s_or_b32 s80, s80, s9
    s_lshl_b32 s80, s80, 4
    buffer_load_dwordx4 v[32:35], v8, s[48:51], s80 offen offset:0 sc1
    v_mfma_f32_16x16x32_bf16 a[64:67], v[72:75], v[156:159], a[64:67]
    v_mfma_f32_16x16x32_bf16 a[84:87], v[72:75], v[160:163], a[84:87]
    v_mfma_f32_16x16x32_bf16 a[104:107], v[72:75], v[164:167], a[104:107]
    v_mfma_f32_16x16x32_bf16 v[220:223], v[76:79], v[152:155], v[220:223]
    buffer_load_dwordx4 v[36:39], v9, s[48:51], s80 offen offset:0 sc1
    v_mfma_f32_16x16x32_bf16 a[68:71], v[76:79], v[156:159], a[68:71]
    v_mfma_f32_16x16x32_bf16 a[88:91], v[76:79], v[160:163], a[88:91]
    v_mfma_f32_16x16x32_bf16 a[108:111], v[76:79], v[164:167], a[108:111]
    v_mfma_f32_16x16x32_bf16 v[224:227], v[80:83], v[152:155], v[224:227]
    buffer_load_dwordx4 v[40:43], v10, s[48:51], s80 offen offset:0 sc1
    v_mfma_f32_16x16x32_bf16 a[72:75], v[80:83], v[156:159], a[72:75]
    v_mfma_f32_16x16x32_bf16 a[92:95], v[80:83], v[160:163], a[92:95]
    v_mfma_f32_16x16x32_bf16 a[112:115], v[80:83], v[164:167], a[112:115]
    v_mfma_f32_16x16x32_bf16 v[228:231], v[84:87], v[152:155], v[228:231]
    v_mfma_f32_16x16x32_bf16 a[76:79], v[84:87], v[156:159], a[76:79]
    buffer_load_dwordx4 v[44:47], v11, s[48:51], s80 offen offset:0 sc1
    v_mfma_f32_16x16x32_bf16 a[96:99], v[84:87], v[160:163], a[96:99]
    v_mfma_f32_16x16x32_bf16 a[116:119], v[84:87], v[164:167], a[116:119]
    v_mfma_f32_16x16x32_bf16 v[232:235], v[88:91], v[152:155], v[232:235]
    v_mfma_f32_16x16x32_bf16 a[80:83], v[88:91], v[156:159], a[80:83]
    buffer_load_dwordx4 v[48:51], v12, s[48:51], s80 offen offset:0 sc1
    v_mfma_f32_16x16x32_bf16 a[100:103], v[88:91], v[160:163], a[100:103]
    v_mfma_f32_16x16x32_bf16 a[120:123], v[88:91], v[164:167], a[120:123]
    s_waitcnt vmcnt(27)
    v_mfma_f32_16x16x32_bf16 v[216:219], v[92:95], v[168:171], v[216:219]
    v_mfma_f32_16x16x32_bf16 a[64:67], v[92:95], v[172:175], a[64:67]
    v_mfma_f32_16x16x32_bf16 a[84:87], v[92:95], v[176:179], a[84:87]
    s_add_u32 s76, s3, 128
    s_and_b32 s76, s76, 0x180
    s_or_b32 s76, s76, s9
    s_add_u32 m0, s73, 98304
    s_add_u32 s77, s90, s76
    buffer_load_dwordx4 v13, s[44:47], s77 offen lds
    v_mfma_f32_16x16x32_bf16 a[104:107], v[92:95], v[180:183], a[104:107]
    v_mfma_f32_16x16x32_bf16 v[220:223], v[96:99], v[168:171], v[220:223]
    v_mfma_f32_16x16x32_bf16 a[68:71], v[96:99], v[172:175], a[68:71]
    v_mfma_f32_16x16x32_bf16 a[88:91], v[96:99], v[176:179], a[88:91]
    s_add_u32 m0, s73, 99328
    s_nop 0
    buffer_load_dwordx4 v30, s[44:47], s77 offen lds
    v_mfma_f32_16x16x32_bf16 a[108:111], v[96:99], v[180:183], a[108:111]
    v_mfma_f32_16x16x32_bf16 v[224:227], v[100:103], v[168:171], v[224:227]
    v_mfma_f32_16x16x32_bf16 a[72:75], v[100:103], v[172:175], a[72:75]
    v_mfma_f32_16x16x32_bf16 a[92:95], v[100:103], v[176:179], a[92:95]
    v_mfma_f32_16x16x32_bf16 a[112:115], v[100:103], v[180:183], a[112:115]
    s_add_u32 m0, s73, 100352
    s_add_u32 s77, s91, s76
    buffer_load_dwordx4 v13, s[44:47], s77 offen lds
    v_mfma_f32_16x16x32_bf16 v[228:231], v[104:107], v[168:171], v[228:231]
    v_mfma_f32_16x16x32_bf16 a[76:79], v[104:107], v[172:175], a[76:79]
    v_mfma_f32_16x16x32_bf16 a[96:99], v[104:107], v[176:179], a[96:99]
    v_mfma_f32_16x16x32_bf16 a[116:119], v[104:107], v[180:183], a[116:119]
    s_add_u32 m0, s73, 101376
    s_nop 0
    buffer_load_dwordx4 v30, s[44:47], s77 offen lds
    v_mfma_f32_16x16x32_bf16 v[232:235], v[108:111], v[168:171], v[232:235]
    v_mfma_f32_16x16x32_bf16 a[80:83], v[108:111], v[172:175], a[80:83]
    v_mfma_f32_16x16x32_bf16 a[100:103], v[108:111], v[176:179], a[100:103]
    v_mfma_f32_16x16x32_bf16 a[120:123], v[108:111], v[180:183], a[120:123]
    s_waitcnt lgkmcnt(0)
    v_mfma_f32_16x16x32_bf16 v[236:239], v[72:75], v[184:187], v[236:239]
    s_add_u32 s80, s3, 256
    s_and_b32 s80, s80, 0x180
    s_or_b32 s80, s80, s9
    s_lshl_b32 s80, s80, 4
    buffer_load_dwordx4 v[52:55], v8, s[48:51], s80 offen offset:1024 sc1
    v_mfma_f32_16x16x32_bf16 a[0:3], v[72:75], v[188:191], a[0:3]
    v_mfma_f32_16x16x32_bf16 a[20:23], v[72:75], v[192:195], a[20:23]
    v_mfma_f32_16x16x32_bf16 a[40:43], v[72:75], v[196:199], a[40:43]
    v_mfma_f32_16x16x32_bf16 v[240:243], v[76:79], v[184:187], v[240:243]
    buffer_load_dwordx4 v[56:59], v9, s[48:51], s80 offen offset:1024 sc1
    v_mfma_f32_16x16x32_bf16 a[4:7], v[76:79], v[188:191], a[4:7]
    v_mfma_f32_16x16x32_bf16 a[24:27], v[76:79], v[192:195], a[24:27]
    v_mfma_f32_16x16x32_bf16 a[44:47], v[76:79], v[196:199], a[44:47]
    v_mfma_f32_16x16x32_bf16 v[244:247], v[80:83], v[184:187], v[244:247]
    buffer_load_dwordx4 v[60:63], v10, s[48:51], s80 offen offset:1024 sc1
    v_mfma_f32_16x16x32_bf16 a[8:11], v[80:83], v[188:191], a[8:11]
    v_mfma_f32_16x16x32_bf16 a[28:31], v[80:83], v[192:195], a[28:31]
    v_mfma_f32_16x16x32_bf16 a[48:51], v[80:83], v[196:199], a[48:51]
    v_mfma_f32_16x16x32_bf16 v[248:251], v[84:87], v[184:187], v[248:251]
    v_mfma_f32_16x16x32_bf16 a[12:15], v[84:87], v[188:191], a[12:15]
    buffer_load_dwordx4 v[64:67], v11, s[48:51], s80 offen offset:1024 sc1
    v_mfma_f32_16x16x32_bf16 a[32:35], v[84:87], v[192:195], a[32:35]
    s_branch kf_pw_k1_o
kf_pw_k1:
    s_branch kf_pw_k5
kf_pw_k1_o:
    v_mfma_f32_16x16x32_bf16 a[52:55], v[84:87], v[196:199], a[52:55]
    v_mfma_f32_16x16x32_bf16 v[252:255], v[88:91], v[184:187], v[252:255]
    v_mfma_f32_16x16x32_bf16 a[16:19], v[88:91], v[188:191], a[16:19]
    buffer_load_dwordx4 v[68:71], v12, s[48:51], s80 offen offset:1024 sc1
    v_mfma_f32_16x16x32_bf16 a[36:39], v[88:91], v[192:195], a[36:39]
    v_mfma_f32_16x16x32_bf16 a[56:59], v[88:91], v[196:199], a[56:59]
    v_mfma_f32_16x16x32_bf16 v[236:239], v[92:95], v[200:203], v[236:239]
    ds_read_b128 v[152:155], v14 offset:0
    v_mfma_f32_16x16x32_bf16 a[0:3], v[92:95], v[204:207], a[0:3]
    ds_read_b128 v[156:159], v14 offset:2048
    v_mfma_f32_16x16x32_bf16 a[20:23], v[92:95], v[208:211], a[20:23]
    s_add_u32 s76, s3, 128
    s_and_b32 s76, s76, 0x180
    s_or_b32 s76, s76, s9
    s_add_u32 m0, s73, 102400
    s_add_u32 s77, s92, s76
    buffer_load_dwordx4 v13, s[44:47], s77 offen lds
    v_mfma_f32_16x16x32_bf16 a[40:43], v[92:95], v[212:215], a[40:43]
    ds_read_b128 v[160:163], v14 offset:4096
    v_mfma_f32_16x16x32_bf16 v[240:243], v[96:99], v[200:203], v[240:243]
    ds_read_b128 v[164:167], v14 offset:6144
    v_mfma_f32_16x16x32_bf16 a[4:7], v[96:99], v[204:207], a[4:7]
    ds_read_b128 v[168:171], v15 offset:0
    v_mfma_f32_16x16x32_bf16 a[24:27], v[96:99], v[208:211], a[24:27]
    s_add_u32 m0, s73, 103424
    s_nop 0
    buffer_load_dwordx4 v30, s[44:47], s77 offen lds
    v_mfma_f32_16x16x32_bf16 a[44:47], v[96:99], v[212:215], a[44:47]
    ds_read_b128 v[172:175], v15 offset:2048
    v_mfma_f32_16x16x32_bf16 v[244:247], v[100:103], v[200:203], v[244:247]
    ds_read_b128 v[176:179], v15 offset:4096
    v_mfma_f32_16x16x32_bf16 a[8:11], v[100:103], v[204:207], a[8:11]
    ds_read_b128 v[180:183], v15 offset:6144
    v_mfma_f32_16x16x32_bf16 a[28:31], v[100:103], v[208:211], a[28:31]
    v_mfma_f32_16x16x32_bf16 a[48:51], v[100:103], v[212:215], a[48:51]
    s_add_u32 m0, s73, 104448
    s_add_u32 s77, s93, s76
    buffer_load_dwordx4 v13, s[44:47], s77 offen lds
    v_mfma_f32_16x16x32_bf16 v[248:251], v[104:107], v[200:203], v[248:251]
    v_mfma_f32_16x16x32_bf16 a[12:15], v[104:107], v[204:207], a[12:15]
    v_mfma_f32_16x16x32_bf16 a[32:35], v[104:107], v[208:211], a[32:35]
    v_mfma_f32_16x16x32_bf16 a[52:55], v[104:107], v[212:215], a[52:55]
    s_add_u32 m0, s73, 105472
    s_nop 0
    buffer_load_dwordx4 v30, s[44:47], s77 offen lds
    v_mfma_f32_16x16x32_bf16 v[252:255], v[108:111], v[200:203], v[252:255]
    v_mfma_f32_16x16x32_bf16 a[16:19], v[108:111], v[204:207], a[16:19]
    v_mfma_f32_16x16x32_bf16 a[36:39], v[108:111], v[208:211], a[36:39]
    v_mfma_f32_16x16x32_bf16 a[56:59], v[108:111], v[212:215], a[56:59]
    s_waitcnt lgkmcnt(0)
    s_waitcnt vmcnt(31)
    v_mfma_f32_16x16x32_bf16 v[216:219], v[112:115], v[152:155], v[216:219]
    s_add_u32 s80, s3, 384
    s_and_b32 s80, s80, 0x180
    s_or_b32 s80, s80, s9
    s_lshl_b32 s80, s80, 4
    buffer_load_dwordx4 v[72:75], v8, s[48:51], s80 offen offset:0 sc1
    v_mfma_f32_16x16x32_bf16 a[64:67], v[112:115], v[156:159], a[64:67]
    buffer_load_dword v31, v0, s[48:51], s94 offen offset:512 sc1
    v_mfma_f32_16x16x32_bf16 a[84:87], v[112:115], v[160:163], a[84:87]
    v_mfma_f32_16x16x32_bf16 a[104:107], v[112:115], v[164:167], a[104:107]
    v_mfma_f32_16x16x32_bf16 v[220:223], v[116:119], v[152:155], v[220:223]
    buffer_load_dwordx4 v[76:79], v9, s[48:51], s80 offen offset:0 sc1
    v_mfma_f32_16x16x32_bf16 a[68:71], v[116:119], v[156:159], a[68:71]
    v_mfma_f32_16x16x32_bf16 a[88:91], v[116:119], v[160:163], a[88:91]
    v_mfma_f32_16x16x32_bf16 a[108:111], v[116:119], v[164:167], a[108:111]
    v_mfma_f32_16x16x32_bf16 v[224:227], v[120:123], v[152:155], v[224:227]
    buffer_load_dwordx4 v[80:83], v10, s[48:51], s80 offen offset:0 sc1
    v_mfma_f32_16x16x32_bf16 a[72:75], v[120:123], v[156:159], a[72:75]
    v_mfma_f32_16x16x32_bf16 a[92:95], v[120:123], v[160:163], a[92:95]
    v_mfma_f32_16x16x32_bf16 a[112:115], v[120:123], v[164:167], a[112:115]
    v_mfma_f32_16x16x32_bf16 v[228:231], v[124:127], v[152:155], v[228:231]
    buffer_load_dwordx4 v[84:87], v11, s[48:51], s80 offen offset:0 sc1
    v_mfma_f32_16x16x32_bf16 a[76:79], v[124:127], v[156:159], a[76:79]
    v_mfma_f32_16x16x32_bf16 a[96:99], v[124:127], v[160:163], a[96:99]
    v_mfma_f32_16x16x32_bf16 a[116:119], v[124:127], v[164:167], a[116:119]
    v_mfma_f32_16x16x32_bf16 v[232:235], v[128:131], v[152:155], v[232:235]
    buffer_load_dwordx4 v[88:91], v12, s[48:51], s80 offen offset:0 sc1
    v_mfma_f32_16x16x32_bf16 a[80:83], v[128:131], v[156:159], a[80:83]
    v_mfma_f32_16x16x32_bf16 a[100:103], v[128:131], v[160:163], a[100:103]
    v_mfma_f32_16x16x32_bf16 a[120:123], v[128:131], v[164:167], a[120:123]
    s_waitcnt vmcnt(28)
    v_mfma_f32_16x16x32_bf16 v[216:219], v[132:135], v[168:171], v[216:219]
    s_add_u32 s80, s3, 384
    s_and_b32 s80, s80, 0x180
    s_or_b32 s80, s80, s9
    s_lshl_b32 s80, s80, 4
    buffer_load_dwordx4 v[92:95], v8, s[48:51], s80 offen offset:1024 sc1
    v_mfma_f32_16x16x32_bf16 a[64:67], v[132:135], v[172:175], a[64:67]
    ds_read_b128 v[184:187], v14 offset:32768
    v_mfma_f32_16x16x32_bf16 a[84:87], v[132:135], v[176:179], a[84:87]
    ds_read_b128 v[188:191], v14 offset:34816
    v_mfma_f32_16x16x32_bf16 a[104:107], v[132:135], v[180:183], a[104:107]
    ds_read_b128 v[192:195], v14 offset:36864
    v_mfma_f32_16x16x32_bf16 v[220:223], v[136:139], v[168:171], v[220:223]
    buffer_load_dwordx4 v[96:99], v9, s[48:51], s80 offen offset:1024 sc1
    v_mfma_f32_16x16x32_bf16 a[68:71], v[136:139], v[172:175], a[68:71]
    ds_read_b128 v[196:199], v14 offset:38912
    v_mfma_f32_16x16x32_bf16 a[88:91], v[136:139], v[176:179], a[88:91]
    ds_read_b128 v[200:203], v15 offset:32768
    v_mfma_f32_16x16x32_bf16 a[108:111], v[136:139], v[180:183], a[108:111]
    ds_read_b128 v[204:207], v15 offset:34816
    v_mfma_f32_16x16x32_bf16 v[224:227], v[140:143], v[168:171], v[224:227]
    buffer_load_dwordx4 v[100:103], v10, s[48:51], s80 offen offset:1024 sc1
    v_mfma_f32_16x16x32_bf16 a[72:75], v[140:143], v[172:175], a[72:75]
    ds_read_b128 v[208:211], v15 offset:36864
    v_mfma_f32_16x16x32_bf16 a[92:95], v[140:143], v[176:179], a[92:95]
    ds_read_b128 v[212:215], v15 offset:38912
    v_mfma_f32_16x16x32_bf16 a[112:115], v[140:143], v[180:183], a[112:115]
    v_mfma_f32_16x16x32_bf16 v[228:231], v[144:147], v[168:171], v[228:231]
    buffer_load_dwordx4 v[104:107], v11, s[48:51], s80 offen offset:1024 sc1
    v_mfma_f32_16x16x32_bf16 a[76:79], v[144:147], v[172:175], a[76:79]
    v_mfma_f32_16x16x32_bf16 a[96:99], v[144:147], v[176:179], a[96:99]
    v_mfma_f32_16x16x32_bf16 a[116:119], v[144:147], v[180:183], a[116:119]
    v_mfma_f32_16x16x32_bf16 v[232:235], v[148:151], v[168:171], v[232:235]
    buffer_load_dwordx4 v[108:111], v12, s[48:51], s80 offen offset:1024 sc1
    v_mfma_f32_16x16x32_bf16 a[80:83], v[148:151], v[172:175], a[80:83]
    v_mfma_f32_16x16x32_bf16 a[100:103], v[148:151], v[176:179], a[100:103]
    v_mfma_f32_16x16x32_bf16 a[120:123], v[148:151], v[180:183], a[120:123]
    s_waitcnt lgkmcnt(0)
    s_waitcnt vmcnt(24)
    v_mfma_f32_16x16x32_bf16 v[216:219], v[32:35], v[184:187], v[216:219]
    s_add_u32 s76, s3, 256
    s_and_b32 s76, s76, 0x180
    s_or_b32 s76, s76, s9
    s_add_u32 m0, s73, 0
    s_add_u32 s77, s90, s76
    buffer_load_dwordx4 v13, s[44:47], s77 offen lds
    v_mfma_f32_16x16x32_bf16 a[64:67], v[32:35], v[188:191], a[64:67]
    v_mfma_f32_16x16x32_bf16 a[84:87], v[32:35], v[192:195], a[84:87]
    v_mfma_f32_16x16x32_bf16 a[104:107], v[32:35], v[196:199], a[104:107]
    v_mfma_f32_16x16x32_bf16 v[220:223], v[36:39], v[184:187], v[220:223]
    v_mfma_f32_16x16x32_bf16 a[68:71], v[36:39], v[188:191], a[68:71]
    s_add_u32 m0, s73, 1024
    s_nop 0
    buffer_load_dwordx4 v30, s[44:47], s77 offen lds
    v_mfma_f32_16x16x32_bf16 a[88:91], v[36:39], v[192:195], a[88:91]
    v_mfma_f32_16x16x32_bf16 a[108:111], v[36:39], v[196:199], a[108:111]
    v_mfma_f32_16x16x32_bf16 v[224:227], v[40:43], v[184:187], v[224:227]
    v_mfma_f32_16x16x32_bf16 a[72:75], v[40:43], v[188:191], a[72:75]
    v_mfma_f32_16x16x32_bf16 a[92:95], v[40:43], v[192:195], a[92:95]
    s_add_u32 m0, s73, 2048
    s_add_u32 s77, s91, s76
    buffer_load_dwordx4 v13, s[44:47], s77 offen lds
    v_mfma_f32_16x16x32_bf16 a[112:115], v[40:43], v[196:199], a[112:115]
    v_mfma_f32_16x16x32_bf16 v[228:231], v[44:47], v[184:187], v[228:231]
    v_mfma_f32_16x16x32_bf16 a[76:79], v[44:47], v[188:191], a[76:79]
    v_mfma_f32_16x16x32_bf16 a[96:99], v[44:47], v[192:195], a[96:99]
    v_mfma_f32_16x16x32_bf16 a[116:119], v[44:47], v[196:199], a[116:119]
    s_add_u32 m0, s73, 3072
    s_nop 0
    buffer_load_dwordx4 v30, s[44:47], s77 offen lds
    v_mfma_f32_16x16x32_bf16 v[232:235], v[48:51], v[184:187], v[232:235]
    v_mfma_f32_16x16x32_bf16 a[80:83], v[48:51], v[188:191], a[80:83]
    v_mfma_f32_16x16x32_bf16 a[100:103], v[48:51], v[192:195], a[100:103]
    v_mfma_f32_16x16x32_bf16 a[120:123], v[48:51], v[196:199], a[120:123]
    s_waitcnt vmcnt(19)
    v_mfma_f32_16x16x32_bf16 v[216:219], v[52:55], v[200:203], v[216:219]
    s_add_u32 m0, s73, 4096
    s_add_u32 s77, s92, s76
    buffer_load_dwordx4 v13, s[44:47], s77 offen lds
    v_mfma_f32_16x16x32_bf16 a[64:67], v[52:55], v[204:207], a[64:67]
    ds_read_b128 v[152:155], v28 offset:0
    v_mfma_f32_16x16x32_bf16 a[84:87], v[52:55], v[208:211], a[84:87]
    ds_read_b128 v[156:159], v28 offset:2048
    v_mfma_f32_16x16x32_bf16 a[104:107], v[52:55], v[212:215], a[104:107]
    ds_read_b128 v[160:163], v28 offset:4096
    v_mfma_f32_16x16x32_bf16 v[220:223], v[56:59], v[200:203], v[220:223]
    ds_read_b128 v[164:167], v28 offset:6144
    v_mfma_f32_16x16x32_bf16 a[68:71], v[56:59], v[204:207], a[68:71]
    s_add_u32 m0, s73, 5120
    s_nop 0
    buffer_load_dwordx4 v30, s[44:47], s77 offen lds
    v_mfma_f32_16x16x32_bf16 a[88:91], v[56:59], v[208:211], a[88:91]
    ds_read_b128 v[168:171], v29 offset:0
    v_mfma_f32_16x16x32_bf16 a[108:111], v[56:59], v[212:215], a[108:111]
    ds_read_b128 v[172:175], v29 offset:2048
    v_mfma_f32_16x16x32_bf16 v[224:227], v[60:63], v[200:203], v[224:227]
    ds_read_b128 v[176:179], v29 offset:4096
    v_mfma_f32_16x16x32_bf16 a[72:75], v[60:63], v[204:207], a[72:75]
    ds_read_b128 v[180:183], v29 offset:6144
    v_mfma_f32_16x16x32_bf16 a[92:95], v[60:63], v[208:211], a[92:95]
    s_add_u32 m0, s73, 6144
    s_add_u32 s77, s93, s76
    buffer_load_dwordx4 v13, s[44:47], s77 offen lds
    v_mfma_f32_16x16x32_bf16 a[112:115], v[60:63], v[212:215], a[112:115]
    v_mfma_f32_16x16x32_bf16 v[228:231], v[64:67], v[200:203], v[228:231]
    v_mfma_f32_16x16x32_bf16 a[76:79], v[64:67], v[204:207], a[76:79]
    v_mfma_f32_16x16x32_bf16 a[96:99], v[64:67], v[208:211], a[96:99]
    v_mfma_f32_16x16x32_bf16 a[116:119], v[64:67], v[212:215], a[116:119]
    s_add_u32 m0, s73, 7168
    s_nop 0
    buffer_load_dwordx4 v30, s[44:47], s77 offen lds
    v_mfma_f32_16x16x32_bf16 v[232:235], v[68:71], v[200:203], v[232:235]
    v_mfma_f32_16x16x32_bf16 a[80:83], v[68:71], v[204:207], a[80:83]
    v_mfma_f32_16x16x32_bf16 a[100:103], v[68:71], v[208:211], a[100:103]
    v_mfma_f32_16x16x32_bf16 a[120:123], v[68:71], v[212:215], a[120:123]
    s_waitcnt lgkmcnt(0)
    s_waitcnt vmcnt(13)
    v_mfma_f32_16x16x32_bf16 v[216:219], v[72:75], v[152:155], v[216:219]
    s_add_u32 s76, s3, 384
    s_and_b32 s76, s76, 0x180
    s_or_b32 s76, s76, s9
    s_add_u32 m0, s73, 32768
    s_add_u32 s77, s90, s76
    buffer_load_dwordx4 v13, s[44:47], s77 offen lds
    v_mfma_f32_16x16x32_bf16 a[64:67], v[72:75], v[156:159], a[64:67]
    s_add_u32 s75, s73, 0x10000
    v_add_u32 v8, s75, v17
    v_mfma_f32_16x16x32_bf16 a[84:87], v[72:75], v[160:163], a[84:87]
    s_sub_u32 s75, s64, 1
    s_and_b32 s75, s75, 3
    s_or_b32 s75, s75, 8
    v_mfma_f32_16x16x32_bf16 a[104:107], v[72:75], v[164:167], a[104:107]
    s_lshl_b32 s75, s75, 13
    v_add_u32 v9, s75, v17
    v_mfma_f32_16x16x32_bf16 v[220:223], v[76:79], v[152:155], v[220:223]
    s_sub_u32 s75, s64, 2
    s_and_b32 s75, s75, 3
    s_or_b32 s75, s75, 8
    v_mfma_f32_16x16x32_bf16 a[68:71], v[76:79], v[156:159], a[68:71]
    s_add_u32 m0, s73, 33792
    s_nop 0
    buffer_load_dwordx4 v30, s[44:47], s77 offen lds
    v_mfma_f32_16x16x32_bf16 a[88:91], v[76:79], v[160:163], a[88:91]
    s_lshl_b32 s75, s75, 13
    v_add_u32 v10, s75, v17
    v_mfma_f32_16x16x32_bf16 a[108:111], v[76:79], v[164:167], a[108:111]
    s_sub_u32 s75, s64, 3
    s_and_b32 s75, s75, 3
    s_or_b32 s75, s75, 8
    v_mfma_f32_16x16x32_bf16 v[224:227], v[80:83], v[152:155], v[224:227]
    s_lshl_b32 s75, s75, 13
    v_add_u32 v11, s75, v17
    v_mfma_f32_16x16x32_bf16 a[72:75], v[80:83], v[156:159], a[72:75]
    v_mfma_f32_16x16x32_bf16 a[92:95], v[80:83], v[160:163], a[92:95]
    s_add_u32 m0, s73, 34816
    s_add_u32 s77, s91, s76
    buffer_load_dwordx4 v13, s[44:47], s77 offen lds
    v_mfma_f32_16x16x32_bf16 a[112:115], v[80:83], v[164:167], a[112:115]
    v_mfma_f32_16x16x32_bf16 v[228:231], v[84:87], v[152:155], v[228:231]
    v_mfma_f32_16x16x32_bf16 a[76:79], v[84:87], v[156:159], a[76:79]
    v_mfma_f32_16x16x32_bf16 a[96:99], v[84:87], v[160:163], a[96:99]
    v_mfma_f32_16x16x32_bf16 a[116:119], v[84:87], v[164:167], a[116:119]
    s_add_u32 m0, s73, 35840
    s_nop 0
    buffer_load_dwordx4 v30, s[44:47], s77 offen lds
    v_mfma_f32_16x16x32_bf16 v[232:235], v[88:91], v[152:155], v[232:235]
    v_mfma_f32_16x16x32_bf16 a[80:83], v[88:91], v[156:159], a[80:83]
    v_mfma_f32_16x16x32_bf16 a[100:103], v[88:91], v[160:163], a[100:103]
    v_mfma_f32_16x16x32_bf16 a[120:123], v[88:91], v[164:167], a[120:123]
    s_waitcnt vmcnt(12)
    v_mfma_f32_16x16x32_bf16 v[216:219], v[92:95], v[168:171], v[216:219]
    s_add_u32 m0, s73, 36864
    s_add_u32 s77, s92, s76
    buffer_load_dwordx4 v13, s[44:47], s77 offen lds
    v_mfma_f32_16x16x32_bf16 a[64:67], v[92:95], v[172:175], a[64:67]
    v_cmp_le_i32 vcc, 0, v31
    s_xor_b32 s97, s10, 1
    s_lshl3_add_u32 s97, s97, s66
    s_lshl2_add_u32 s97, s97, s64
    s_cbranch_vccnz kf_fw_slow
kf_fw_ok:
    v_readlane_b32 s97, v31, s97
    v_mfma_f32_16x16x32_bf16 a[84:87], v[92:95], v[176:179], a[84:87]
    ds_read_b128 v[184:187], v28 offset:32768
    v_mfma_f32_16x16x32_bf16 a[104:107], v[92:95], v[180:183], a[104:107]
    ds_read_b128 v[188:191], v28 offset:34816
    v_mfma_f32_16x16x32_bf16 v[220:223], v[96:99], v[168:171], v[220:223]
    ds_read_b128 v[192:195], v28 offset:36864
    v_mfma_f32_16x16x32_bf16 a[68:71], v[96:99], v[172:175], a[68:71]
    s_add_u32 m0, s73, 37888
    s_nop 0
    buffer_load_dwordx4 v30, s[44:47], s77 offen lds
    v_mfma_f32_16x16x32_bf16 a[88:91], v[96:99], v[176:179], a[88:91]
    ds_read_b128 v[196:199], v28 offset:38912
    v_mfma_f32_16x16x32_bf16 a[108:111], v[96:99], v[180:183], a[108:111]
    ds_read_b128 v[200:203], v29 offset:32768
    v_mfma_f32_16x16x32_bf16 v[224:227], v[100:103], v[168:171], v[224:227]
    ds_read_b128 v[204:207], v29 offset:34816
    v_mfma_f32_16x16x32_bf16 a[72:75], v[100:103], v[172:175], a[72:75]
    ds_read_b128 v[208:211], v29 offset:36864
    v_mfma_f32_16x16x32_bf16 a[92:95], v[100:103], v[176:179], a[92:95]
    s_add_u32 m0, s73, 38912
    s_add_u32 s77, s93, s76
    buffer_load_dwordx4 v13, s[44:47], s77 offen lds
    v_mfma_f32_16x16x32_bf16 a[112:115], v[100:103], v[180:183], a[112:115]
    ds_read_b128 v[212:215], v29 offset:38912
    v_mfma_f32_16x16x32_bf16 v[228:231], v[104:107], v[168:171], v[228:231]
    v_mfma_f32_16x16x32_bf16 a[76:79], v[104:107], v[172:175], a[76:79]
    v_mfma_f32_16x16x32_bf16 a[96:99], v[104:107], v[176:179], a[96:99]
    v_mfma_f32_16x16x32_bf16 a[116:119], v[104:107], v[180:183], a[116:119]
    s_add_u32 m0, s73, 39936
    s_nop 0
    buffer_load_dwordx4 v30, s[44:47], s77 offen lds
    v_mfma_f32_16x16x32_bf16 v[232:235], v[108:111], v[168:171], v[232:235]
    v_mfma_f32_16x16x32_bf16 a[80:83], v[108:111], v[172:175], a[80:83]
    v_mfma_f32_16x16x32_bf16 a[100:103], v[108:111], v[176:179], a[100:103]
    v_mfma_f32_16x16x32_bf16 a[120:123], v[108:111], v[180:183], a[120:123]
    s_waitcnt lgkmcnt(0)
    v_mfma_f32_16x16x32_bf16 v[236:239], v[112:115], v[184:187], v[236:239]
    s_lshl3_add_u32 s62, s10, s66
    s_lshl2_add_u32 s62, s62, s64
    s_mul_i32 s62, s62, 6144
    v_mfma_f32_16x16x32_bf16 a[0:3], v[112:115], v[188:191], a[0:3]
    s_mul_i32 s63, s5, 393216
    s_add_u32 s62, s62, s63
    s_add_u32 s62, s62, 7864320
    v_mfma_f32_16x16x32_bf16 a[20:23], v[112:115], v[192:195], a[20:23]
    s_add_u32 s63, s62, 4096
    v_accvgpr_write_b32 a60, -1
    v_accvgpr_write_b32 a61, -1
    s_add_u32 s12, s11, 0
    buffer_load_dwordx4 a[124:127], v17, s[48:51], s12 offen sc1
    v_mfma_f32_16x16x32_bf16 a[40:43], v[112:115], v[196:199], a[40:43]
    v_accvgpr_write_b32 a62, -1
    v_accvgpr_write_b32 a63, -1
    v_mfma_f32_16x16x32_bf16 v[240:243], v[116:119], v[184:187], v[240:243]
    v_mfma_f32_16x16x32_bf16 a[4:7], v[116:119], v[188:191], a[4:7]
    buffer_store_dwordx4 a[60:63], v17, s[48:51], s62 offen offset:0 sc1
    s_add_u32 s12, s11, 20480
    buffer_load_dwordx4 a[128:131], v17, s[48:51], s12 offen sc1
    v_mfma_f32_16x16x32_bf16 a[24:27], v[116:119], v[192:195], a[24:27]
    buffer_store_dwordx4 a[60:63], v17, s[48:51], s62 offen offset:1024 sc1
    v_mfma_f32_16x16x32_bf16 a[44:47], v[116:119], v[196:199], a[44:47]
    buffer_store_dwordx4 a[60:63], v17, s[48:51], s62 offen offset:2048 sc1
    v_mfma_f32_16x16x32_bf16 v[244:247], v[120:123], v[184:187], v[244:247]
    buffer_store_dwordx4 a[60:63], v17, s[48:51], s62 offen offset:3072 sc1
    v_mfma_f32_16x16x32_bf16 a[8:11], v[120:123], v[188:191], a[8:11]
    buffer_store_dwordx4 a[60:63], v17, s[48:51], s63 offen offset:0 sc1
    s_add_u32 s12, s11, 40960
    buffer_load_dwordx4 a[132:135], v17, s[48:51], s12 offen sc1
    v_mfma_f32_16x16x32_bf16 a[28:31], v[120:123], v[192:195], a[28:31]
    buffer_store_dwordx4 a[60:63], v17, s[48:51], s63 offen offset:1024 sc1
    v_mfma_f32_16x16x32_bf16 a[48:51], v[120:123], v[196:199], a[48:51]
    ds_write_b128 v8, a[64:67] offset:0
    v_mfma_f32_16x16x32_bf16 v[248:251], v[124:127], v[184:187], v[248:251]
    ds_write_b128 v8, a[84:87] offset:5120
    v_mfma_f32_16x16x32_bf16 a[12:15], v[124:127], v[188:191], a[12:15]
    ds_write_b128 v8, a[104:107] offset:34816
    s_add_u32 s12, s11, 1024
    buffer_load_dwordx4 a[136:139], v17, s[48:51], s12 offen sc1
    v_mfma_f32_16x16x32_bf16 a[32:35], v[124:127], v[192:195], a[32:35]
    ds_write_b128 v8, a[68:71] offset:1024
    v_mfma_f32_16x16x32_bf16 a[52:55], v[124:127], v[196:199], a[52:55]
    ds_write_b128 v8, a[88:91] offset:6144
    v_mfma_f32_16x16x32_bf16 v[252:255], v[128:131], v[184:187], v[252:255]
    ds_write_b128 v8, a[108:111] offset:35840
    v_mfma_f32_16x16x32_bf16 a[16:19], v[128:131], v[188:191], a[16:19]
    ds_write_b128 v8, a[72:75] offset:2048
    s_add_u32 s12, s11, 21504
    buffer_load_dwordx4 a[140:143], v17, s[48:51], s12 offen sc1
    v_mfma_f32_16x16x32_bf16 a[36:39], v[128:131], v[192:195], a[36:39]
    ds_write_b128 v8, a[92:95] offset:7168
    v_mfma_f32_16x16x32_bf16 a[56:59], v[128:131], v[196:199], a[56:59]
    v_mfma_f32_16x16x32_bf16 v[236:239], v[132:135], v[200:203], v[236:239]
    s_waitcnt vmcnt(19)
    ds_read_b128 v[152:155], v14 offset:0
    v_mfma_f32_16x16x32_bf16 a[0:3], v[132:135], v[204:207], a[0:3]
    ds_read_b128 v[156:159], v14 offset:2048
    s_add_u32 s12, s11, 41984
    buffer_load_dwordx4 a[144:147], v17, s[48:51], s12 offen sc1
    v_mfma_f32_16x16x32_bf16 a[20:23], v[132:135], v[208:211], a[20:23]
    ds_read_b128 v[160:163], v14 offset:4096
    v_mfma_f32_16x16x32_bf16 a[40:43], v[132:135], v[212:215], a[40:43]
    ds_read_b128 v[164:167], v14 offset:6144
    v_mfma_f32_16x16x32_bf16 v[240:243], v[136:139], v[200:203], v[240:243]
    ds_read_b128 v[168:171], v15 offset:0
    s_add_u32 s12, s11, 2048
    buffer_load_dwordx4 a[148:151], v17, s[48:51], s12 offen sc1
    v_mfma_f32_16x16x32_bf16 a[4:7], v[136:139], v[204:207], a[4:7]
    ds_read_b128 v[172:175], v15 offset:2048
    v_mfma_f32_16x16x32_bf16 a[24:27], v[136:139], v[208:211], a[24:27]
    ds_read_b128 v[176:179], v15 offset:4096
    v_mfma_f32_16x16x32_bf16 a[44:47], v[136:139], v[212:215], a[44:47]
    ds_read_b128 v[180:183], v15 offset:6144
    v_mfma_f32_16x16x32_bf16 v[244:247], v[140:143], v[200:203], v[244:247]
    ds_write_b128 v8, a[112:115] offset:36864
    s_add_u32 s12, s11, 22528
    buffer_load_dwordx4 a[152:155], v17, s[48:51], s12 offen sc1
    v_mfma_f32_16x16x32_bf16 a[8:11], v[140:143], v[204:207], a[8:11]
    ds_write_b128 v8, a[76:79] offset:3072
    v_mfma_f32_16x16x32_bf16 a[28:31], v[140:143], v[208:211], a[28:31]
    ds_write_b128 v8, a[96:99] offset:32768
    v_mfma_f32_16x16x32_bf16 a[48:51], v[140:143], v[212:215], a[48:51]
    ds_write_b128 v8, a[116:119] offset:37888
    v_mfma_f32_16x16x32_bf16 v[248:251], v[144:147], v[200:203], v[248:251]
    ds_write_b128 v8, a[80:83] offset:4096
    s_add_u32 s12, s11, 43008
    buffer_load_dwordx4 a[156:159], v17, s[48:51], s12 offen sc1
    v_mfma_f32_16x16x32_bf16 a[12:15], v[144:147], v[204:207], a[12:15]
    ds_write_b128 v8, a[100:103] offset:33792
    v_mfma_f32_16x16x32_bf16 a[32:35], v[144:147], v[208:211], a[32:35]
    ds_write_b128 v8, a[120:123] offset:38912
    v_mfma_f32_16x16x32_bf16 a[52:55], v[144:147], v[212:215], a[52:55]
    v_mfma_f32_16x16x32_bf16 v[252:255], v[148:151], v[200:203], v[252:255]
    s_add_u32 s12, s11, 3072
    buffer_load_dwordx4 a[160:163], v17, s[48:51], s12 offen sc1
    v_mfma_f32_16x16x32_bf16 a[16:19], v[148:151], v[204:207], a[16:19]
    v_mfma_f32_16x16x32_bf16 a[36:39], v[148:151], v[208:211], a[36:39]
    v_mfma_f32_16x16x32_bf16 a[56:59], v[148:151], v[212:215], a[56:59]
    s_waitcnt lgkmcnt(0)
    s_barrier
    v_mfma_f32_16x16x32_bf16 v[236:239], v[32:35], v[152:155], v[236:239]
    ds_read_b128 v[112:115], v9 offset:0
    ds_read_b128 v[116:119], v10 offset:5120
    ds_read_b128 v[120:123], v11 offset:34816
    v_mfma_f32_16x16x32_bf16 a[0:3], v[32:35], v[156:159], a[0:3]
    ds_read_b128 v[124:127], v9 offset:1024
    ds_read_b128 v[128:131], v10 offset:6144
    ds_read_b128 v[132:135], v11 offset:35840
    v_mfma_f32_16x16x32_bf16 a[20:23], v[32:35], v[160:163], a[20:23]
    ds_read_b128 v[136:139], v9 offset:2048
    ds_read_b128 v[140:143], v10 offset:7168
    ds_read_b128 v[144:147], v11 offset:36864
    s_add_u32 s12, s11, 23552
    buffer_load_dwordx4 a[164:167], v17, s[48:51], s12 offen sc1
    v_mfma_f32_16x16x32_bf16 a[40:43], v[32:35], v[164:167], a[40:43]
    v_mfma_f32_16x16x32_bf16 v[240:243], v[36:39], v[152:155], v[240:243]
    v_mfma_f32_16x16x32_bf16 a[4:7], v[36:39], v[156:159], a[4:7]
    s_waitcnt lgkmcnt(6)
    v_add_f32 v112, v112, v116
    v_add_f32 v216, v216, v120
    v_add_f32 v113, v113, v117
    s_add_u32 s12, s11, 44032
    buffer_load_dwordx4 a[168:171], v17, s[48:51], s12 offen sc1
    v_mfma_f32_16x16x32_bf16 a[24:27], v[36:39], v[160:163], a[24:27]
    v_add_f32 v217, v217, v121
    v_add_f32 v114, v114, v118
    v_add_f32 v218, v218, v122
    v_mfma_f32_16x16x32_bf16 a[44:47], v[36:39], v[164:167], a[44:47]
    v_add_f32 v115, v115, v119
    v_add_f32 v219, v219, v123
    v_add_f32 v216, v216, v112
    v_mfma_f32_16x16x32_bf16 v[244:247], v[40:43], v[152:155], v[244:247]
    v_add_f32 v217, v217, v113
    v_add_f32 v218, v218, v114
    v_add_f32 v219, v219, v115
    v_mfma_f32_16x16x32_bf16 a[8:11], v[40:43], v[156:159], a[8:11]
    v_cvt_pk_bf16_f32 v216, v216, v217
    v_cvt_pk_bf16_f32 v217, v218, v219
    ds_read_b128 v[112:115], v9 offset:3072
    s_add_u32 s12, s11, 4096
    buffer_load_dwordx4 a[172:175], v17, s[48:51], s12 offen sc1
    v_mfma_f32_16x16x32_bf16 a[28:31], v[40:43], v[160:163], a[28:31]
    ds_read_b128 v[116:119], v10 offset:32768
    ds_read_b128 v[120:123], v11 offset:37888
    s_waitcnt lgkmcnt(6)
    v_add_f32 v124, v124, v128
    v_mfma_f32_16x16x32_bf16 a[48:51], v[40:43], v[164:167], a[48:51]
    v_add_f32 v220, v220, v132
    v_add_f32 v125, v125, v129
    v_add_f32 v221, v221, v133
    v_mfma_f32_16x16x32_bf16 v[248:251], v[44:47], v[152:155], v[248:251]
    v_add_f32 v126, v126, v130
    v_add_f32 v222, v222, v134
    v_add_f32 v127, v127, v131
    v_mfma_f32_16x16x32_bf16 a[12:15], v[44:47], v[156:159], a[12:15]
    v_add_f32 v223, v223, v135
    v_add_f32 v220, v220, v124
    v_add_f32 v221, v221, v125
    s_add_u32 s12, s11, 24576
    buffer_load_dwordx4 a[176:179], v17, s[48:51], s12 offen sc1
    v_mfma_f32_16x16x32_bf16 a[32:35], v[44:47], v[160:163], a[32:35]
    v_add_f32 v222, v222, v126
    v_add_f32 v223, v223, v127
    v_cvt_pk_bf16_f32 v218, v220, v221
    v_mfma_f32_16x16x32_bf16 a[52:55], v[44:47], v[164:167], a[52:55]
    v_cvt_pk_bf16_f32 v219, v222, v223
    ds_read_b128 v[124:127], v9 offset:4096
    ds_read_b128 v[128:131], v10 offset:33792
    v_mfma_f32_16x16x32_bf16 v[252:255], v[48:51], v[152:155], v[252:255]
    ds_read_b128 v[132:135], v11 offset:38912
    s_waitcnt lgkmcnt(6)
    v_add_f32 v136, v136, v140
    v_add_f32 v224, v224, v144
    v_mfma_f32_16x16x32_bf16 a[16:19], v[48:51], v[156:159], a[16:19]
    v_add_f32 v137, v137, v141
    v_add_f32 v225, v225, v145
    v_add_f32 v138, v138, v142
    s_add_u32 s12, s11, 45056
    buffer_load_dwordx4 a[180:183], v17, s[48:51], s12 offen sc1
    v_mfma_f32_16x16x32_bf16 a[36:39], v[48:51], v[160:163], a[36:39]
    v_add_f32 v226, v226, v146
    v_add_f32 v139, v139, v143
    v_add_f32 v227, v227, v147
    v_mfma_f32_16x16x32_bf16 a[56:59], v[48:51], v[164:167], a[56:59]
    v_add_f32 v224, v224, v136
    v_add_f32 v225, v225, v137
    v_add_f32 v226, v226, v138
    v_mfma_f32_16x16x32_bf16 v[236:239], v[52:55], v[168:171], v[236:239]
    v_add_f32 v227, v227, v139
    v_cvt_pk_bf16_f32 v220, v224, v225
    v_cvt_pk_bf16_f32 v221, v226, v227
    v_mfma_f32_16x16x32_bf16 a[0:3], v[52:55], v[172:175], a[0:3]
    s_waitcnt lgkmcnt(3)
    v_add_f32 v112, v112, v116
    v_add_f32 v228, v228, v120
    v_add_f32 v113, v113, v117
    s_add_u32 s12, s11, 5120
    buffer_load_dwordx4 a[184:187], v17, s[48:51], s12 offen sc1
    v_mfma_f32_16x16x32_bf16 a[20:23], v[52:55], v[176:179], a[20:23]
    v_add_f32 v229, v229, v121
    v_add_f32 v114, v114, v118
    v_add_f32 v230, v230, v122
    v_mfma_f32_16x16x32_bf16 a[40:43], v[52:55], v[180:183], a[40:43]
    v_add_f32 v115, v115, v119
    v_add_f32 v231, v231, v123
    v_add_f32 v228, v228, v112
    v_mfma_f32_16x16x32_bf16 v[240:243], v[56:59], v[168:171], v[240:243]
    v_add_f32 v229, v229, v113
    v_add_f32 v230, v230, v114
    v_add_f32 v231, v231, v115
    s_add_u32 s12, s11, 25600
    buffer_load_dwordx4 a[188:191], v17, s[48:51], s12 offen sc1
    v_mfma_f32_16x16x32_bf16 a[4:7], v[56:59], v[172:175], a[4:7]
    v_cvt_pk_bf16_f32 v222, v228, v229
    v_cvt_pk_bf16_f32 v223, v230, v231
    s_waitcnt lgkmcnt(0)
    v_add_f32 v124, v124, v128
    v_mfma_f32_16x16x32_bf16 a[24:27], v[56:59], v[176:179], a[24:27]
    v_add_f32 v232, v232, v132
    v_add_f32 v125, v125, v129
    v_add_f32 v233, v233, v133
    v_mfma_f32_16x16x32_bf16 a[44:47], v[56:59], v[180:183], a[44:47]
    v_add_f32 v126, v126, v130
    v_add_f32 v234, v234, v134
    v_add_f32 v127, v127, v131
    v_mfma_f32_16x16x32_bf16 v[244:247], v[60:63], v[168:171], v[244:247]
    v_add_f32 v235, v235, v135
    v_add_f32 v232, v232, v124
    v_add_f32 v233, v233, v125
    s_add_u32 s12, s11, 46080
    buffer_load_dwordx4 a[192:195], v17, s[48:51], s12 offen sc1
    v_mfma_f32_16x16x32_bf16 a[8:11], v[60:63], v[172:175], a[8:11]
    v_add_f32 v234, v234, v126
    v_add_f32 v235, v235, v127
    v_cvt_pk_bf16_f32 v224, v232, v233
    v_mfma_f32_16x16x32_bf16 a[28:31], v[60:63], v[176:179], a[28:31]
    v_cvt_pk_bf16_f32 v225, v234, v235
    buffer_store_dwordx4 v[216:219], v17, s[48:51], s60 offen offset:0 sc1
    buffer_store_dwordx4 v[220:223], v17, s[48:51], s60 offen offset:1024 sc1
    v_mfma_f32_16x16x32_bf16 a[48:51], v[60:63], v[180:183], a[48:51]
    v_add3_u32 v226, s96, v216, v217
    v_add3_u32 v226, v226, v218, v219
    v_add3_u32 v226, v226, v220, v221
    v_mfma_f32_16x16x32_bf16 v[248:251], v[64:67], v[168:171], v[248:251]
    v_add3_u32 v226, v226, v222, v223
    v_add3_u32 v226, v226, v224, v225
    buffer_store_dwordx4 v[224:227], v17, s[48:51], s60 offen offset:2048 sc1
    s_add_u32 s12, s11, 6144
    buffer_load_dwordx4 a[196:199], v17, s[48:51], s12 offen sc1
    v_mfma_f32_16x16x32_bf16 a[12:15], v[64:67], v[172:175], a[12:15]
    s_waitcnt vmcnt(28)
    ds_read_b128 v[184:187], v14 offset:32768
    ds_read_b128 v[188:191], v14 offset:34816
    ds_read_b128 v[192:195], v14 offset:36864
    v_mfma_f32_16x16x32_bf16 a[32:35], v[64:67], v[176:179], a[32:35]
    ds_read_b128 v[196:199], v14 offset:38912
    ds_read_b128 v[200:203], v15 offset:32768
    ds_read_b128 v[204:207], v15 offset:34816
    v_mfma_f32_16x16x32_bf16 a[52:55], v[64:67], v[180:183], a[52:55]
    ds_read_b128 v[208:211], v15 offset:36864
    ds_read_b128 v[212:215], v15 offset:38912
    v_mfma_f32_16x16x32_bf16 v[252:255], v[68:71], v[168:171], v[252:255]
    s_add_u32 s12, s11, 26624
    buffer_load_dwordx4 a[200:203], v17, s[48:51], s12 offen sc1
    v_mfma_f32_16x16x32_bf16 a[16:19], v[68:71], v[172:175], a[16:19]
    v_mfma_f32_16x16x32_bf16 a[36:39], v[68:71], v[176:179], a[36:39]
    v_mfma_f32_16x16x32_bf16 a[56:59], v[68:71], v[180:183], a[56:59]
    s_waitcnt lgkmcnt(0)
    v_mfma_f32_16x16x32_bf16 v[236:239], v[72:75], v[184:187], v[236:239]
    v_subrev_u32 v8, 0x10000, v8
    v_mfma_f32_16x16x32_bf16 a[0:3], v[72:75], v[188:191], a[0:3]
    v_subrev_u32 v9, 0x10000, v9
    v_mfma_f32_16x16x32_bf16 a[20:23], v[72:75], v[192:195], a[20:23]
    v_subrev_u32 v10, 0x10000, v10
    v_mfma_f32_16x16x32_bf16 a[40:43], v[72:75], v[196:199], a[40:43]
    s_branch kf_pw_k2_o
kf_pw_k2:
    s_branch kf_pw_k6
kf_pw_k2_o:
    v_subrev_u32 v11, 0x10000, v11
    v_mfma_f32_16x16x32_bf16 v[236:239], v[92:95], v[200:203], v[236:239]
    v_mfma_f32_16x16x32_bf16 a[0:3], v[92:95], v[204:207], a[0:3]
    v_mfma_f32_16x16x32_bf16 a[20:23], v[92:95], v[208:211], a[20:23]
    v_mfma_f32_16x16x32_bf16 a[40:43], v[92:95], v[212:215], a[40:43]
    v_mfma_f32_16x16x32_bf16 v[240:243], v[76:79], v[184:187], v[240:243]
    v_mfma_f32_16x16x32_bf16 a[4:7], v[76:79], v[188:191], a[4:7]
    v_mfma_f32_16x16x32_bf16 a[24:27], v[76:79], v[192:195], a[24:27]
    v_mfma_f32_16x16x32_bf16 a[44:47], v[76:79], v[196:199], a[44:47]
    v_mfma_f32_16x16x32_bf16 v[240:243], v[96:99], v[200:203], v[240:243]
    v_mfma_f32_16x16x32_bf16 a[4:7], v[96:99], v[204:207], a[4:7]
    ds_write_b128 v8, a[0:3] offset:0
    v_mfma_f32_16x16x32_bf16 a[24:27], v[96:99], v[208:211], a[24:27]
    ds_write_b128 v8, a[20:23] offset:5120
    v_mfma_f32_16x16x32_bf16 a[44:47], v[96:99], v[212:215], a[44:47]
    ds_write_b128 v8, a[40:43] offset:34816
    v_mfma_f32_16x16x32_bf16 v[244:247], v[80:83], v[184:187], v[244:247]
    v_mfma_f32_16x16x32_bf16 a[8:11], v[80:83], v[188:191], a[8:11]
    v_mfma_f32_16x16x32_bf16 a[28:31], v[80:83], v[192:195], a[28:31]
    v_mfma_f32_16x16x32_bf16 a[48:51], v[80:83], v[196:199], a[48:51]
    v_mfma_f32_16x16x32_bf16 v[244:247], v[100:103], v[200:203], v[244:247]
    v_mfma_f32_16x16x32_bf16 a[8:11], v[100:103], v[204:207], a[8:11]
    ds_write_b128 v8, a[4:7] offset:1024
    v_mfma_f32_16x16x32_bf16 a[28:31], v[100:103], v[208:211], a[28:31]
    ds_write_b128 v8, a[24:27] offset:6144
    v_mfma_f32_16x16x32_bf16 a[48:51], v[100:103], v[212:215], a[48:51]
    ds_write_b128 v8, a[44:47] offset:35840
    v_mfma_f32_16x16x32_bf16 v[248:251], v[84:87], v[184:187], v[248:251]
    v_mfma_f32_16x16x32_bf16 a[12:15], v[84:87], v[188:191], a[12:15]
    v_mfma_f32_16x16x32_bf16 a[32:35], v[84:87], v[192:195], a[32:35]
    v_mfma_f32_16x16x32_bf16 a[52:55], v[84:87], v[196:199], a[52:55]
    v_mfma_f32_16x16x32_bf16 v[248:251], v[104:107], v[200:203], v[248:251]
    v_mfma_f32_16x16x32_bf16 a[12:15], v[104:107], v[204:207], a[12:15]
    ds_write_b128 v8, a[8:11] offset:2048
    v_mfma_f32_16x16x32_bf16 a[32:35], v[104:107], v[208:211], a[32:35]
    ds_write_b128 v8, a[28:31] offset:7168
    v_mfma_f32_16x16x32_bf16 a[52:55], v[104:107], v[212:215], a[52:55]
    ds_write_b128 v8, a[48:51] offset:36864
    v_mfma_f32_16x16x32_bf16 v[252:255], v[88:91], v[184:187], v[252:255]
    v_mfma_f32_16x16x32_bf16 a[16:19], v[88:91], v[188:191], a[16:19]
    v_mfma_f32_16x16x32_bf16 a[36:39], v[88:91], v[192:195], a[36:39]
    v_mfma_f32_16x16x32_bf16 a[56:59], v[88:91], v[196:199], a[56:59]
    v_mfma_f32_16x16x32_bf16 v[252:255], v[108:111], v[200:203], v[252:255]
    v_mfma_f32_16x16x32_bf16 a[16:19], v[108:111], v[204:207], a[16:19]
    ds_write_b128 v8, a[12:15] offset:3072
    v_mfma_f32_16x16x32_bf16 a[36:39], v[108:111], v[208:211], a[36:39]
    ds_write_b128 v8, a[32:35] offset:32768
    v_mfma_f32_16x16x32_bf16 a[56:59], v[108:111], v[212:215], a[56:59]
    ds_write_b128 v8, a[52:55] offset:37888
    buffer_load_dwordx4 v[172:175], v17, s[48:51], s61 offen offset:0 sc1
    buffer_load_dwordx4 v[176:179], v17, s[48:51], s61 offen offset:1024 sc1
    buffer_load_dwordx4 v[180:183], v17, s[48:51], s61 offen offset:2048 sc1
    s_nop 3
    s_nop 3
    ds_write_b128 v8, a[16:19] offset:4096
    ds_write_b128 v8, a[36:39] offset:33792
    ds_write_b128 v8, a[56:59] offset:38912
    s_waitcnt lgkmcnt(0)
    s_barrier
    ds_read_b128 v[32:35], v9 offset:0
    ds_read_b128 v[36:39], v10 offset:5120
    ds_read_b128 v[40:43], v11 offset:34816
    ds_read_b128 v[44:47], v9 offset:1024
    ds_read_b128 v[48:51], v10 offset:6144
    ds_read_b128 v[52:55], v11 offset:35840
    ds_read_b128 v[56:59], v9 offset:2048
    ds_read_b128 v[60:63], v10 offset:7168
    ds_read_b128 v[64:67], v11 offset:36864
    ds_read_b128 v[68:71], v9 offset:3072
    ds_read_b128 v[72:75], v10 offset:32768
    ds_read_b128 v[76:79], v11 offset:37888
    ds_read_b128 v[80:83], v9 offset:4096
    ds_read_b128 v[84:87], v10 offset:33792
    ds_read_b128 v[88:91], v11 offset:38912
    s_waitcnt lgkmcnt(12)
    v_pk_add_f32 v[32:33], v[32:33], v[36:37]
    v_pk_add_f32 v[236:237], v[236:237], v[40:41]
    s_add_u32 s12, s11, 47104
    buffer_load_dwordx4 a[204:207], v17, s[48:51], s12 offen sc1
    v_pk_add_f32 v[34:35], v[34:35], v[38:39]
    v_pk_add_f32 v[238:239], v[238:239], v[42:43]
    v_pk_add_f32 v[236:237], v[236:237], v[32:33]
    s_add_u32 s12, s11, 7168
    buffer_load_dwordx4 a[208:211], v17, s[48:51], s12 offen sc1
    v_pk_add_f32 v[238:239], v[238:239], v[34:35]
    v_cvt_pk_bf16_f32 v92, v236, v237
    v_cvt_pk_bf16_f32 v93, v238, v239
    s_add_u32 s12, s11, 27648
    buffer_load_dwordx4 a[212:215], v17, s[48:51], s12 offen sc1
    s_waitcnt lgkmcnt(9)
    v_pk_add_f32 v[44:45], v[44:45], v[48:49]
    v_pk_add_f32 v[240:241], v[240:241], v[52:53]
    s_add_u32 s12, s11, 48128
    buffer_load_dwordx4 a[216:219], v17, s[48:51], s12 offen sc1
    v_pk_add_f32 v[46:47], v[46:47], v[50:51]
    v_pk_add_f32 v[242:243], v[242:243], v[54:55]
    v_pk_add_f32 v[240:241], v[240:241], v[44:45]
    s_add_u32 s12, s11, 8192
    buffer_load_dwordx4 a[220:223], v17, s[48:51], s12 offen sc1
    v_pk_add_f32 v[242:243], v[242:243], v[46:47]
    v_cvt_pk_bf16_f32 v94, v240, v241
    v_cvt_pk_bf16_f32 v95, v242, v243
    s_add_u32 s12, s11, 28672
    buffer_load_dwordx4 a[224:227], v17, s[48:51], s12 offen sc1
    s_waitcnt lgkmcnt(6)
    v_pk_add_f32 v[56:57], v[56:57], v[60:61]
    v_pk_add_f32 v[244:245], v[244:245], v[64:65]
    s_add_u32 s12, s11, 49152
    buffer_load_dwordx4 a[228:231], v17, s[48:51], s12 offen sc1
    v_pk_add_f32 v[58:59], v[58:59], v[62:63]
    v_pk_add_f32 v[246:247], v[246:247], v[66:67]
    v_pk_add_f32 v[244:245], v[244:245], v[56:57]
    s_add_u32 s12, s11, 9216
    buffer_load_dwordx4 a[232:235], v17, s[48:51], s12 offen sc1
    v_pk_add_f32 v[246:247], v[246:247], v[58:59]
    v_cvt_pk_bf16_f32 v96, v244, v245
    v_cvt_pk_bf16_f32 v97, v246, v247
    s_add_u32 s12, s11, 29696
    buffer_load_dwordx4 a[236:239], v17, s[48:51], s12 offen sc1
    s_waitcnt lgkmcnt(3)
    v_pk_add_f32 v[68:69], v[68:69], v[72:73]
    v_pk_add_f32 v[248:249], v[248:249], v[76:77]
    s_add_u32 s12, s11, 50176
    buffer_load_dwordx4 a[240:243], v17, s[48:51], s12 offen sc1
    v_pk_add_f32 v[70:71], v[70:71], v[74:75]
    v_pk_add_f32 v[250:251], v[250:251], v[78:79]
    v_pk_add_f32 v[248:249], v[248:249], v[68:69]
    v_pk_add_f32 v[250:251], v[250:251], v[70:71]
    v_cvt_pk_bf16_f32 v98, v248, v249
    v_cvt_pk_bf16_f32 v99, v250, v251
    s_waitcnt lgkmcnt(0)
    v_pk_add_f32 v[80:81], v[80:81], v[84:85]
    v_pk_add_f32 v[252:253], v[252:253], v[88:89]
    v_pk_add_f32 v[82:83], v[82:83], v[86:87]
    v_pk_add_f32 v[254:255], v[254:255], v[90:91]
    v_pk_add_f32 v[252:253], v[252:253], v[80:81]
    v_pk_add_f32 v[254:255], v[254:255], v[82:83]
    v_cvt_pk_bf16_f32 v100, v252, v253
    v_cvt_pk_bf16_f32 v101, v254, v255
    v_lshlrev_b32 v104, 16, v92
    v_and_b32 v105, 0xffff0000, v92
    v_lshlrev_b32 v152, 16, v18
    v_and_b32 v153, 0xffff0000, v18
    v_lshlrev_b32 v106, 16, v93
    v_and_b32 v107, 0xffff0000, v93
    v_lshlrev_b32 v154, 16, v19
    v_and_b32 v155, 0xffff0000, v19
    v_lshlrev_b32 v108, 16, v94
    v_and_b32 v109, 0xffff0000, v94
    v_lshlrev_b32 v156, 16, v20
    v_and_b32 v157, 0xffff0000, v20
    v_lshlrev_b32 v110, 16, v95
    v_and_b32 v111, 0xffff0000, v95
    v_lshlrev_b32 v158, 16, v21
    v_and_b32 v159, 0xffff0000, v21
    v_lshlrev_b32 v112, 16, v96
    v_and_b32 v113, 0xffff0000, v96
    v_lshlrev_b32 v160, 16, v22
    v_and_b32 v161, 0xffff0000, v22
    v_lshlrev_b32 v114, 16, v97
    v_and_b32 v115, 0xffff0000, v97
    v_lshlrev_b32 v162, 16, v23
    v_and_b32 v163, 0xffff0000, v23
    v_lshlrev_b32 v116, 16, v98
    v_and_b32 v117, 0xffff0000, v98
    v_lshlrev_b32 v164, 16, v24
    v_and_b32 v165, 0xffff0000, v24
    v_lshlrev_b32 v118, 16, v99
    v_and_b32 v119, 0xffff0000, v99
    v_lshlrev_b32 v166, 16, v25
    v_and_b32 v167, 0xffff0000, v25
    v_lshlrev_b32 v120, 16, v100
    v_and_b32 v121, 0xffff0000, v100
    v_lshlrev_b32 v168, 16, v26
    v_and_b32 v169, 0xffff0000, v26
    v_lshlrev_b32 v122, 16, v101
    v_and_b32 v123, 0xffff0000, v101
    v_lshlrev_b32 v170, 16, v27
    v_and_b32 v171, 0xffff0000, v27
    s_waitcnt vmcnt(10)
    v_add3_u32 v184, s97, v172, v173
    v_add3_u32 v184, v184, v174, v175
    v_add3_u32 v184, v184, v176, v177
    v_add3_u32 v184, v184, v178, v179
    v_add3_u32 v184, v184, v180, v181
    v_cmp_ne_u32 vcc, v184, v182
    s_cbranch_vccnz kf_x_slow
kf_x_ok:
    v_lshlrev_b32 v184, 16, v172
    v_and_b32 v185, 0xffff0000, v172
    v_pk_add_f32 v[184:185], v[184:185], v[104:105]
    v_cvt_pk_bf16_f32 v186, v184, v185
    v_lshlrev_b32 v184, 16, v186
    v_and_b32 v185, 0xffff0000, v186
    v_pk_add_f32 v[184:185], v[184:185], v[152:153]
    v_cvt_pk_bf16_f32 v18, v184, v185
    v_lshlrev_b32 v188, 16, v173
    v_and_b32 v189, 0xffff0000, v173
    v_pk_add_f32 v[188:189], v[188:189], v[106:107]
    v_cvt_pk_bf16_f32 v190, v188, v189
    v_lshlrev_b32 v188, 16, v190
    v_and_b32 v189, 0xffff0000, v190
    v_pk_add_f32 v[188:189], v[188:189], v[154:155]
    v_cvt_pk_bf16_f32 v19, v188, v189
    v_lshlrev_b32 v184, 16, v174
    v_and_b32 v185, 0xffff0000, v174
    v_pk_add_f32 v[184:185], v[184:185], v[108:109]
    v_cvt_pk_bf16_f32 v186, v184, v185
    v_lshlrev_b32 v184, 16, v186
    v_and_b32 v185, 0xffff0000, v186
    v_pk_add_f32 v[184:185], v[184:185], v[156:157]
    v_cvt_pk_bf16_f32 v20, v184, v185
    v_lshlrev_b32 v188, 16, v175
    v_and_b32 v189, 0xffff0000, v175
    v_pk_add_f32 v[188:189], v[188:189], v[110:111]
    v_cvt_pk_bf16_f32 v190, v188, v189
    v_lshlrev_b32 v188, 16, v190
    v_and_b32 v189, 0xffff0000, v190
    v_pk_add_f32 v[188:189], v[188:189], v[158:159]
    v_cvt_pk_bf16_f32 v21, v188, v189
    v_lshlrev_b32 v184, 16, v176
    v_and_b32 v185, 0xffff0000, v176
    v_pk_add_f32 v[184:185], v[184:185], v[112:113]
    v_cvt_pk_bf16_f32 v186, v184, v185
    v_lshlrev_b32 v184, 16, v186
    v_and_b32 v185, 0xffff0000, v186
    v_pk_add_f32 v[184:185], v[184:185], v[160:161]
    v_cvt_pk_bf16_f32 v22, v184, v185
    v_lshlrev_b32 v188, 16, v177
    v_and_b32 v189, 0xffff0000, v177
    v_pk_add_f32 v[188:189], v[188:189], v[114:115]
    v_cvt_pk_bf16_f32 v190, v188, v189
    v_lshlrev_b32 v188, 16, v190
    v_and_b32 v189, 0xffff0000, v190
    v_pk_add_f32 v[188:189], v[188:189], v[162:163]
    v_cvt_pk_bf16_f32 v23, v188, v189
    v_lshlrev_b32 v184, 16, v178
    v_and_b32 v185, 0xffff0000, v178
    v_pk_add_f32 v[184:185], v[184:185], v[116:117]
    v_cvt_pk_bf16_f32 v186, v184, v185
    v_lshlrev_b32 v184, 16, v186
    v_and_b32 v185, 0xffff0000, v186
    v_pk_add_f32 v[184:185], v[184:185], v[164:165]
    v_cvt_pk_bf16_f32 v24, v184, v185
    v_lshlrev_b32 v188, 16, v179
    v_and_b32 v189, 0xffff0000, v179
    v_pk_add_f32 v[188:189], v[188:189], v[118:119]
    v_cvt_pk_bf16_f32 v190, v188, v189
    v_lshlrev_b32 v188, 16, v190
    v_and_b32 v189, 0xffff0000, v190
    v_pk_add_f32 v[188:189], v[188:189], v[166:167]
    v_cvt_pk_bf16_f32 v25, v188, v189
    v_lshlrev_b32 v184, 16, v180
    v_and_b32 v185, 0xffff0000, v180
    v_pk_add_f32 v[184:185], v[184:185], v[120:121]
    v_cvt_pk_bf16_f32 v186, v184, v185
    v_lshlrev_b32 v184, 16, v186
    v_and_b32 v185, 0xffff0000, v186
    v_pk_add_f32 v[184:185], v[184:185], v[168:169]
    v_cvt_pk_bf16_f32 v26, v184, v185
    v_lshlrev_b32 v188, 16, v181
    v_and_b32 v189, 0xffff0000, v181
    v_pk_add_f32 v[188:189], v[188:189], v[122:123]
    v_cvt_pk_bf16_f32 v190, v188, v189
    v_lshlrev_b32 v188, 16, v190
    v_and_b32 v189, 0xffff0000, v190
    v_pk_add_f32 v[188:189], v[188:189], v[170:171]
    v_cvt_pk_bf16_f32 v27, v188, v189
    s_bitcmp1_b32 s66, 0
    s_cbranch_scc1 kf_h_odd
    buffer_store_dwordx4 v[18:21], v17, s[48:51], s84 offen sc1
    buffer_store_dwordx4 v[22:25], v17, s[48:51], s84 offen offset:1024 sc1
    buffer_store_dwordx2 v[26:27], v17, s[48:51], s84 offen offset:2048 sc1
    s_branch kf_h_done
kf_h_odd:
    buffer_store_dwordx2 v[18:19], v17, s[48:51], s84 offen offset:8 sc1
    buffer_store_dwordx4 v[20:23], v17, s[48:51], s84 offen offset:1024 sc1
    buffer_store_dwordx4 v[24:27], v17, s[48:51], s84 offen offset:2048 sc1
kf_h_done:
    v_mov_b32 v32, 0
    v_mov_b32 v33, 0
    v_mov_b32 v36, 0x3f803f80
    v_dot2_f32_bf16 v33, v18, v18, v33
    v_dot2_f32_bf16 v32, v18, v36, v32
    v_dot2_f32_bf16 v33, v19, v19, v33
    v_dot2_f32_bf16 v32, v19, v36, v32
    v_dot2_f32_bf16 v33, v20, v20, v33
    v_dot2_f32_bf16 v32, v20, v36, v32
    v_dot2_f32_bf16 v33, v21, v21, v33
    v_dot2_f32_bf16 v32, v21, v36, v32
    v_dot2_f32_bf16 v33, v22, v22, v33
    v_dot2_f32_bf16 v32, v22, v36, v32
    v_dot2_f32_bf16 v33, v23, v23, v33
    v_dot2_f32_bf16 v32, v23, v36, v32
    v_dot2_f32_bf16 v33, v24, v24, v33
    v_dot2_f32_bf16 v32, v24, v36, v32
    v_dot2_f32_bf16 v33, v25, v25, v33
    v_dot2_f32_bf16 v32, v25, v36, v32
    v_dot2_f32_bf16 v33, v26, v26, v33
    v_dot2_f32_bf16 v32, v26, v36, v32
    v_dot2_f32_bf16 v33, v27, v27, v33
    v_dot2_f32_bf16 v32, v27, v36, v32
    s_lshl_b32 s75, s65, 6
    s_lshl_b32 s76, s64, 4
    s_add_u32 s75, s75, s76
    s_lshl_b32 s75, s75, 6
    s_lshl_b32 s76, s66, 3
    s_add_u32 s75, s75, s76
    s_add_u32 s75, s75, 20140032
    v_lshlrev_b32 v36, 6, v2
    v_mov_b32 v34, v32
    v_mov_b32 v35, v33
    s_nop 1
    v_permlane32_swap_b32 v32, v34
    v_permlane32_swap_b32 v33, v35
    s_nop 1
    v_add_f32 v32, v32, v34
    v_add_f32 v33, v33, v35
    v_mov_b32 v34, v32
    v_mov_b32 v35, v33
    s_nop 1
    v_permlane16_swap_b32 v32, v34
    v_permlane16_swap_b32 v33, v35
    s_nop 1
    v_add_f32 v32, v32, v34
    v_add_f32 v33, v33, v35
    s_mov_b64 exec, 0xffff
    buffer_store_dwordx2 v[32:33], v36, s[48:51], s75 offen sc1
    s_mov_b64 exec, -1
    s_add_u32 s12, s11, 10240
    buffer_load_dwordx4 a[244:247], v17, s[48:51], s12 offen sc1
    s_add_u32 s12, s11, 30720
    buffer_load_dwordx4 a[248:251], v17, s[48:51], s12 offen sc1
    s_add_u32 s12, s11, 51200
    buffer_load_dwordx4 a[252:255], v17, s[48:51], s12 offen sc1
    s_add_u32 s12, s11, 11264
    buffer_load_dwordx4 a[60:63], v17, s[48:51], s12 offen sc1
    s_add_u32 s12, s11, 31744
    buffer_load_dwordx4 a[80:83], v17, s[48:51], s12 offen sc1
    s_add_u32 s12, s11, 52224
    buffer_load_dwordx4 a[84:87], v17, s[48:51], s12 offen sc1
    s_add_u32 s12, s11, 12288
    buffer_load_dwordx4 a[88:91], v17, s[48:51], s12 offen sc1
    s_add_u32 s12, s11, 32768
    buffer_load_dwordx4 a[92:95], v17, s[48:51], s12 offen sc1
    s_add_u32 s12, s11, 53248
    buffer_load_dwordx4 a[96:99], v17, s[48:51], s12 offen sc1
    s_add_u32 s12, s11, 13312
    buffer_load_dwordx4 a[100:103], v17, s[48:51], s12 offen sc1
    s_add_u32 s12, s11, 33792
    buffer_load_dwordx4 a[104:107], v17, s[48:51], s12 offen sc1
    s_add_u32 s12, s11, 54272
    buffer_load_dwordx4 a[108:111], v17, s[48:51], s12 offen sc1
    s_add_u32 s12, s11, 14336
    buffer_load_dwordx4 a[112:115], v17, s[48:51], s12 offen sc1
    s_add_u32 s12, s11, 34816
    buffer_load_dwordx4 a[116:119], v17, s[48:51], s12 offen sc1
    v_mov_b32 v5, 1
    v_lshlrev_b32 v6, 10, v2
    s_lshl_b32 s9, s5, 9
    s_add_u32 s9, s9, 20121600
    s_lshl3_add_u32 s8, s10, s66
    s_lshl_b32 s7, s5, 12
    s_add_u32 s8, s8, s7
    s_lshl_b32 s8, s8, 2
    s_add_u32 s8, s8, 24711936
    s_waitcnt vmcnt(14)
    s_barrier
    s_cmp_lg_u32 s64, 0
    s_cbranch_scc1 kf_s1_a
    s_mov_b64 exec, 0xffff
    buffer_store_dword v5, v6, s[48:51], s8 offen sc1
    s_mov_b64 exec, 1
    buffer_atomic_add v5, v6, s[48:51], s9 offen sc1
    s_mov_b64 exec, -1
kf_s1_a:
    v_mov_b32 v128, 0x3f803f80
    v_mov_b32 v129, 0x3f803f80
    v_mov_b32 v130, 0x3f803f80
    v_mov_b32 v131, 0x3f803f80
    s_mul_i32 s72, s14, 163840
    s_mul_i32 s75, s64, 5120
    s_add_u32 s72, s72, s75
    s_add_u32 s72, s72, 5242880
    v_add_u32 v8, s72, v17
    v_add_u32 v9, s75, v17
    s_mul_i32 s75, s64, 3
    s_add_u32 s76, s75, 0
    s_lshr_b32 s77, s76, 2
    s_lshl_b32 s77, s77, 10
    s_and_b32 s76, s76, 3
    s_lshl_b32 s76, s76, 2
    s_add_u32 s76, s76, s77
    s_add_u32 s76, s76, 102400
    v_add_u32 v10, s76, v17
    s_add_u32 s76, s75, 1
    s_lshr_b32 s77, s76, 2
    s_lshl_b32 s77, s77, 10
    s_and_b32 s76, s76, 3
    s_lshl_b32 s76, s76, 2
    s_add_u32 s76, s76, s77
    s_add_u32 s76, s76, 102400
    v_add_u32 v11, s76, v17
    s_add_u32 s76, s75, 2
    s_lshr_b32 s77, s76, 2
    s_lshl_b32 s77, s77, 10
    s_and_b32 s76, s76, 3
    s_lshl_b32 s76, s76, 2
    s_add_u32 s76, s76, s77
    s_add_u32 s76, s76, 102400
    v_add_u32 v12, s76, v17
    s_lshl_b32 s76, s64, 10
    s_add_u32 s77, s76, 102400
    v_add_u32 v13, s77, v17
    s_mul_i32 s77, s14, 393216
    s_add_u32 s77, s77, s76
    s_mul_i32 s78, s15, 3072
    s_add_u32 s77, s77, s78
    s_add_u32 s77, s77, 7864320
    v_add_u32 v14, s77, v17
    v_lshlrev_b32 v15, 4, v2
    v_add_u32 v15, 111616, v15
    s_lshl_b32 s76, s14, 13
    s_lshl_b32 s77, s64, 11
    s_add_u32 s76, s76, s77
    s_add_u32 s76, s76, 20140032
    v_lshlrev_b32 v16, 5, v1
    v_add_u32 v16, s76, v16
    s_mul_i32 s69, s64, 12288
    s_mul_i32 s76, s65, 196608
    s_add_u32 s76, s69, s76
    s_add_u32 s86, s76, 7864320
    s_add_u32 s87, s76, 7868416
    s_add_u32 s88, s76, 7872512
    s_add_u32 s89, s76, 7913472
    s_add_u32 s90, s76, 7917568
    s_add_u32 s91, s76, 7921664
    s_add_u32 s92, s76, 7962624
    s_add_u32 s93, s76, 7966720
    s_add_u32 s44, s76, 7970816
    s_add_u32 s45, s76, 8011776
    s_add_u32 s46, s76, 8015872
    s_add_u32 s47, s76, 8019968
    s_add_u32 s69, s69, 113664
    s_lshl_b32 s70, s5, 9
    s_add_u32 s70, s70, 20121600
    s_mov_b32 s83, 0xc0135761
    s_mov_b32 s84, 0xbdd2d3e8
    v_add_u32 v9, 4096, v8
    v_add_u32 v81, 61440, v17
    s_mul_i32 s85, s64, 5120
    s_mov_b32 s40, 196608
    s_mov_b32 s41, 49152
    s_mov_b32 s42, 245760
    s_mov_b32 s43, 98304
    s_mov_b32 s68, 294912
    s_cmp_lg_u32 s64, 3
    s_cselect_b64 vcc, -1, 0
    s_lshl4_add_u32 s9, s14, s15
    s_lshl_b32 s9, s9, 10
    s_add_u32 s9, s9, 24711936
    s_mov_b32 s7, 0
    s_load_dwordx16 s[16:31], s[38:39], s9 glc
    s_add_u32 s12, s11, 55296
    buffer_load_dwordx4 a[120:123], v17, s[48:51], s12 offen sc1
    v_mfma_f32_16x16x32_bf16 v[52:55], a[124:127], v[128:131], 0
    v_mfma_f32_16x16x32_bf16 v[56:59], a[128:131], v[128:131], 0
    v_mfma_f32_16x16x32_bf16 v[60:63], a[132:135], v[128:131], 0
    s_add_u32 s12, s11, 15360
    buffer_load_dwordx4 a[0:3], v17, s[48:51], s12 offen sc1
    v_mfma_f32_16x16x32_bf16 v[52:55], a[136:139], v[128:131], v[52:55]
    v_mfma_f32_16x16x32_bf16 v[56:59], a[140:143], v[128:131], v[56:59]
    v_mfma_f32_16x16x32_bf16 v[60:63], a[144:147], v[128:131], v[60:63]
    s_add_u32 s12, s11, 35840
    buffer_load_dwordx4 a[4:7], v17, s[48:51], s12 offen sc1
    v_mfma_f32_16x16x32_bf16 v[52:55], a[148:151], v[128:131], v[52:55]
    v_mfma_f32_16x16x32_bf16 v[56:59], a[152:155], v[128:131], v[56:59]
    v_mfma_f32_16x16x32_bf16 v[60:63], a[156:159], v[128:131], v[60:63]
    s_add_u32 s12, s11, 56320
    buffer_load_dwordx4 a[8:11], v17, s[48:51], s12 offen sc1
    v_mfma_f32_16x16x32_bf16 v[52:55], a[160:163], v[128:131], v[52:55]
    v_mfma_f32_16x16x32_bf16 v[56:59], a[164:167], v[128:131], v[56:59]
    v_mfma_f32_16x16x32_bf16 v[60:63], a[168:171], v[128:131], v[60:63]
    s_add_u32 s12, s11, 16384
    buffer_load_dwordx4 a[12:15], v17, s[48:51], s12 offen sc1
    v_mfma_f32_16x16x32_bf16 v[52:55], a[172:175], v[128:131], v[52:55]
    v_mfma_f32_16x16x32_bf16 v[56:59], a[176:179], v[128:131], v[56:59]
    v_mfma_f32_16x16x32_bf16 v[60:63], a[180:183], v[128:131], v[60:63]
    s_add_u32 s12, s11, 36864
    buffer_load_dwordx4 a[16:19], v17, s[48:51], s12 offen sc1
    v_mfma_f32_16x16x32_bf16 v[52:55], a[184:187], v[128:131], v[52:55]
    v_mfma_f32_16x16x32_bf16 v[56:59], a[188:191], v[128:131], v[56:59]
    v_mfma_f32_16x16x32_bf16 v[60:63], a[192:195], v[128:131], v[60:63]
    s_add_u32 s12, s11, 57344
    buffer_load_dwordx4 a[20:23], v17, s[48:51], s12 offen sc1
    v_mfma_f32_16x16x32_bf16 v[52:55], a[196:199], v[128:131], v[52:55]
    v_mfma_f32_16x16x32_bf16 v[56:59], a[200:203], v[128:131], v[56:59]
    v_mfma_f32_16x16x32_bf16 v[60:63], a[204:207], v[128:131], v[60:63]
    s_add_u32 s12, s11, 17408
    buffer_load_dwordx4 a[24:27], v17, s[48:51], s12 offen sc1
    v_mfma_f32_16x16x32_bf16 v[52:55], a[208:211], v[128:131], v[52:55]
    v_mfma_f32_16x16x32_bf16 v[56:59], a[212:215], v[128:131], v[56:59]
    v_mfma_f32_16x16x32_bf16 v[60:63], a[216:219], v[128:131], v[60:63]
    s_cmp_eq_u32 s7, -1
    s_cbranch_scc1 kf_s1_k0
    s_waitcnt lgkmcnt(0)
    s_or_b64 s[16:17], s[16:17], s[18:19]
    s_or_b64 s[20:21], s[20:21], s[22:23]
    s_or_b64 s[24:25], s[24:25], s[26:27]
    s_or_b64 s[28:29], s[28:29], s[30:31]
    s_or_b64 s[16:17], s[16:17], s[20:21]
    s_or_b64 s[24:25], s[24:25], s[28:29]
    s_or_b64 s[16:17], s[16:17], s[24:25]
    s_or_b32 s16, s16, s17
    s_cmp_eq_u32 s16, 1
    s_load_dwordx16 s[16:31], s[38:39], s9 glc
    s_cbranch_scc0 kf_s1_k0
    buffer_load_dwordx4 v[40:43], v16, s[48:51], 0 offen sc1
    buffer_load_dwordx4 v[44:47], v16, s[48:51], 0 offen offset:16 sc1
    s_add_u32 m0, s85, 0
    s_mov_b32 s80, 0
    buffer_load_dwordx4 v8, s[48:51], s80 offen offset:0 sc1 lds
    buffer_load_dwordx4 v8, s[48:51], s80 offen offset:1024 sc1 lds
    buffer_load_dwordx4 v8, s[48:51], s80 offen offset:2048 sc1 lds
    buffer_load_dwordx4 v8, s[48:51], s80 offen offset:3072 sc1 lds
    s_add_u32 m0, s85, 4096
    s_nop 0
    buffer_load_dwordx4 v9, s[48:51], s80 offen offset:0 sc1 lds
    s_mov_b32 s7, -1
kf_s1_k0:
    s_add_u32 s12, s11, 37888
    buffer_load_dwordx4 a[28:31], v17, s[48:51], s12 offen sc1
    v_mfma_f32_16x16x32_bf16 v[52:55], a[220:223], v[128:131], v[52:55]
    v_mfma_f32_16x16x32_bf16 v[56:59], a[224:227], v[128:131], v[56:59]
    v_mfma_f32_16x16x32_bf16 v[60:63], a[228:231], v[128:131], v[60:63]
    s_add_u32 s12, s11, 58368
    buffer_load_dwordx4 a[32:35], v17, s[48:51], s12 offen sc1
    v_mfma_f32_16x16x32_bf16 v[52:55], a[232:235], v[128:131], v[52:55]
    v_mfma_f32_16x16x32_bf16 v[56:59], a[236:239], v[128:131], v[56:59]
    v_mfma_f32_16x16x32_bf16 v[60:63], a[240:243], v[128:131], v[60:63]
    s_add_u32 s12, s11, 18432
    buffer_load_dwordx4 a[36:39], v17, s[48:51], s12 offen sc1
    s_waitcnt vmcnt(23)
    v_mfma_f32_16x16x32_bf16 v[52:55], a[244:247], v[128:131], v[52:55]
    s_add_u32 s12, s11, 38912
    buffer_load_dwordx4 a[40:43], v17, s[48:51], s12 offen sc1
    v_mfma_f32_16x16x32_bf16 v[56:59], a[248:251], v[128:131], v[56:59]
    s_add_u32 s12, s11, 59392
    buffer_load_dwordx4 a[44:47], v17, s[48:51], s12 offen sc1
    s_waitcnt vmcnt(23)
    v_mfma_f32_16x16x32_bf16 v[60:63], a[252:255], v[128:131], v[60:63]
    s_add_u32 s12, s11, 19456
    buffer_load_dwordx4 a[48:51], v17, s[48:51], s12 offen sc1
    v_mfma_f32_16x16x32_bf16 v[52:55], a[60:63], v[128:131], v[52:55]
    s_add_u32 s12, s11, 39936
    buffer_load_dwordx4 a[52:55], v17, s[48:51], s12 offen sc1
    s_waitcnt vmcnt(23)
    v_mfma_f32_16x16x32_bf16 v[56:59], a[80:83], v[128:131], v[56:59]
    s_add_u32 s12, s11, 60416
    buffer_load_dwordx4 a[56:59], v17, s[48:51], s12 offen sc1
    v_mfma_f32_16x16x32_bf16 v[60:63], a[84:87], v[128:131], v[60:63]
    s_cmp_eq_u32 s7, -1
    s_cbranch_scc1 kf_s1_b
kf_s1_poll:
    s_waitcnt lgkmcnt(0)
    s_or_b64 s[16:17], s[16:17], s[18:19]
    s_or_b64 s[20:21], s[20:21], s[22:23]
    s_or_b64 s[24:25], s[24:25], s[26:27]
    s_or_b64 s[28:29], s[28:29], s[30:31]
    s_or_b64 s[16:17], s[16:17], s[20:21]
    s_or_b64 s[24:25], s[24:25], s[28:29]
    s_or_b64 s[16:17], s[16:17], s[24:25]
    s_or_b32 s16, s16, s17
    s_cmp_eq_u32 s16, 1
    s_cbranch_scc1 kf_s1_done
    s_sleep 1
    s_load_dwordx16 s[16:31], s[38:39], s9 glc
    s_add_u32 s7, s7, 1
    s_cmp_lt_u32 s7, 65536
    s_cbranch_scc1 kf_s1_poll
kf_s1_done:
    buffer_load_dwordx4 v[40:43], v16, s[48:51], 0 offen sc1
    buffer_load_dwordx4 v[44:47], v16, s[48:51], 0 offen offset:16 sc1
    s_add_u32 m0, s85, 0
    s_mov_b32 s80, 0
    buffer_load_dwordx4 v8, s[48:51], s80 offen offset:0 sc1 lds
    buffer_load_dwordx4 v8, s[48:51], s80 offen offset:1024 sc1 lds
    buffer_load_dwordx4 v8, s[48:51], s80 offen offset:2048 sc1 lds
    buffer_load_dwordx4 v8, s[48:51], s80 offen offset:3072 sc1 lds
    s_add_u32 m0, s85, 4096
    s_nop 0
    buffer_load_dwordx4 v9, s[48:51], s80 offen offset:0 sc1 lds
kf_s1_b:
    s_add_u32 m0, s85, 20480
    s_mov_b32 s80, 81920
    buffer_load_dwordx4 v8, s[48:51], s80 offen offset:0 sc1 lds
    s_waitcnt vmcnt(23)
    v_mfma_f32_16x16x32_bf16 v[52:55], a[88:91], v[128:131], v[52:55]
    buffer_load_dwordx4 v8, s[48:51], s80 offen offset:1024 sc1 lds
    v_mfma_f32_16x16x32_bf16 v[56:59], a[92:95], v[128:131], v[56:59]
    buffer_load_dwordx4 v8, s[48:51], s80 offen offset:2048 sc1 lds
    s_waitcnt vmcnt(23)
    v_mfma_f32_16x16x32_bf16 v[60:63], a[96:99], v[128:131], v[60:63]
    buffer_load_dwordx4 v8, s[48:51], s80 offen offset:3072 sc1 lds
    s_add_u32 m0, s85, 24576
    s_nop 0
    v_mfma_f32_16x16x32_bf16 v[52:55], a[100:103], v[128:131], v[52:55]
    buffer_load_dwordx4 v9, s[48:51], s80 offen offset:0 sc1 lds
    s_waitcnt vmcnt(23)
    v_mfma_f32_16x16x32_bf16 v[56:59], a[104:107], v[128:131], v[56:59]
    s_branch kf_pw_k3_o
kf_pw_k3:
    s_branch kf_pw_k_ret
kf_pw_k3_o:
    s_waitcnt lgkmcnt(0)
    s_add_u32 s16, s13, 0
    s_add_u32 s17, s13, 4096
    s_add_u32 s18, s13, 8192
    s_add_u32 s19, s13, 49152
    s_add_u32 s20, s13, 53248
    s_add_u32 s21, s13, 57344
    s_add_u32 s22, s13, 98304
    s_add_u32 s23, s13, 102400
    s_add_u32 s24, s13, 106496
    s_add_u32 s25, s13, 147456
    s_add_u32 s26, s13, 151552
    s_add_u32 s27, s13, 155648
    s_add_u32 s28, s13, 196608
    s_add_u32 s29, s13, 200704
    s_add_u32 s30, s13, 204800
    s_mov_b32 s31, 102400
    s_mov_b32 s32, 40960
    s_mov_b32 s33, 122880
    s_mov_b32 s34, 61440
    s_mov_b32 s35, 143360
    v_add_u32 v16, s69, v17
    v_mfma_f32_16x16x32_bf16 v[60:63], a[108:111], v[128:131], v[60:63]
    s_waitcnt vmcnt(21)
    v_mfma_f32_16x16x32_bf16 v[52:55], a[112:115], v[128:131], v[52:55]
    v_mfma_f32_16x16x32_bf16 v[56:59], a[116:119], v[128:131], v[56:59]
    s_waitcnt vmcnt(19)
    v_mfma_f32_16x16x32_bf16 v[60:63], a[120:123], v[128:131], v[60:63]
    v_mfma_f32_16x16x32_bf16 v[52:55], a[0:3], v[128:131], v[52:55]
    s_waitcnt vmcnt(17)
    v_mfma_f32_16x16x32_bf16 v[56:59], a[4:7], v[128:131], v[56:59]
    v_mfma_f32_16x16x32_bf16 v[60:63], a[8:11], v[128:131], v[60:63]
    s_waitcnt vmcnt(15)
    v_mfma_f32_16x16x32_bf16 v[52:55], a[12:15], v[128:131], v[52:55]
    v_mfma_f32_16x16x32_bf16 v[56:59], a[16:19], v[128:131], v[56:59]
    s_waitcnt vmcnt(13)
    v_mfma_f32_16x16x32_bf16 v[60:63], a[20:23], v[128:131], v[60:63]
    v_mfma_f32_16x16x32_bf16 v[52:55], a[24:27], v[128:131], v[52:55]
    s_waitcnt vmcnt(11)
    v_mfma_f32_16x16x32_bf16 v[56:59], a[28:31], v[128:131], v[56:59]
    v_mfma_f32_16x16x32_bf16 v[60:63], a[32:35], v[128:131], v[60:63]
    s_waitcnt vmcnt(9)
    v_mfma_f32_16x16x32_bf16 v[52:55], a[36:39], v[128:131], v[52:55]
    v_mfma_f32_16x16x32_bf16 v[56:59], a[40:43], v[128:131], v[56:59]
    s_waitcnt vmcnt(7)
    v_mfma_f32_16x16x32_bf16 v[60:63], a[44:47], v[128:131], v[60:63]
    v_mfma_f32_16x16x32_bf16 v[52:55], a[48:51], v[128:131], v[52:55]
    s_waitcnt vmcnt(5)
    v_mfma_f32_16x16x32_bf16 v[56:59], a[52:55], v[128:131], v[56:59]
    v_mfma_f32_16x16x32_bf16 v[60:63], a[56:59], v[128:131], v[60:63]
    s_waitcnt vmcnt(5)
    s_nop 1
    s_waitcnt lgkmcnt(0)
    s_barrier
    ds_read_b128 v[128:131], v17 offset:0
    ds_read_b128 v[132:135], v17 offset:1024
    ds_read_b128 v[136:139], v17 offset:2048
    ds_read_b128 v[140:143], v17 offset:3072
    s_waitcnt lgkmcnt(3)
    v_mfma_f32_16x16x32_bf16 v[28:31], a[124:127], v[128:131], 0
    ds_read_b128 v[144:147], v17 offset:4096
    v_mfma_f32_16x16x32_bf16 v[32:35], a[128:131], v[128:131], 0
    s_add_u32 m0, s85, 40960
    s_mov_b32 s80, 20480
    buffer_load_dwordx4 v8, s[48:51], s80 offen offset:0 sc1 lds
    v_mfma_f32_16x16x32_bf16 v[36:39], a[132:135], v[128:131], 0
    s_waitcnt lgkmcnt(3)
    v_add_f32 v40, v40, v42
    v_add_f32 v41, v41, v43
    v_mfma_f32_16x16x32_bf16 v[28:31], a[136:139], v[132:135], v[28:31]
    ds_read_b128 v[128:131], v17 offset:5120
    v_add_f32 v44, v44, v46
    v_mfma_f32_16x16x32_bf16 v[32:35], a[140:143], v[132:135], v[32:35]
    buffer_load_dwordx4 v8, s[48:51], s80 offen offset:1024 sc1 lds
    v_mfma_f32_16x16x32_bf16 v[36:39], a[144:147], v[132:135], v[36:39]
    s_waitcnt lgkmcnt(3)
    v_add_f32 v45, v45, v47
    v_add_f32 v40, v40, v44
    v_mfma_f32_16x16x32_bf16 v[28:31], a[148:151], v[136:139], v[28:31]
    ds_read_b128 v[132:135], v17 offset:6144
    v_add_f32 v41, v41, v45
    v_mfma_f32_16x16x32_bf16 v[32:35], a[152:155], v[136:139], v[32:35]
    v_lshrrev_b32 v46, 1, v1
    v_lshlrev_b32 v46, 4, v46
    v_mfma_f32_16x16x32_bf16 v[36:39], a[156:159], v[136:139], v[36:39]
    s_waitcnt lgkmcnt(3)
    v_add_f32_dpp v42, v40, v40 quad_perm:[1,0,3,2] row_mask:0xf bank_mask:0xf
    v_add_f32_dpp v43, v41, v41 quad_perm:[1,0,3,2] row_mask:0xf bank_mask:0xf
    v_mfma_f32_16x16x32_bf16 v[28:31], a[160:163], v[140:143], v[28:31]
    ds_read_b128 v[136:139], v17 offset:7168
    v_mul_f32 v42, 0x3acccccd, v42
    v_mfma_f32_16x16x32_bf16 v[32:35], a[164:167], v[140:143], v[32:35]
    buffer_load_dwordx4 v8, s[48:51], s80 offen offset:2048 sc1 lds
    v_mfma_f32_16x16x32_bf16 v[36:39], a[168:171], v[140:143], v[36:39]
    s_waitcnt lgkmcnt(3)
    v_mul_f32 v43, 0x3acccccd, v43
    v_fma_f32 v43, -v42, v42, v43
    v_mfma_f32_16x16x32_bf16 v[28:31], a[172:175], v[144:147], v[28:31]
    ds_read_b128 v[140:143], v17 offset:8192
    v_max_f32 v43, 0, v43
    v_mfma_f32_16x16x32_bf16 v[32:35], a[176:179], v[144:147], v[32:35]
    buffer_load_dwordx4 v8, s[48:51], s80 offen offset:3072 sc1 lds
    s_add_u32 m0, s85, 45056
    s_nop 0
    v_mfma_f32_16x16x32_bf16 v[36:39], a[180:183], v[144:147], v[36:39]
    s_waitcnt lgkmcnt(3)
    v_cvt_pk_bf16_f32 v42, v42, v42
    v_lshlrev_b32 v42, 16, v42
    v_mfma_f32_16x16x32_bf16 v[28:31], a[184:187], v[128:131], v[28:31]
    ds_read_b128 v[144:147], v17 offset:9216
    v_sub_f32 v48, 0, v42
    v_mfma_f32_16x16x32_bf16 v[32:35], a[188:191], v[128:131], v[32:35]
    v_cvt_pk_bf16_f32 v43, v43, v43
    v_lshlrev_b32 v43, 16, v43
    v_mfma_f32_16x16x32_bf16 v[36:39], a[192:195], v[128:131], v[36:39]
    s_waitcnt lgkmcnt(3)
    v_add_f32 v43, 0x3727c5ac, v43
    v_cvt_pk_bf16_f32 v43, v43, v43
    v_mfma_f32_16x16x32_bf16 v[28:31], a[196:199], v[132:135], v[28:31]
    ds_read_b128 v[128:131], v17 offset:10240
    v_lshlrev_b32 v43, 16, v43
    v_mfma_f32_16x16x32_bf16 v[32:35], a[200:203], v[132:135], v[32:35]
    buffer_load_dwordx4 v9, s[48:51], s80 offen offset:0 sc1 lds
    v_mfma_f32_16x16x32_bf16 v[36:39], a[204:207], v[132:135], v[36:39]
    s_waitcnt lgkmcnt(3)
    v_sqrt_f32 v43, v43
    s_lshl_b32 s76, s64, 9
    v_mfma_f32_16x16x32_bf16 v[28:31], a[208:211], v[136:139], v[28:31]
    ds_read_b128 v[132:135], v17 offset:11264
    v_cvt_pk_bf16_f32 v43, v43, v43
    v_mfma_f32_16x16x32_bf16 v[32:35], a[212:215], v[136:139], v[32:35]
    v_lshlrev_b32 v43, 16, v43
    v_mfma_f32_16x16x32_bf16 v[36:39], a[216:219], v[136:139], v[36:39]
    s_waitcnt lgkmcnt(3)
    v_rcp_f32 v42, v43
    v_mfma_f32_16x16x32_bf16 v[28:31], a[220:223], v[140:143], v[28:31]
    ds_read_b128 v[136:139], v17 offset:12288
    v_mul_f32 v51, v43, v43
    v_mfma_f32_16x16x32_bf16 v[32:35], a[224:227], v[140:143], v[32:35]
    buffer_load_dwordx4 v[148:151], v17, s[48:51], s16 offen offset:0 sc1
    v_mfma_f32_16x16x32_bf16 v[36:39], a[228:231], v[140:143], v[36:39]
    s_waitcnt lgkmcnt(3)
    v_mul_f32 v49, s83, v42
    v_mul_f32 v50, v42, v42
    v_mfma_f32_16x16x32_bf16 v[28:31], a[232:235], v[144:147], v[28:31]
    ds_read_b128 v[140:143], v17 offset:13312
    v_mul_f32 v50, v50, v42
    v_mfma_f32_16x16x32_bf16 v[32:35], a[236:239], v[144:147], v[32:35]
    buffer_load_dwordx4 v[152:155], v17, s[48:51], s19 offen offset:0 sc1
    v_mfma_f32_16x16x32_bf16 v[36:39], a[240:243], v[144:147], v[36:39]
    s_waitcnt lgkmcnt(3)
    v_mul_f32 v50, s84, v50
    s_add_u32 s76, s76, 111616
    v_add_u32 v46, s76, v46
    v_mfma_f32_16x16x32_bf16 v[28:31], a[244:247], v[128:131], v[28:31]
    ds_read_b128 v[144:147], v17 offset:14336
    v_mfma_f32_16x16x32_bf16 v[32:35], a[248:251], v[128:131], v[32:35]
    ds_write_b128 v46, v[48:51]
    v_mfma_f32_16x16x32_bf16 v[36:39], a[252:255], v[128:131], v[36:39]
    s_waitcnt lgkmcnt(4)
    v_mfma_f32_16x16x32_bf16 v[28:31], a[60:63], v[132:135], v[28:31]
    ds_read_b128 v[128:131], v17 offset:15360
    v_mfma_f32_16x16x32_bf16 v[32:35], a[80:83], v[132:135], v[32:35]
    buffer_load_dwordx4 v[156:159], v17, s[48:51], s22 offen offset:0 sc1
    v_mfma_f32_16x16x32_bf16 v[36:39], a[84:87], v[132:135], v[36:39]
    s_waitcnt lgkmcnt(4)
    v_mfma_f32_16x16x32_bf16 v[28:31], a[88:91], v[136:139], v[28:31]
    ds_read_b128 v[132:135], v17 offset:16384
    v_mfma_f32_16x16x32_bf16 v[32:35], a[92:95], v[136:139], v[32:35]
    v_mfma_f32_16x16x32_bf16 v[36:39], a[96:99], v[136:139], v[36:39]
    s_waitcnt lgkmcnt(4)
    v_mfma_f32_16x16x32_bf16 v[28:31], a[100:103], v[140:143], v[28:31]
    ds_read_b128 v[136:139], v17 offset:17408
    v_mfma_f32_16x16x32_bf16 v[32:35], a[104:107], v[140:143], v[32:35]
    buffer_load_dwordx4 v[160:163], v17, s[48:51], s25 offen offset:0 sc1
    v_mfma_f32_16x16x32_bf16 v[36:39], a[108:111], v[140:143], v[36:39]
    s_waitcnt lgkmcnt(4)
    v_mfma_f32_16x16x32_bf16 v[28:31], a[112:115], v[144:147], v[28:31]
    ds_read_b128 v[140:143], v17 offset:18432
    v_mfma_f32_16x16x32_bf16 v[32:35], a[116:119], v[144:147], v[32:35]
    buffer_load_dwordx4 v[164:167], v17, s[48:51], s28 offen offset:0 sc1
    v_mfma_f32_16x16x32_bf16 v[36:39], a[120:123], v[144:147], v[36:39]
    s_waitcnt lgkmcnt(3)
    v_mfma_f32_16x16x32_bf16 v[28:31], a[0:3], v[128:131], v[28:31]
    ds_read_b128 v[144:147], v17 offset:19456
    v_mfma_f32_16x16x32_bf16 v[32:35], a[4:7], v[128:131], v[32:35]
    s_waitcnt vmcnt(10)
    s_barrier
    v_mfma_f32_16x16x32_bf16 v[36:39], a[8:11], v[128:131], v[36:39]
    s_waitcnt lgkmcnt(3)
    v_mfma_f32_16x16x32_bf16 v[28:31], a[12:15], v[132:135], v[28:31]
    ds_read_b128 v[128:131], v17 offset:20480
    v_mfma_f32_16x16x32_bf16 v[32:35], a[16:19], v[132:135], v[32:35]
    ds_read_b128 v[64:67], v15 offset:0
    v_mfma_f32_16x16x32_bf16 v[36:39], a[20:23], v[132:135], v[36:39]
    s_waitcnt lgkmcnt(4)
    v_mfma_f32_16x16x32_bf16 v[28:31], a[24:27], v[136:139], v[28:31]
    ds_read_b128 v[132:135], v17 offset:21504
    v_mfma_f32_16x16x32_bf16 v[32:35], a[28:31], v[136:139], v[32:35]
    v_mfma_f32_16x16x32_bf16 v[36:39], a[32:35], v[136:139], v[36:39]
    s_waitcnt lgkmcnt(4)
    v_mfma_f32_16x16x32_bf16 v[28:31], a[36:39], v[140:143], v[28:31]
    ds_read_b128 v[136:139], v17 offset:22528
    v_mfma_f32_16x16x32_bf16 v[32:35], a[40:43], v[140:143], v[32:35]
    buffer_load_dwordx4 v[168:171], v17, s[48:51], s16 offen offset:1024 sc1
    v_mfma_f32_16x16x32_bf16 v[36:39], a[44:47], v[140:143], v[36:39]
    s_waitcnt lgkmcnt(4)
    v_mfma_f32_16x16x32_bf16 v[28:31], a[48:51], v[144:147], v[28:31]
    ds_read_b128 v[140:143], v17 offset:23552
    v_mfma_f32_16x16x32_bf16 v[32:35], a[52:55], v[144:147], v[32:35]
    v_mfma_f32_16x16x32_bf16 v[36:39], a[56:59], v[144:147], v[36:39]
    s_waitcnt lgkmcnt(4)
    v_mfma_f32_16x16x32_bf16 v[40:43], a[124:127], v[128:131], 0
    ds_read_b128 v[144:147], v17 offset:24576
    v_mfma_f32_16x16x32_bf16 v[44:47], a[128:131], v[128:131], 0
    s_add_u32 m0, s85, 61440
    s_nop 0
    buffer_load_dwordx4 v8, s[48:51], s31 offen offset:0 sc1 lds
    v_mfma_f32_16x16x32_bf16 v[48:51], a[132:135], v[128:131], 0
    s_waitcnt lgkmcnt(3)
    v_mfma_f32_16x16x32_bf16 v[40:43], a[136:139], v[132:135], v[40:43]
    ds_read_b128 v[128:131], v17 offset:25600
    v_fma_f32 v28, v52, v64, v28
    v_mfma_f32_16x16x32_bf16 v[44:47], a[140:143], v[132:135], v[44:47]
    buffer_load_dwordx4 v8, s[48:51], s31 offen offset:1024 sc1 lds
    v_mfma_f32_16x16x32_bf16 v[48:51], a[144:147], v[132:135], v[48:51]
    s_waitcnt lgkmcnt(3)
    v_mul_f32 v72, v28, v28
    v_fma_f32 v72, v72, v66, v65
    v_mfma_f32_16x16x32_bf16 v[40:43], a[148:151], v[136:139], v[40:43]
    ds_read_b128 v[132:135], v17 offset:26624
    v_mul_f32 v72, v72, v28
    v_fma_f32 v30, v54, v64, v30
    v_mfma_f32_16x16x32_bf16 v[44:47], a[152:155], v[136:139], v[44:47]
    v_exp_f32 v72, v72
    v_mfma_f32_16x16x32_bf16 v[48:51], a[156:159], v[136:139], v[48:51]
    s_waitcnt lgkmcnt(3)
    v_fma_f32 v72, v72, v67, v67
    v_mul_f32 v30, v30, v28
    v_mfma_f32_16x16x32_bf16 v[40:43], a[160:163], v[140:143], v[40:43]
    ds_read_b128 v[136:139], v17 offset:27648
    v_fma_f32 v29, v53, v64, v29
    v_mfma_f32_16x16x32_bf16 v[44:47], a[164:167], v[140:143], v[44:47]
    buffer_load_dwordx4 v8, s[48:51], s31 offen offset:2048 sc1 lds
    v_mfma_f32_16x16x32_bf16 v[48:51], a[168:171], v[140:143], v[48:51]
    s_waitcnt lgkmcnt(3)
    v_rcp_f32 v72, v72
    v_mul_f32 v73, v29, v29
    v_mfma_f32_16x16x32_bf16 v[40:43], a[172:175], v[144:147], v[40:43]
    ds_read_b128 v[140:143], v17 offset:28672
    v_mul_f32 v30, v30, v72
    v_mfma_f32_16x16x32_bf16 v[44:47], a[176:179], v[144:147], v[44:47]
    buffer_load_dwordx4 v8, s[48:51], s31 offen offset:3072 sc1 lds
    s_add_u32 m0, s85, 65536
    v_mfma_f32_16x16x32_bf16 v[48:51], a[180:183], v[144:147], v[48:51]
    s_waitcnt lgkmcnt(3)
    v_fma_f32 v73, v73, v66, v65
    v_mul_f32 v73, v73, v29
    v_mfma_f32_16x16x32_bf16 v[40:43], a[184:187], v[128:131], v[40:43]
    ds_read_b128 v[144:147], v17 offset:29696
    v_fma_f32 v31, v55, v64, v31
    v_mfma_f32_16x16x32_bf16 v[44:47], a[188:191], v[128:131], v[44:47]
    v_exp_f32 v73, v73
    v_mfma_f32_16x16x32_bf16 v[48:51], a[192:195], v[128:131], v[48:51]
    s_waitcnt lgkmcnt(3)
    v_fma_f32 v73, v73, v67, v67
    v_rcp_f32 v73, v73
    v_mfma_f32_16x16x32_bf16 v[40:43], a[196:199], v[132:135], v[40:43]
    ds_read_b128 v[128:131], v17 offset:30720
    v_mul_f32 v31, v31, v29
    v_mfma_f32_16x16x32_bf16 v[44:47], a[200:203], v[132:135], v[44:47]
    buffer_load_dwordx4 v9, s[48:51], s31 offen offset:0 sc1 lds
    v_mfma_f32_16x16x32_bf16 v[48:51], a[204:207], v[132:135], v[48:51]
    s_waitcnt lgkmcnt(3)
    v_mul_f32 v31, v31, v73
    v_cvt_pk_bf16_f32 v78, v30, v31
    v_mfma_f32_16x16x32_bf16 v[40:43], a[208:211], v[136:139], v[40:43]
    ds_read_b128 v[132:135], v17 offset:31744
    v_fma_f32 v32, v56, v64, v32
    v_mfma_f32_16x16x32_bf16 v[44:47], a[212:215], v[136:139], v[44:47]
    buffer_load_dwordx4 v[172:175], v17, s[48:51], s19 offen offset:1024 sc1
    v_mfma_f32_16x16x32_bf16 v[48:51], a[216:219], v[136:139], v[48:51]
    s_waitcnt lgkmcnt(3)
    ds_write_b32 v10, v78 offset:0
    v_mfma_f32_16x16x32_bf16 v[40:43], a[220:223], v[140:143], v[40:43]
    ds_read_b128 v[136:139], v17 offset:32768
    v_mul_f32 v74, v32, v32
    v_fma_f32 v74, v74, v66, v65
    v_mfma_f32_16x16x32_bf16 v[44:47], a[224:227], v[140:143], v[44:47]
    v_mul_f32 v74, v74, v32
    v_fma_f32 v34, v58, v64, v34
    v_mfma_f32_16x16x32_bf16 v[48:51], a[228:231], v[140:143], v[48:51]
    s_waitcnt lgkmcnt(4)
    v_exp_f32 v74, v74
    v_mfma_f32_16x16x32_bf16 v[40:43], a[232:235], v[144:147], v[40:43]
    ds_read_b128 v[140:143], v17 offset:33792
    v_fma_f32 v74, v74, v67, v67
    v_mfma_f32_16x16x32_bf16 v[44:47], a[236:239], v[144:147], v[44:47]
    buffer_load_dwordx4 v[176:179], v17, s[48:51], s22 offen offset:1024 sc1
    v_mfma_f32_16x16x32_bf16 v[48:51], a[240:243], v[144:147], v[48:51]
    s_waitcnt lgkmcnt(4)
    v_rcp_f32 v74, v74
    v_mul_f32 v34, v34, v32
    v_mfma_f32_16x16x32_bf16 v[40:43], a[244:247], v[128:131], v[40:43]
    ds_read_b128 v[144:147], v17 offset:34816
    v_mul_f32 v34, v34, v74
    v_mfma_f32_16x16x32_bf16 v[44:47], a[248:251], v[128:131], v[44:47]
    buffer_load_dwordx4 v[180:183], v17, s[48:51], s25 offen offset:1024 sc1
    v_mfma_f32_16x16x32_bf16 v[48:51], a[252:255], v[128:131], v[48:51]
    s_waitcnt lgkmcnt(4)
    v_fma_f32 v33, v57, v64, v33
    v_mul_f32 v75, v33, v33
    v_mfma_f32_16x16x32_bf16 v[40:43], a[60:63], v[132:135], v[40:43]
    ds_read_b128 v[128:131], v17 offset:35840
    v_fma_f32 v75, v75, v66, v65
    v_mfma_f32_16x16x32_bf16 v[44:47], a[80:83], v[132:135], v[44:47]
    v_mul_f32 v75, v75, v33
    v_fma_f32 v35, v59, v64, v35
    v_mfma_f32_16x16x32_bf16 v[48:51], a[84:87], v[132:135], v[48:51]
    s_waitcnt lgkmcnt(3)
    v_exp_f32 v75, v75
    v_mul_f32 v35, v35, v33
    v_mfma_f32_16x16x32_bf16 v[40:43], a[88:91], v[136:139], v[40:43]
    ds_read_b128 v[132:135], v17 offset:36864
    v_fma_f32 v75, v75, v67, v67
    v_mfma_f32_16x16x32_bf16 v[44:47], a[92:95], v[136:139], v[44:47]
    buffer_load_dwordx4 v[184:187], v17, s[48:51], s28 offen offset:1024 sc1
    v_mfma_f32_16x16x32_bf16 v[48:51], a[96:99], v[136:139], v[48:51]
    s_waitcnt lgkmcnt(3)
    v_rcp_f32 v75, v75
    v_mfma_f32_16x16x32_bf16 v[40:43], a[100:103], v[140:143], v[40:43]
    ds_read_b128 v[136:139], v17 offset:37888
    v_mul_f32 v35, v35, v75
    v_mfma_f32_16x16x32_bf16 v[44:47], a[104:107], v[140:143], v[44:47]
    buffer_load_dwordx4 v[188:191], v17, s[48:51], s16 offen offset:2048 sc1
    v_mfma_f32_16x16x32_bf16 v[48:51], a[108:111], v[140:143], v[48:51]
    s_waitcnt lgkmcnt(3)
    v_cvt_pk_bf16_f32 v79, v34, v35
    ds_write_b32 v11, v79 offset:0
    v_mfma_f32_16x16x32_bf16 v[40:43], a[112:115], v[144:147], v[40:43]
    ds_read_b128 v[140:143], v17 offset:38912
    v_fma_f32 v36, v60, v64, v36
    v_mfma_f32_16x16x32_bf16 v[44:47], a[116:119], v[144:147], v[44:47]
    v_mul_f32 v76, v36, v36
    v_fma_f32 v76, v76, v66, v65
    v_mfma_f32_16x16x32_bf16 v[48:51], a[120:123], v[144:147], v[48:51]
    s_waitcnt lgkmcnt(4)
    v_mul_f32 v76, v76, v36
    v_fma_f32 v38, v62, v64, v38
    v_mfma_f32_16x16x32_bf16 v[40:43], a[0:3], v[128:131], v[40:43]
    ds_read_b128 v[144:147], v17 offset:39936
    v_mul_f32 v38, v38, v36
    v_mfma_f32_16x16x32_bf16 v[44:47], a[4:7], v[128:131], v[44:47]
    s_waitcnt vmcnt(16)
    s_barrier
    v_exp_f32 v76, v76
    v_mfma_f32_16x16x32_bf16 v[48:51], a[8:11], v[128:131], v[48:51]
    s_waitcnt lgkmcnt(4)
    v_fma_f32 v76, v76, v67, v67
    v_fma_f32 v37, v61, v64, v37
    v_mfma_f32_16x16x32_bf16 v[40:43], a[12:15], v[132:135], v[40:43]
    ds_read_b128 v[128:131], v17 offset:40960
    v_mul_f32 v77, v37, v37
    v_mfma_f32_16x16x32_bf16 v[44:47], a[16:19], v[132:135], v[44:47]
    ds_read_b128 v[68:71], v15 offset:1024
    v_fma_f32 v77, v77, v66, v65
    v_mfma_f32_16x16x32_bf16 v[48:51], a[20:23], v[132:135], v[48:51]
    s_waitcnt lgkmcnt(5)
    v_rcp_f32 v76, v76
    v_mfma_f32_16x16x32_bf16 v[40:43], a[24:27], v[136:139], v[40:43]
    ds_read_b128 v[132:135], v17 offset:41984
    v_mul_f32 v38, v38, v76
    v_mul_f32 v77, v77, v37
    v_mfma_f32_16x16x32_bf16 v[44:47], a[28:31], v[136:139], v[44:47]
    buffer_load_dwordx4 v[192:195], v17, s[48:51], s19 offen offset:2048 sc1
    v_mfma_f32_16x16x32_bf16 v[48:51], a[32:35], v[136:139], v[48:51]
    s_waitcnt lgkmcnt(4)
    v_exp_f32 v77, v77
    v_mfma_f32_16x16x32_bf16 v[40:43], a[36:39], v[140:143], v[40:43]
    ds_read_b128 v[136:139], v17 offset:43008
    v_fma_f32 v77, v77, v67, v67
    v_mfma_f32_16x16x32_bf16 v[44:47], a[40:43], v[140:143], v[44:47]
    buffer_load_dwordx4 v[196:199], v17, s[48:51], s22 offen offset:2048 sc1
    v_mfma_f32_16x16x32_bf16 v[48:51], a[44:47], v[140:143], v[48:51]
    s_waitcnt lgkmcnt(4)
    v_rcp_f32 v77, v77
    v_mfma_f32_16x16x32_bf16 v[40:43], a[48:51], v[144:147], v[40:43]
    ds_read_b128 v[140:143], v17 offset:44032
    v_fma_f32 v39, v63, v64, v39
    v_mul_f32 v39, v39, v37
    v_mfma_f32_16x16x32_bf16 v[44:47], a[52:55], v[144:147], v[44:47]
    v_mul_f32 v39, v39, v77
    v_cvt_pk_bf16_f32 v80, v38, v39
    v_mfma_f32_16x16x32_bf16 v[48:51], a[56:59], v[144:147], v[48:51]
    s_waitcnt lgkmcnt(4)
    ds_write_b32 v12, v80 offset:0
    v_mfma_f32_16x16x32_bf16 v[28:31], a[124:127], v[128:131], 0
    ds_read_b128 v[144:147], v17 offset:45056
    v_mfma_f32_16x16x32_bf16 v[32:35], a[128:131], v[128:131], 0
    s_add_u32 m0, s85, 81920
    s_nop 0
    buffer_load_dwordx4 v8, s[48:51], s32 offen offset:0 sc1 lds
    v_mfma_f32_16x16x32_bf16 v[36:39], a[132:135], v[128:131], 0
    s_waitcnt lgkmcnt(4)
    v_mfma_f32_16x16x32_bf16 v[28:31], a[136:139], v[132:135], v[28:31]
    ds_read_b128 v[128:131], v17 offset:46080
    v_fma_f32 v40, v52, v68, v40
    v_mfma_f32_16x16x32_bf16 v[32:35], a[140:143], v[132:135], v[32:35]
    s_waitcnt vmcnt(8)
    s_waitcnt lgkmcnt(2)
    s_barrier
    v_mul_f32 v72, v40, v40
    v_fma_f32 v72, v72, v70, v69
    v_mfma_f32_16x16x32_bf16 v[36:39], a[144:147], v[132:135], v[36:39]
    v_mul_f32 v72, v72, v40
    v_fma_f32 v42, v54, v68, v42
    v_mfma_f32_16x16x32_bf16 v[28:31], a[148:151], v[136:139], v[28:31]
    ds_read_b128 v[132:135], v17 offset:47104
    v_mul_f32 v42, v42, v40
    v_mfma_f32_16x16x32_bf16 v[32:35], a[152:155], v[136:139], v[32:35]
    ds_read_b128 v[82:85], v13 offset:0
    v_fma_f32 v41, v53, v68, v41
    v_mfma_f32_16x16x32_bf16 v[36:39], a[156:159], v[136:139], v[36:39]
    v_exp_f32 v72, v72
    v_mul_f32 v73, v41, v41
    v_mfma_f32_16x16x32_bf16 v[28:31], a[160:163], v[140:143], v[28:31]
    ds_read_b128 v[136:139], v17 offset:48128
    v_fma_f32 v72, v72, v71, v71
    v_mfma_f32_16x16x32_bf16 v[32:35], a[164:167], v[140:143], v[32:35]
    buffer_load_dwordx4 v8, s[48:51], s32 offen offset:1024 sc1 lds
    v_mfma_f32_16x16x32_bf16 v[36:39], a[168:171], v[140:143], v[36:39]
    s_waitcnt lgkmcnt(4)
    v_rcp_f32 v72, v72
    v_mfma_f32_16x16x32_bf16 v[28:31], a[172:175], v[144:147], v[28:31]
    ds_read_b128 v[140:143], v17 offset:49152
    v_mul_f32 v42, v42, v72
    v_fma_f32 v73, v73, v70, v69
    v_mfma_f32_16x16x32_bf16 v[32:35], a[176:179], v[144:147], v[32:35]
    s_waitcnt lgkmcnt(2)
    s_cbranch_vccz kf_as_0
    buffer_store_dwordx4 v[82:85], v14, s[48:51], 0 offen sc1
kf_as_0:
    v_mfma_f32_16x16x32_bf16 v[36:39], a[180:183], v[144:147], v[36:39]
    v_mul_f32 v73, v73, v41
    v_fma_f32 v43, v55, v68, v43
    v_mfma_f32_16x16x32_bf16 v[28:31], a[184:187], v[128:131], v[28:31]
    ds_read_b128 v[144:147], v17 offset:50176
    v_mul_f32 v43, v43, v41
    v_mfma_f32_16x16x32_bf16 v[32:35], a[188:191], v[128:131], v[32:35]
    buffer_load_dwordx4 v8, s[48:51], s32 offen offset:2048 sc1 lds
    v_mfma_f32_16x16x32_bf16 v[36:39], a[192:195], v[128:131], v[36:39]
    v_exp_f32 v73, v73
    v_mfma_f32_16x16x32_bf16 v[28:31], a[196:199], v[132:135], v[28:31]
    ds_read_b128 v[128:131], v17 offset:51200
    v_fma_f32 v73, v73, v71, v71
    v_fma_f32 v44, v56, v68, v44
    v_mfma_f32_16x16x32_bf16 v[32:35], a[200:203], v[132:135], v[32:35]
    v_rcp_f32 v73, v73
    v_mfma_f32_16x16x32_bf16 v[36:39], a[204:207], v[132:135], v[36:39]
    s_waitcnt lgkmcnt(3)
    v_mul_f32 v43, v43, v73
    v_cvt_pk_bf16_f32 v78, v42, v43
    v_mfma_f32_16x16x32_bf16 v[28:31], a[208:211], v[136:139], v[28:31]
    ds_read_b128 v[132:135], v17 offset:52224
    ds_write_b32 v10, v78 offset:3072
    v_mfma_f32_16x16x32_bf16 v[32:35], a[212:215], v[136:139], v[32:35]
    buffer_load_dwordx4 v8, s[48:51], s32 offen offset:3072 sc1 lds
    s_add_u32 m0, s85, 86016
    v_mfma_f32_16x16x32_bf16 v[36:39], a[216:219], v[136:139], v[36:39]
    s_waitcnt lgkmcnt(4)
    v_mul_f32 v74, v44, v44
    v_fma_f32 v74, v74, v70, v69
    v_mfma_f32_16x16x32_bf16 v[28:31], a[220:223], v[140:143], v[28:31]
    ds_read_b128 v[136:139], v17 offset:53248
    v_mul_f32 v74, v74, v44
    v_mfma_f32_16x16x32_bf16 v[32:35], a[224:227], v[140:143], v[32:35]
    buffer_load_dwordx4 v9, s[48:51], s32 offen offset:0 sc1 lds
    v_mfma_f32_16x16x32_bf16 v[36:39], a[228:231], v[140:143], v[36:39]
    s_waitcnt lgkmcnt(4)
    v_exp_f32 v74, v74
    v_mfma_f32_16x16x32_bf16 v[28:31], a[232:235], v[144:147], v[28:31]
    ds_read_b128 v[140:143], v17 offset:54272
    v_fma_f32 v74, v74, v71, v71
    v_fma_f32 v46, v58, v68, v46
    v_mfma_f32_16x16x32_bf16 v[32:35], a[236:239], v[144:147], v[32:35]
    buffer_load_dwordx4 v[200:203], v17, s[48:51], s25 offen offset:2048 sc1
    v_mfma_f32_16x16x32_bf16 v[36:39], a[240:243], v[144:147], v[36:39]
    s_waitcnt lgkmcnt(4)
    v_rcp_f32 v74, v74
    v_mfma_f32_16x16x32_bf16 v[28:31], a[244:247], v[128:131], v[28:31]
    ds_read_b128 v[144:147], v17 offset:55296
    v_mul_f32 v46, v46, v44
    v_mfma_f32_16x16x32_bf16 v[32:35], a[248:251], v[128:131], v[32:35]
    v_mul_f32 v46, v46, v74
    v_fma_f32 v45, v57, v68, v45
    v_mul_f32 v75, v45, v45
    v_mfma_f32_16x16x32_bf16 v[36:39], a[252:255], v[128:131], v[36:39]
    s_waitcnt lgkmcnt(4)
    v_fma_f32 v75, v75, v70, v69
    v_mul_f32 v75, v75, v45
    v_mfma_f32_16x16x32_bf16 v[28:31], a[60:63], v[132:135], v[28:31]
    ds_read_b128 v[128:131], v17 offset:56320
    v_fma_f32 v47, v59, v68, v47
    v_mfma_f32_16x16x32_bf16 v[32:35], a[80:83], v[132:135], v[32:35]
    buffer_load_dwordx4 v[204:207], v17, s[48:51], s28 offen offset:2048 sc1
    v_mfma_f32_16x16x32_bf16 v[36:39], a[84:87], v[132:135], v[36:39]
    s_waitcnt lgkmcnt(3)
    v_exp_f32 v75, v75
    v_mul_f32 v47, v47, v45
    v_mfma_f32_16x16x32_bf16 v[28:31], a[88:91], v[136:139], v[28:31]
    ds_read_b128 v[132:135], v17 offset:57344
    v_fma_f32 v75, v75, v71, v71
    v_mfma_f32_16x16x32_bf16 v[32:35], a[92:95], v[136:139], v[32:35]
    buffer_load_dwordx4 v[208:211], v17, s[48:51], s16 offen offset:3072 sc1
    v_mfma_f32_16x16x32_bf16 v[36:39], a[96:99], v[136:139], v[36:39]
    s_waitcnt lgkmcnt(3)
    v_rcp_f32 v75, v75
    v_mfma_f32_16x16x32_bf16 v[28:31], a[100:103], v[140:143], v[28:31]
    ds_read_b128 v[136:139], v17 offset:58368
    v_mul_f32 v47, v47, v75
    v_mfma_f32_16x16x32_bf16 v[32:35], a[104:107], v[140:143], v[32:35]
    buffer_load_dwordx4 v[212:215], v17, s[48:51], s19 offen offset:3072 sc1
    v_mfma_f32_16x16x32_bf16 v[36:39], a[108:111], v[140:143], v[36:39]
    s_waitcnt lgkmcnt(3)
    v_cvt_pk_bf16_f32 v79, v46, v47
    ds_write_b32 v11, v79 offset:3072
    v_mfma_f32_16x16x32_bf16 v[28:31], a[112:115], v[144:147], v[28:31]
    ds_read_b128 v[140:143], v17 offset:59392
    v_fma_f32 v48, v60, v68, v48
    v_mfma_f32_16x16x32_bf16 v[32:35], a[116:119], v[144:147], v[32:35]
    v_mul_f32 v76, v48, v48
    v_fma_f32 v76, v76, v70, v69
    v_mfma_f32_16x16x32_bf16 v[36:39], a[120:123], v[144:147], v[36:39]
    s_waitcnt lgkmcnt(4)
    v_mul_f32 v76, v76, v48
    v_exp_f32 v76, v76
    v_mfma_f32_16x16x32_bf16 v[28:31], a[0:3], v[128:131], v[28:31]
    ds_read_b128 v[144:147], v17 offset:60416
    v_fma_f32 v76, v76, v71, v71
    v_mfma_f32_16x16x32_bf16 v[32:35], a[4:7], v[128:131], v[32:35]
    buffer_load_dwordx4 v[216:219], v17, s[48:51], s22 offen offset:3072 sc1
    v_mfma_f32_16x16x32_bf16 v[36:39], a[8:11], v[128:131], v[36:39]
    s_waitcnt lgkmcnt(4)
    v_rcp_f32 v76, v76
    v_mfma_f32_16x16x32_bf16 v[28:31], a[12:15], v[132:135], v[28:31]
    ds_read_b128 v[128:131], v81 offset:0
    v_fma_f32 v50, v62, v68, v50
    v_mfma_f32_16x16x32_bf16 v[32:35], a[16:19], v[132:135], v[32:35]
    ds_read_b128 v[64:67], v15 offset:256
    v_mul_f32 v50, v50, v48
    v_mul_f32 v50, v50, v76
    v_mfma_f32_16x16x32_bf16 v[36:39], a[20:23], v[132:135], v[36:39]
    s_waitcnt lgkmcnt(5)
    v_fma_f32 v49, v61, v68, v49
    v_mul_f32 v77, v49, v49
    v_mfma_f32_16x16x32_bf16 v[28:31], a[24:27], v[136:139], v[28:31]
    ds_read_b128 v[132:135], v81 offset:1024
    v_fma_f32 v77, v77, v70, v69
    v_mfma_f32_16x16x32_bf16 v[32:35], a[28:31], v[136:139], v[32:35]
    buffer_load_dwordx4 v[220:223], v17, s[48:51], s25 offen offset:3072 sc1
    v_mfma_f32_16x16x32_bf16 v[36:39], a[32:35], v[136:139], v[36:39]
    s_waitcnt lgkmcnt(4)
    v_mul_f32 v77, v77, v49
    v_exp_f32 v77, v77
    v_mfma_f32_16x16x32_bf16 v[28:31], a[36:39], v[140:143], v[28:31]
    ds_read_b128 v[136:139], v81 offset:2048
    v_fma_f32 v77, v77, v71, v71
    v_mfma_f32_16x16x32_bf16 v[32:35], a[40:43], v[140:143], v[32:35]
    buffer_load_dwordx4 v[224:227], v17, s[48:51], s28 offen offset:3072 sc1
    v_mfma_f32_16x16x32_bf16 v[36:39], a[44:47], v[140:143], v[36:39]
    s_waitcnt lgkmcnt(4)
    v_rcp_f32 v77, v77
    v_mfma_f32_16x16x32_bf16 v[28:31], a[48:51], v[144:147], v[28:31]
    ds_read_b128 v[140:143], v81 offset:3072
    v_fma_f32 v51, v63, v68, v51
    v_mfma_f32_16x16x32_bf16 v[32:35], a[52:55], v[144:147], v[32:35]
    v_mul_f32 v51, v51, v49
    v_mul_f32 v51, v51, v77
    v_cvt_pk_bf16_f32 v80, v50, v51
    v_mfma_f32_16x16x32_bf16 v[36:39], a[56:59], v[144:147], v[36:39]
    s_waitcnt lgkmcnt(4)
    ds_write_b32 v12, v80 offset:3072
    v_mfma_f32_16x16x32_bf16 v[40:43], a[124:127], v[128:131], 0
    ds_read_b128 v[144:147], v81 offset:4096
    v_mfma_f32_16x16x32_bf16 v[44:47], a[128:131], v[128:131], 0
    s_add_u32 m0, s85, 0
    s_nop 0
    buffer_load_dwordx4 v8, s[48:51], s33 offen offset:0 sc1 lds
    v_mfma_f32_16x16x32_bf16 v[48:51], a[132:135], v[128:131], 0
    s_waitcnt lgkmcnt(4)
    v_mfma_f32_16x16x32_bf16 v[40:43], a[136:139], v[132:135], v[40:43]
    ds_read_b128 v[128:131], v81 offset:5120
    v_fma_f32 v28, v52, v64, v28
    v_mfma_f32_16x16x32_bf16 v[44:47], a[140:143], v[132:135], v[44:47]
    s_waitcnt vmcnt(8)
    s_waitcnt lgkmcnt(2)
    s_barrier
    v_mul_f32 v72, v28, v28
    v_fma_f32 v72, v72, v66, v65
    v_mfma_f32_16x16x32_bf16 v[48:51], a[144:147], v[132:135], v[48:51]
    v_mul_f32 v72, v72, v28
    v_fma_f32 v30, v54, v64, v30
    v_mfma_f32_16x16x32_bf16 v[40:43], a[148:151], v[136:139], v[40:43]
    ds_read_b128 v[132:135], v81 offset:6144
    v_mul_f32 v30, v30, v28
    v_mfma_f32_16x16x32_bf16 v[44:47], a[152:155], v[136:139], v[44:47]
    s_branch kf_pw_k4_o
kf_pw_k4:
    s_branch kf_pw_k_ret
kf_pw_k4_o:
    ds_read_b128 v[82:85], v13 offset:3072
    v_fma_f32 v29, v53, v64, v29
    v_mfma_f32_16x16x32_bf16 v[48:51], a[156:159], v[136:139], v[48:51]
    v_exp_f32 v72, v72
    v_mul_f32 v73, v29, v29
    v_mfma_f32_16x16x32_bf16 v[40:43], a[160:163], v[140:143], v[40:43]
    ds_read_b128 v[136:139], v81 offset:7168
    v_fma_f32 v72, v72, v67, v67
    v_mfma_f32_16x16x32_bf16 v[44:47], a[164:167], v[140:143], v[44:47]
    buffer_load_dwordx4 v8, s[48:51], s33 offen offset:1024 sc1 lds
    v_mfma_f32_16x16x32_bf16 v[48:51], a[168:171], v[140:143], v[48:51]
    s_waitcnt lgkmcnt(4)
    v_rcp_f32 v72, v72
    v_mfma_f32_16x16x32_bf16 v[40:43], a[172:175], v[144:147], v[40:43]
    ds_read_b128 v[140:143], v81 offset:8192
    v_mul_f32 v30, v30, v72
    v_fma_f32 v73, v73, v66, v65
    v_mfma_f32_16x16x32_bf16 v[44:47], a[176:179], v[144:147], v[44:47]
    s_waitcnt lgkmcnt(2)
    s_cbranch_vccz kf_as_1
    buffer_store_dwordx4 v[82:85], v14, s[48:51], s40 offen sc1
kf_as_1:
    v_mfma_f32_16x16x32_bf16 v[48:51], a[180:183], v[144:147], v[48:51]
    v_mul_f32 v73, v73, v29
    v_fma_f32 v31, v55, v64, v31
    v_mfma_f32_16x16x32_bf16 v[40:43], a[184:187], v[128:131], v[40:43]
    ds_read_b128 v[144:147], v81 offset:9216
    v_mul_f32 v31, v31, v29
    v_mfma_f32_16x16x32_bf16 v[44:47], a[188:191], v[128:131], v[44:47]
    buffer_load_dwordx4 v8, s[48:51], s33 offen offset:2048 sc1 lds
    v_mfma_f32_16x16x32_bf16 v[48:51], a[192:195], v[128:131], v[48:51]
    v_exp_f32 v73, v73
    v_mfma_f32_16x16x32_bf16 v[40:43], a[196:199], v[132:135], v[40:43]
    ds_read_b128 v[128:131], v81 offset:10240
    v_fma_f32 v73, v73, v67, v67
    v_fma_f32 v32, v56, v64, v32
    v_mfma_f32_16x16x32_bf16 v[44:47], a[200:203], v[132:135], v[44:47]
    v_rcp_f32 v73, v73
    v_mfma_f32_16x16x32_bf16 v[48:51], a[204:207], v[132:135], v[48:51]
    s_waitcnt lgkmcnt(3)
    v_mul_f32 v31, v31, v73
    v_cvt_pk_bf16_f32 v78, v30, v31
    v_mfma_f32_16x16x32_bf16 v[40:43], a[208:211], v[136:139], v[40:43]
    ds_read_b128 v[132:135], v81 offset:11264
    ds_write_b32 v10, v78 offset:6144
    v_mfma_f32_16x16x32_bf16 v[44:47], a[212:215], v[136:139], v[44:47]
    buffer_load_dwordx4 v8, s[48:51], s33 offen offset:3072 sc1 lds
    s_add_u32 m0, s85, 4096
    v_mfma_f32_16x16x32_bf16 v[48:51], a[216:219], v[136:139], v[48:51]
    s_waitcnt lgkmcnt(4)
    v_mul_f32 v74, v32, v32
    v_fma_f32 v74, v74, v66, v65
    v_mfma_f32_16x16x32_bf16 v[40:43], a[220:223], v[140:143], v[40:43]
    ds_read_b128 v[136:139], v81 offset:12288
    v_mul_f32 v74, v74, v32
    v_mfma_f32_16x16x32_bf16 v[44:47], a[224:227], v[140:143], v[44:47]
    buffer_load_dwordx4 v9, s[48:51], s33 offen offset:0 sc1 lds
    v_mfma_f32_16x16x32_bf16 v[48:51], a[228:231], v[140:143], v[48:51]
    s_waitcnt lgkmcnt(4)
    v_exp_f32 v74, v74
    v_mfma_f32_16x16x32_bf16 v[40:43], a[232:235], v[144:147], v[40:43]
    ds_read_b128 v[140:143], v81 offset:13312
    v_fma_f32 v74, v74, v67, v67
    v_fma_f32 v34, v58, v64, v34
    v_mfma_f32_16x16x32_bf16 v[44:47], a[236:239], v[144:147], v[44:47]
    buffer_load_dwordx4 v[228:231], v17, s[48:51], s17 offen offset:0 sc1
    v_mfma_f32_16x16x32_bf16 v[48:51], a[240:243], v[144:147], v[48:51]
    s_waitcnt lgkmcnt(4)
    v_rcp_f32 v74, v74
    v_mfma_f32_16x16x32_bf16 v[40:43], a[244:247], v[128:131], v[40:43]
    ds_read_b128 v[144:147], v81 offset:14336
    v_mul_f32 v34, v34, v32
    v_mfma_f32_16x16x32_bf16 v[44:47], a[248:251], v[128:131], v[44:47]
    v_mul_f32 v34, v34, v74
    v_fma_f32 v33, v57, v64, v33
    v_mul_f32 v75, v33, v33
    v_mfma_f32_16x16x32_bf16 v[48:51], a[252:255], v[128:131], v[48:51]
    s_waitcnt lgkmcnt(4)
    v_fma_f32 v75, v75, v66, v65
    v_mul_f32 v75, v75, v33
    v_mfma_f32_16x16x32_bf16 v[40:43], a[60:63], v[132:135], v[40:43]
    ds_read_b128 v[128:131], v81 offset:15360
    v_fma_f32 v35, v59, v64, v35
    v_mfma_f32_16x16x32_bf16 v[44:47], a[80:83], v[132:135], v[44:47]
    buffer_load_dwordx4 v[232:235], v17, s[48:51], s20 offen offset:0 sc1
    v_mfma_f32_16x16x32_bf16 v[48:51], a[84:87], v[132:135], v[48:51]
    s_waitcnt lgkmcnt(3)
    v_exp_f32 v75, v75
    v_mul_f32 v35, v35, v33
    v_mfma_f32_16x16x32_bf16 v[40:43], a[88:91], v[136:139], v[40:43]
    ds_read_b128 v[132:135], v81 offset:16384
    v_fma_f32 v75, v75, v67, v67
    v_mfma_f32_16x16x32_bf16 v[44:47], a[92:95], v[136:139], v[44:47]
    buffer_load_dwordx4 v[236:239], v17, s[48:51], s23 offen offset:0 sc1
    v_mfma_f32_16x16x32_bf16 v[48:51], a[96:99], v[136:139], v[48:51]
    s_waitcnt lgkmcnt(3)
    v_rcp_f32 v75, v75
    v_mfma_f32_16x16x32_bf16 v[40:43], a[100:103], v[140:143], v[40:43]
    ds_read_b128 v[136:139], v81 offset:17408
    v_mul_f32 v35, v35, v75
    v_mfma_f32_16x16x32_bf16 v[44:47], a[104:107], v[140:143], v[44:47]
    buffer_load_dwordx4 v[240:243], v17, s[48:51], s26 offen offset:0 sc1
    v_mfma_f32_16x16x32_bf16 v[48:51], a[108:111], v[140:143], v[48:51]
    s_waitcnt lgkmcnt(3)
    v_cvt_pk_bf16_f32 v79, v34, v35
    ds_write_b32 v11, v79 offset:6144
    v_mfma_f32_16x16x32_bf16 v[40:43], a[112:115], v[144:147], v[40:43]
    ds_read_b128 v[140:143], v81 offset:18432
    v_fma_f32 v36, v60, v64, v36
    v_mfma_f32_16x16x32_bf16 v[44:47], a[116:119], v[144:147], v[44:47]
    v_mul_f32 v76, v36, v36
    v_fma_f32 v76, v76, v66, v65
    v_mfma_f32_16x16x32_bf16 v[48:51], a[120:123], v[144:147], v[48:51]
    s_waitcnt lgkmcnt(4)
    v_mul_f32 v76, v76, v36
    v_exp_f32 v76, v76
    v_mfma_f32_16x16x32_bf16 v[40:43], a[0:3], v[128:131], v[40:43]
    ds_read_b128 v[144:147], v81 offset:19456
    v_fma_f32 v76, v76, v67, v67
    v_mfma_f32_16x16x32_bf16 v[44:47], a[4:7], v[128:131], v[44:47]
    buffer_load_dwordx4 v[244:247], v17, s[48:51], s29 offen offset:0 sc1
    v_mfma_f32_16x16x32_bf16 v[48:51], a[8:11], v[128:131], v[48:51]
    s_waitcnt lgkmcnt(4)
    v_rcp_f32 v76, v76
    v_mfma_f32_16x16x32_bf16 v[40:43], a[12:15], v[132:135], v[40:43]
    ds_read_b128 v[128:131], v81 offset:20480
    v_fma_f32 v38, v62, v64, v38
    v_mfma_f32_16x16x32_bf16 v[44:47], a[16:19], v[132:135], v[44:47]
    ds_read_b128 v[68:71], v15 offset:1280
    v_mul_f32 v38, v38, v36
    v_mul_f32 v38, v38, v76
    v_mfma_f32_16x16x32_bf16 v[48:51], a[20:23], v[132:135], v[48:51]
    s_waitcnt lgkmcnt(5)
    v_fma_f32 v37, v61, v64, v37
    v_mul_f32 v77, v37, v37
    v_mfma_f32_16x16x32_bf16 v[40:43], a[24:27], v[136:139], v[40:43]
    ds_read_b128 v[132:135], v81 offset:21504
    v_fma_f32 v77, v77, v66, v65
    v_mfma_f32_16x16x32_bf16 v[44:47], a[28:31], v[136:139], v[44:47]
    buffer_load_dwordx4 v[248:251], v17, s[48:51], s17 offen offset:1024 sc1
    v_mfma_f32_16x16x32_bf16 v[48:51], a[32:35], v[136:139], v[48:51]
    s_waitcnt lgkmcnt(4)
    v_mul_f32 v77, v77, v37
    v_exp_f32 v77, v77
    v_mfma_f32_16x16x32_bf16 v[40:43], a[36:39], v[140:143], v[40:43]
    ds_read_b128 v[136:139], v81 offset:22528
    v_fma_f32 v77, v77, v67, v67
    v_mfma_f32_16x16x32_bf16 v[44:47], a[40:43], v[140:143], v[44:47]
    buffer_load_dwordx4 v[252:255], v17, s[48:51], s20 offen offset:1024 sc1
    v_mfma_f32_16x16x32_bf16 v[48:51], a[44:47], v[140:143], v[48:51]
    s_waitcnt lgkmcnt(4)
    v_rcp_f32 v77, v77
    v_mfma_f32_16x16x32_bf16 v[40:43], a[48:51], v[144:147], v[40:43]
    ds_read_b128 v[140:143], v81 offset:23552
    v_fma_f32 v39, v63, v64, v39
    v_mfma_f32_16x16x32_bf16 v[44:47], a[52:55], v[144:147], v[44:47]
    v_mul_f32 v39, v39, v37
    v_mul_f32 v39, v39, v77
    v_cvt_pk_bf16_f32 v80, v38, v39
    v_mfma_f32_16x16x32_bf16 v[48:51], a[56:59], v[144:147], v[48:51]
    s_waitcnt lgkmcnt(4)
    ds_write_b32 v12, v80 offset:6144
    v_mfma_f32_16x16x32_bf16 v[28:31], a[124:127], v[128:131], 0
    ds_read_b128 v[144:147], v81 offset:24576
    v_mfma_f32_16x16x32_bf16 v[32:35], a[128:131], v[128:131], 0
    s_add_u32 m0, s85, 20480
    s_nop 0
    buffer_load_dwordx4 v8, s[48:51], s34 offen offset:0 sc1 lds
    v_mfma_f32_16x16x32_bf16 v[36:39], a[132:135], v[128:131], 0
    s_waitcnt lgkmcnt(4)
    v_mfma_f32_16x16x32_bf16 v[28:31], a[136:139], v[132:135], v[28:31]
    ds_read_b128 v[128:131], v81 offset:25600
    v_fma_f32 v40, v52, v68, v40
    v_mfma_f32_16x16x32_bf16 v[32:35], a[140:143], v[132:135], v[32:35]
    s_waitcnt vmcnt(8)
    s_waitcnt lgkmcnt(2)
    s_barrier
    v_mul_f32 v72, v40, v40
    v_fma_f32 v72, v72, v70, v69
    v_mfma_f32_16x16x32_bf16 v[36:39], a[144:147], v[132:135], v[36:39]
    v_mul_f32 v72, v72, v40
    v_fma_f32 v42, v54, v68, v42
    v_mfma_f32_16x16x32_bf16 v[28:31], a[148:151], v[136:139], v[28:31]
    ds_read_b128 v[132:135], v81 offset:26624
    v_mul_f32 v42, v42, v40
    v_mfma_f32_16x16x32_bf16 v[32:35], a[152:155], v[136:139], v[32:35]
    ds_read_b128 v[82:85], v13 offset:6144
    v_fma_f32 v41, v53, v68, v41
    v_mfma_f32_16x16x32_bf16 v[36:39], a[156:159], v[136:139], v[36:39]
    v_exp_f32 v72, v72
    v_mul_f32 v73, v41, v41
    v_mfma_f32_16x16x32_bf16 v[28:31], a[160:163], v[140:143], v[28:31]
    ds_read_b128 v[136:139], v81 offset:27648
    v_fma_f32 v72, v72, v71, v71
    v_mfma_f32_16x16x32_bf16 v[32:35], a[164:167], v[140:143], v[32:35]
    buffer_load_dwordx4 v8, s[48:51], s34 offen offset:1024 sc1 lds
    v_mfma_f32_16x16x32_bf16 v[36:39], a[168:171], v[140:143], v[36:39]
    s_waitcnt lgkmcnt(4)
    v_rcp_f32 v72, v72
    v_mfma_f32_16x16x32_bf16 v[28:31], a[172:175], v[144:147], v[28:31]
    ds_read_b128 v[140:143], v81 offset:28672
    v_mul_f32 v42, v42, v72
    v_fma_f32 v73, v73, v70, v69
    v_mfma_f32_16x16x32_bf16 v[32:35], a[176:179], v[144:147], v[32:35]
    s_waitcnt lgkmcnt(2)
    s_cbranch_vccz kf_as_2
    buffer_store_dwordx4 v[82:85], v14, s[48:51], s41 offen sc1
kf_as_2:
    v_mfma_f32_16x16x32_bf16 v[36:39], a[180:183], v[144:147], v[36:39]
    v_mul_f32 v73, v73, v41
    v_fma_f32 v43, v55, v68, v43
    v_mfma_f32_16x16x32_bf16 v[28:31], a[184:187], v[128:131], v[28:31]
    ds_read_b128 v[144:147], v81 offset:29696
    v_mul_f32 v43, v43, v41
    v_mfma_f32_16x16x32_bf16 v[32:35], a[188:191], v[128:131], v[32:35]
    buffer_load_dwordx4 v8, s[48:51], s34 offen offset:2048 sc1 lds
    v_mfma_f32_16x16x32_bf16 v[36:39], a[192:195], v[128:131], v[36:39]
    v_exp_f32 v73, v73
    v_mfma_f32_16x16x32_bf16 v[28:31], a[196:199], v[132:135], v[28:31]
    ds_read_b128 v[128:131], v81 offset:30720
    v_fma_f32 v73, v73, v71, v71
    v_fma_f32 v44, v56, v68, v44
    v_mfma_f32_16x16x32_bf16 v[32:35], a[200:203], v[132:135], v[32:35]
    v_rcp_f32 v73, v73
    v_mfma_f32_16x16x32_bf16 v[36:39], a[204:207], v[132:135], v[36:39]
    s_waitcnt lgkmcnt(3)
    v_mul_f32 v43, v43, v73
    v_cvt_pk_bf16_f32 v78, v42, v43
    v_mfma_f32_16x16x32_bf16 v[28:31], a[208:211], v[136:139], v[28:31]
    ds_read_b128 v[132:135], v81 offset:31744
    ds_write_b32 v10, v78 offset:0
    v_mfma_f32_16x16x32_bf16 v[32:35], a[212:215], v[136:139], v[32:35]
    buffer_load_dwordx4 v8, s[48:51], s34 offen offset:3072 sc1 lds
    s_add_u32 m0, s85, 24576
    v_mfma_f32_16x16x32_bf16 v[36:39], a[216:219], v[136:139], v[36:39]
    s_waitcnt lgkmcnt(4)
    v_mul_f32 v74, v44, v44
    v_fma_f32 v74, v74, v70, v69
    v_mfma_f32_16x16x32_bf16 v[28:31], a[220:223], v[140:143], v[28:31]
    ds_read_b128 v[136:139], v81 offset:32768
    v_mul_f32 v74, v74, v44
    v_mfma_f32_16x16x32_bf16 v[32:35], a[224:227], v[140:143], v[32:35]
    buffer_load_dwordx4 v9, s[48:51], s34 offen offset:0 sc1 lds
    v_mfma_f32_16x16x32_bf16 v[36:39], a[228:231], v[140:143], v[36:39]
    s_waitcnt lgkmcnt(4)
    v_exp_f32 v74, v74
    v_mfma_f32_16x16x32_bf16 v[28:31], a[232:235], v[144:147], v[28:31]
    ds_read_b128 v[140:143], v81 offset:33792
    v_fma_f32 v74, v74, v71, v71
    v_fma_f32 v46, v58, v68, v46
    v_mfma_f32_16x16x32_bf16 v[32:35], a[236:239], v[144:147], v[32:35]
    buffer_load_dwordx4 a[64:67], v17, s[48:51], s23 offen offset:1024 sc1
    v_mfma_f32_16x16x32_bf16 v[36:39], a[240:243], v[144:147], v[36:39]
    s_waitcnt lgkmcnt(4)
    v_rcp_f32 v74, v74
    v_mfma_f32_16x16x32_bf16 v[28:31], a[244:247], v[128:131], v[28:31]
    ds_read_b128 v[144:147], v81 offset:34816
    v_mul_f32 v46, v46, v44
    v_mfma_f32_16x16x32_bf16 v[32:35], a[248:251], v[128:131], v[32:35]
    v_mul_f32 v46, v46, v74
    v_fma_f32 v45, v57, v68, v45
    v_mul_f32 v75, v45, v45
    v_mfma_f32_16x16x32_bf16 v[36:39], a[252:255], v[128:131], v[36:39]
    s_waitcnt lgkmcnt(4)
    v_fma_f32 v75, v75, v70, v69
    v_mul_f32 v75, v75, v45
    v_mfma_f32_16x16x32_bf16 v[28:31], a[60:63], v[132:135], v[28:31]
    ds_read_b128 v[128:131], v81 offset:35840
    v_fma_f32 v47, v59, v68, v47
    v_mfma_f32_16x16x32_bf16 v[32:35], a[80:83], v[132:135], v[32:35]
    buffer_load_dwordx4 a[68:71], v17, s[48:51], s26 offen offset:1024 sc1
    v_mfma_f32_16x16x32_bf16 v[36:39], a[84:87], v[132:135], v[36:39]
    s_waitcnt lgkmcnt(3)
    v_exp_f32 v75, v75
    v_mul_f32 v47, v47, v45
    v_mfma_f32_16x16x32_bf16 v[28:31], a[88:91], v[136:139], v[28:31]
    ds_read_b128 v[132:135], v81 offset:36864
    v_fma_f32 v75, v75, v71, v71
    v_mfma_f32_16x16x32_bf16 v[32:35], a[92:95], v[136:139], v[32:35]
    buffer_load_dwordx4 a[72:75], v17, s[48:51], s29 offen offset:1024 sc1
    v_mfma_f32_16x16x32_bf16 v[36:39], a[96:99], v[136:139], v[36:39]
    s_waitcnt lgkmcnt(3)
    v_rcp_f32 v75, v75
    v_mfma_f32_16x16x32_bf16 v[28:31], a[100:103], v[140:143], v[28:31]
    ds_read_b128 v[136:139], v81 offset:37888
    v_mul_f32 v47, v47, v75
    v_mfma_f32_16x16x32_bf16 v[32:35], a[104:107], v[140:143], v[32:35]
    buffer_load_dwordx4 a[76:79], v17, s[48:51], s17 offen offset:2048 sc1
    v_mfma_f32_16x16x32_bf16 v[36:39], a[108:111], v[140:143], v[36:39]
    s_waitcnt lgkmcnt(3)
    v_cvt_pk_bf16_f32 v79, v46, v47
    ds_write_b32 v11, v79 offset:0
    v_mfma_f32_16x16x32_bf16 v[28:31], a[112:115], v[144:147], v[28:31]
    ds_read_b128 v[140:143], v81 offset:38912
    v_fma_f32 v48, v60, v68, v48
    v_mfma_f32_16x16x32_bf16 v[32:35], a[116:119], v[144:147], v[32:35]
    v_mul_f32 v76, v48, v48
    v_fma_f32 v76, v76, v70, v69
    v_mfma_f32_16x16x32_bf16 v[36:39], a[120:123], v[144:147], v[36:39]
    s_waitcnt lgkmcnt(4)
    v_mul_f32 v76, v76, v48
    v_exp_f32 v76, v76
    v_mfma_f32_16x16x32_bf16 v[28:31], a[0:3], v[128:131], v[28:31]
    ds_read_b128 v[144:147], v81 offset:39936
    v_fma_f32 v76, v76, v71, v71
    v_mfma_f32_16x16x32_bf16 v[32:35], a[4:7], v[128:131], v[32:35]
    buffer_load_dwordx4 v[88:91], v17, s[48:51], s20 offen offset:2048 sc1
    v_mfma_f32_16x16x32_bf16 v[36:39], a[8:11], v[128:131], v[36:39]
    s_waitcnt lgkmcnt(4)
    v_rcp_f32 v76, v76
    v_mfma_f32_16x16x32_bf16 v[28:31], a[12:15], v[132:135], v[28:31]
    ds_read_b128 v[128:131], v17 offset:0
    v_fma_f32 v50, v62, v68, v50
    v_mfma_f32_16x16x32_bf16 v[32:35], a[16:19], v[132:135], v[32:35]
    ds_read_b128 v[64:67], v15 offset:512
    v_mul_f32 v50, v50, v48
    v_mul_f32 v50, v50, v76
    v_mfma_f32_16x16x32_bf16 v[36:39], a[20:23], v[132:135], v[36:39]
    s_waitcnt lgkmcnt(5)
    v_fma_f32 v49, v61, v68, v49
    v_mul_f32 v77, v49, v49
    v_mfma_f32_16x16x32_bf16 v[28:31], a[24:27], v[136:139], v[28:31]
    ds_read_b128 v[132:135], v17 offset:1024
    v_fma_f32 v77, v77, v70, v69
    v_mfma_f32_16x16x32_bf16 v[32:35], a[28:31], v[136:139], v[32:35]
    buffer_load_dwordx4 v[92:95], v17, s[48:51], s23 offen offset:2048 sc1
    v_mfma_f32_16x16x32_bf16 v[36:39], a[32:35], v[136:139], v[36:39]
    s_waitcnt lgkmcnt(4)
    v_mul_f32 v77, v77, v49
    v_exp_f32 v77, v77
    v_mfma_f32_16x16x32_bf16 v[28:31], a[36:39], v[140:143], v[28:31]
    ds_read_b128 v[136:139], v17 offset:2048
    v_fma_f32 v77, v77, v71, v71
    v_mfma_f32_16x16x32_bf16 v[32:35], a[40:43], v[140:143], v[32:35]
    buffer_load_dwordx4 v[96:99], v17, s[48:51], s26 offen offset:2048 sc1
    v_mfma_f32_16x16x32_bf16 v[36:39], a[44:47], v[140:143], v[36:39]
    s_waitcnt lgkmcnt(4)
    v_rcp_f32 v77, v77
    v_mfma_f32_16x16x32_bf16 v[28:31], a[48:51], v[144:147], v[28:31]
    ds_read_b128 v[140:143], v17 offset:3072
    v_fma_f32 v51, v63, v68, v51
    v_mfma_f32_16x16x32_bf16 v[32:35], a[52:55], v[144:147], v[32:35]
    v_mul_f32 v51, v51, v49
    v_mul_f32 v51, v51, v77
    v_cvt_pk_bf16_f32 v80, v50, v51
    v_mfma_f32_16x16x32_bf16 v[36:39], a[56:59], v[144:147], v[36:39]
    s_waitcnt lgkmcnt(4)
    ds_write_b32 v12, v80 offset:0
    v_mfma_f32_16x16x32_bf16 v[40:43], a[124:127], v[128:131], 0
    ds_read_b128 v[144:147], v17 offset:4096
    v_mfma_f32_16x16x32_bf16 v[44:47], a[128:131], v[128:131], 0
    buffer_load_dword v7, off, s[48:51], s70 sc1
    v_mfma_f32_16x16x32_bf16 v[48:51], a[132:135], v[128:131], 0
    s_waitcnt lgkmcnt(4)
    v_mfma_f32_16x16x32_bf16 v[40:43], a[136:139], v[132:135], v[40:43]
    ds_read_b128 v[128:131], v17 offset:5120
    v_fma_f32 v28, v52, v64, v28
    v_mfma_f32_16x16x32_bf16 v[44:47], a[140:143], v[132:135], v[44:47]
    s_waitcnt vmcnt(8)
    s_waitcnt lgkmcnt(2)
    s_barrier
    v_mul_f32 v72, v28, v28
    v_fma_f32 v72, v72, v66, v65
    v_mfma_f32_16x16x32_bf16 v[48:51], a[144:147], v[132:135], v[48:51]
    v_mul_f32 v72, v72, v28
    v_fma_f32 v30, v54, v64, v30
    v_mfma_f32_16x16x32_bf16 v[40:43], a[148:151], v[136:139], v[40:43]
    ds_read_b128 v[132:135], v17 offset:6144
    v_exp_f32 v72, v72
    v_mfma_f32_16x16x32_bf16 v[44:47], a[152:155], v[136:139], v[44:47]
    ds_read_b128 v[82:85], v13 offset:0
    v_fma_f32 v72, v72, v67, v67
    v_mfma_f32_16x16x32_bf16 v[48:51], a[156:159], v[136:139], v[48:51]
    v_rcp_f32 v72, v72
    v_mul_f32 v30, v30, v28
    v_mfma_f32_16x16x32_bf16 v[40:43], a[160:163], v[140:143], v[40:43]
    ds_read_b128 v[136:139], v17 offset:7168
    v_mul_f32 v30, v30, v72
    v_mfma_f32_16x16x32_bf16 v[44:47], a[164:167], v[140:143], v[44:47]
    s_add_u32 m0, s85, 40960
    s_nop 0
    buffer_load_dwordx4 v8, s[48:51], s35 offen offset:0 sc1 lds
    v_mfma_f32_16x16x32_bf16 v[48:51], a[168:171], v[140:143], v[48:51]
    s_waitcnt lgkmcnt(4)
    v_fma_f32 v29, v53, v64, v29
    v_mul_f32 v73, v29, v29
    v_mfma_f32_16x16x32_bf16 v[40:43], a[172:175], v[144:147], v[40:43]
    ds_read_b128 v[140:143], v17 offset:8192
    v_fma_f32 v73, v73, v66, v65
    v_mul_f32 v73, v73, v29
    v_mfma_f32_16x16x32_bf16 v[44:47], a[176:179], v[144:147], v[44:47]
    s_waitcnt lgkmcnt(2)
    s_cbranch_vccz kf_as_3
    buffer_store_dwordx4 v[82:85], v14, s[48:51], s42 offen sc1
kf_as_3:
    v_mfma_f32_16x16x32_bf16 v[48:51], a[180:183], v[144:147], v[48:51]
    v_exp_f32 v73, v73
    v_mfma_f32_16x16x32_bf16 v[40:43], a[184:187], v[128:131], v[40:43]
    ds_read_b128 v[144:147], v17 offset:9216
    v_fma_f32 v73, v73, v67, v67
    v_fma_f32 v31, v55, v64, v31
    v_mfma_f32_16x16x32_bf16 v[44:47], a[188:191], v[128:131], v[44:47]
    buffer_load_dwordx4 v8, s[48:51], s35 offen offset:1024 sc1 lds
    v_mfma_f32_16x16x32_bf16 v[48:51], a[192:195], v[128:131], v[48:51]
    v_rcp_f32 v73, v73
    v_mfma_f32_16x16x32_bf16 v[40:43], a[196:199], v[132:135], v[40:43]
    ds_read_b128 v[128:131], v17 offset:10240
    v_mul_f32 v31, v31, v29
    v_mfma_f32_16x16x32_bf16 v[44:47], a[200:203], v[132:135], v[44:47]
    buffer_load_dwordx4 v8, s[48:51], s35 offen offset:2048 sc1 lds
    v_mfma_f32_16x16x32_bf16 v[48:51], a[204:207], v[132:135], v[48:51]
    s_waitcnt lgkmcnt(3)
    v_mul_f32 v31, v31, v73
    v_cvt_pk_bf16_f32 v78, v30, v31
    v_fma_f32 v32, v56, v64, v32
    v_mfma_f32_16x16x32_bf16 v[40:43], a[208:211], v[136:139], v[40:43]
    ds_read_b128 v[132:135], v17 offset:11264
    v_mul_f32 v74, v32, v32
    v_mfma_f32_16x16x32_bf16 v[44:47], a[212:215], v[136:139], v[44:47]
    buffer_load_dwordx4 v8, s[48:51], s35 offen offset:3072 sc1 lds
    s_add_u32 m0, s85, 45056
    v_mfma_f32_16x16x32_bf16 v[48:51], a[216:219], v[136:139], v[48:51]
    s_waitcnt lgkmcnt(3)
    ds_write_b32 v10, v78 offset:3072
    v_fma_f32 v74, v74, v66, v65
    v_mfma_f32_16x16x32_bf16 v[40:43], a[220:223], v[140:143], v[40:43]
    ds_read_b128 v[136:139], v17 offset:12288
    v_mul_f32 v74, v74, v32
    v_mfma_f32_16x16x32_bf16 v[44:47], a[224:227], v[140:143], v[44:47]
    buffer_load_dwordx4 v9, s[48:51], s35 offen offset:0 sc1 lds
    v_mfma_f32_16x16x32_bf16 v[48:51], a[228:231], v[140:143], v[48:51]
    s_waitcnt lgkmcnt(4)
    v_exp_f32 v74, v74
    v_fma_f32 v34, v58, v64, v34
    v_mfma_f32_16x16x32_bf16 v[40:43], a[232:235], v[144:147], v[40:43]
    ds_read_b128 v[140:143], v17 offset:13312
    v_fma_f32 v74, v74, v67, v67
    v_mfma_f32_16x16x32_bf16 v[44:47], a[236:239], v[144:147], v[44:47]
    buffer_load_dwordx4 v[100:103], v17, s[48:51], s29 offen offset:2048 sc1
    v_mfma_f32_16x16x32_bf16 v[48:51], a[240:243], v[144:147], v[48:51]
    s_waitcnt lgkmcnt(4)
    v_rcp_f32 v74, v74
    v_mfma_f32_16x16x32_bf16 v[40:43], a[244:247], v[128:131], v[40:43]
    ds_read_b128 v[144:147], v17 offset:14336
    v_mul_f32 v34, v34, v32
    v_mul_f32 v34, v34, v74
    v_mfma_f32_16x16x32_bf16 v[44:47], a[248:251], v[128:131], v[44:47]
    v_fma_f32 v33, v57, v64, v33
    v_mul_f32 v75, v33, v33
    v_mfma_f32_16x16x32_bf16 v[48:51], a[252:255], v[128:131], v[48:51]
    s_waitcnt lgkmcnt(4)
    v_fma_f32 v75, v75, v66, v65
    v_mul_f32 v75, v75, v33
    v_fma_f32 v35, v59, v64, v35
    v_mfma_f32_16x16x32_bf16 v[40:43], a[60:63], v[132:135], v[40:43]
    ds_read_b128 v[128:131], v17 offset:15360
    v_mul_f32 v35, v35, v33
    v_mfma_f32_16x16x32_bf16 v[44:47], a[80:83], v[132:135], v[44:47]
    buffer_load_dwordx4 v[104:107], v17, s[48:51], s17 offen offset:3072 sc1
    v_mfma_f32_16x16x32_bf16 v[48:51], a[84:87], v[132:135], v[48:51]
    s_waitcnt lgkmcnt(3)
    v_exp_f32 v75, v75
    v_mfma_f32_16x16x32_bf16 v[40:43], a[88:91], v[136:139], v[40:43]
    ds_read_b128 v[132:135], v17 offset:16384
    v_fma_f32 v75, v75, v67, v67
    v_fma_f32 v36, v60, v64, v36
    v_mfma_f32_16x16x32_bf16 v[44:47], a[92:95], v[136:139], v[44:47]
    buffer_load_dwordx4 v[108:111], v17, s[48:51], s20 offen offset:3072 sc1
    v_mfma_f32_16x16x32_bf16 v[48:51], a[96:99], v[136:139], v[48:51]
    s_waitcnt lgkmcnt(3)
    v_rcp_f32 v75, v75
    v_mfma_f32_16x16x32_bf16 v[40:43], a[100:103], v[140:143], v[40:43]
    ds_read_b128 v[136:139], v17 offset:17408
    v_mul_f32 v35, v35, v75
    v_cvt_pk_bf16_f32 v79, v34, v35
    v_mfma_f32_16x16x32_bf16 v[44:47], a[104:107], v[140:143], v[44:47]
    buffer_load_dwordx4 v[112:115], v17, s[48:51], s23 offen offset:3072 sc1
    v_mfma_f32_16x16x32_bf16 v[48:51], a[108:111], v[140:143], v[48:51]
    s_waitcnt lgkmcnt(3)
    ds_write_b32 v11, v79 offset:3072
    v_mfma_f32_16x16x32_bf16 v[40:43], a[112:115], v[144:147], v[40:43]
    ds_read_b128 v[140:143], v17 offset:18432
    v_mul_f32 v76, v36, v36
    v_fma_f32 v76, v76, v66, v65
    v_mfma_f32_16x16x32_bf16 v[44:47], a[116:119], v[144:147], v[44:47]
    buffer_load_dwordx4 v[116:119], v17, s[48:51], s26 offen offset:3072 sc1
    v_mfma_f32_16x16x32_bf16 v[48:51], a[120:123], v[144:147], v[48:51]
    s_waitcnt lgkmcnt(4)
    v_mul_f32 v76, v76, v36
    v_fma_f32 v38, v62, v64, v38
    v_mfma_f32_16x16x32_bf16 v[40:43], a[0:3], v[128:131], v[40:43]
    ds_read_b128 v[144:147], v17 offset:19456
    v_mul_f32 v38, v38, v36
    v_mfma_f32_16x16x32_bf16 v[44:47], a[4:7], v[128:131], v[44:47]
    buffer_load_dwordx4 v[120:123], v17, s[48:51], s29 offen offset:3072 sc1
    v_mfma_f32_16x16x32_bf16 v[48:51], a[8:11], v[128:131], v[48:51]
    s_waitcnt lgkmcnt(4)
    v_exp_f32 v76, v76
    v_fma_f32 v37, v61, v64, v37
    v_mfma_f32_16x16x32_bf16 v[40:43], a[12:15], v[132:135], v[40:43]
    ds_read_b128 v[128:131], v17 offset:20480
    v_fma_f32 v76, v76, v67, v67
    v_mfma_f32_16x16x32_bf16 v[44:47], a[16:19], v[132:135], v[44:47]
    ds_read_b128 v[68:71], v15 offset:1536
    v_rcp_f32 v76, v76
    v_mfma_f32_16x16x32_bf16 v[48:51], a[20:23], v[132:135], v[48:51]
    s_waitcnt lgkmcnt(5)
    v_mul_f32 v38, v38, v76
    v_mul_f32 v77, v37, v37
    v_mfma_f32_16x16x32_bf16 v[40:43], a[24:27], v[136:139], v[40:43]
    ds_read_b128 v[132:135], v17 offset:21504
    v_fma_f32 v77, v77, v66, v65
    v_mfma_f32_16x16x32_bf16 v[44:47], a[28:31], v[136:139], v[44:47]
    buffer_load_dwordx4 v[124:127], v17, s[48:51], s18 offen offset:0 sc1
    v_mfma_f32_16x16x32_bf16 v[48:51], a[32:35], v[136:139], v[48:51]
    s_waitcnt lgkmcnt(4)
    v_mul_f32 v77, v77, v37
    v_exp_f32 v77, v77
    v_mfma_f32_16x16x32_bf16 v[40:43], a[36:39], v[140:143], v[40:43]
    ds_read_b128 v[136:139], v17 offset:22528
    v_fma_f32 v77, v77, v67, v67
    v_mfma_f32_16x16x32_bf16 v[44:47], a[40:43], v[140:143], v[44:47]
    s_waitcnt vmcnt(12)
    v_readfirstlane_b32 s8, v7
    s_nop 0
    s_cmp_ge_u32 s8, 16
    s_cbranch_scc0 kf_ck_slow
kf_ck_ok:
    v_mfma_f32_16x16x32_bf16 v[48:51], a[44:47], v[140:143], v[48:51]
    s_waitcnt lgkmcnt(4)
    v_rcp_f32 v77, v77
    v_fma_f32 v39, v63, v64, v39
    v_mfma_f32_16x16x32_bf16 v[40:43], a[48:51], v[144:147], v[40:43]
    ds_read_b128 v[140:143], v17 offset:23552
    v_mul_f32 v39, v39, v37
    v_mfma_f32_16x16x32_bf16 v[44:47], a[52:55], v[144:147], v[44:47]
    v_mul_f32 v39, v39, v77
    v_cvt_pk_bf16_f32 v80, v38, v39
    v_mfma_f32_16x16x32_bf16 v[48:51], a[56:59], v[144:147], v[48:51]
    s_waitcnt lgkmcnt(4)
    ds_write_b32 v12, v80 offset:3072
    v_mfma_f32_16x16x32_bf16 v[28:31], a[124:127], v[128:131], 0
    ds_read_b128 v[144:147], v17 offset:24576
    v_mfma_f32_16x16x32_bf16 v[32:35], a[128:131], v[128:131], 0
    s_add_u32 m0, s69, 0
    s_nop 0
    buffer_load_dwordx4 v17, s[48:51], s86 offen offset:0 sc1 lds
    v_mfma_f32_16x16x32_bf16 v[36:39], a[132:135], v[128:131], 0
    s_waitcnt lgkmcnt(4)
    v_mfma_f32_16x16x32_bf16 v[28:31], a[136:139], v[132:135], v[28:31]
    ds_read_b128 v[128:131], v17 offset:25600
    v_fma_f32 v40, v52, v68, v40
    v_mfma_f32_16x16x32_bf16 v[32:35], a[140:143], v[132:135], v[32:35]
    s_waitcnt vmcnt(8)
    s_waitcnt lgkmcnt(2)
    s_barrier
    v_mul_f32 v72, v40, v40
    v_fma_f32 v72, v72, v70, v69
    v_mfma_f32_16x16x32_bf16 v[36:39], a[144:147], v[132:135], v[36:39]
    v_mul_f32 v72, v72, v40
    v_fma_f32 v42, v54, v68, v42
    v_mfma_f32_16x16x32_bf16 v[28:31], a[148:151], v[136:139], v[28:31]
    ds_read_b128 v[132:135], v17 offset:26624
    v_mul_f32 v42, v42, v40
    v_mfma_f32_16x16x32_bf16 v[32:35], a[152:155], v[136:139], v[32:35]
    ds_read_b128 v[82:85], v13 offset:3072
    v_fma_f32 v41, v53, v68, v41
    v_mfma_f32_16x16x32_bf16 v[36:39], a[156:159], v[136:139], v[36:39]
    v_exp_f32 v72, v72
    v_mul_f32 v73, v41, v41
    v_mfma_f32_16x16x32_bf16 v[28:31], a[160:163], v[140:143], v[28:31]
    ds_read_b128 v[136:139], v17 offset:27648
    v_fma_f32 v72, v72, v71, v71
    v_mfma_f32_16x16x32_bf16 v[32:35], a[164:167], v[140:143], v[32:35]
    buffer_load_dwordx4 v17, s[48:51], s86 offen offset:1024 sc1 lds
    v_mfma_f32_16x16x32_bf16 v[36:39], a[168:171], v[140:143], v[36:39]
    s_waitcnt lgkmcnt(4)
    v_rcp_f32 v72, v72
    v_mfma_f32_16x16x32_bf16 v[28:31], a[172:175], v[144:147], v[28:31]
    ds_read_b128 v[140:143], v17 offset:28672
    v_mul_f32 v42, v42, v72
    v_fma_f32 v73, v73, v70, v69
    v_mfma_f32_16x16x32_bf16 v[32:35], a[176:179], v[144:147], v[32:35]
    s_waitcnt lgkmcnt(2)
    s_cbranch_vccz kf_as_4
    buffer_store_dwordx4 v[82:85], v14, s[48:51], s43 offen sc1
kf_as_4:
    v_mfma_f32_16x16x32_bf16 v[36:39], a[180:183], v[144:147], v[36:39]
    v_mul_f32 v73, v73, v41
    v_fma_f32 v43, v55, v68, v43
    v_mfma_f32_16x16x32_bf16 v[28:31], a[184:187], v[128:131], v[28:31]
    ds_read_b128 v[144:147], v17 offset:29696
    v_mul_f32 v43, v43, v41
    v_mfma_f32_16x16x32_bf16 v[32:35], a[188:191], v[128:131], v[32:35]
    buffer_load_dwordx4 v17, s[48:51], s86 offen offset:2048 sc1 lds
    v_mfma_f32_16x16x32_bf16 v[36:39], a[192:195], v[128:131], v[36:39]
    v_exp_f32 v73, v73
    v_mfma_f32_16x16x32_bf16 v[28:31], a[196:199], v[132:135], v[28:31]
    ds_read_b128 v[128:131], v17 offset:30720
    v_fma_f32 v73, v73, v71, v71
    v_fma_f32 v44, v56, v68, v44
    v_mfma_f32_16x16x32_bf16 v[32:35], a[200:203], v[132:135], v[32:35]
    v_rcp_f32 v73, v73
    v_mfma_f32_16x16x32_bf16 v[36:39], a[204:207], v[132:135], v[36:39]
    s_waitcnt lgkmcnt(3)
    v_mul_f32 v43, v43, v73
    v_cvt_pk_bf16_f32 v78, v42, v43
    v_mfma_f32_16x16x32_bf16 v[28:31], a[208:211], v[136:139], v[28:31]
    ds_read_b128 v[132:135], v17 offset:31744
    ds_write_b32 v10, v78 offset:6144
    v_mfma_f32_16x16x32_bf16 v[32:35], a[212:215], v[136:139], v[32:35]
    buffer_load_dwordx4 v17, s[48:51], s86 offen offset:3072 sc1 lds
    v_mfma_f32_16x16x32_bf16 v[36:39], a[216:219], v[136:139], v[36:39]
    s_branch kf_pw_k5_o
kf_pw_k5:
    s_branch kf_pw_k_ret
kf_pw_k5_o:
    s_waitcnt lgkmcnt(4)
    v_mul_f32 v74, v44, v44
    v_fma_f32 v74, v74, v70, v69
    v_mfma_f32_16x16x32_bf16 v[28:31], a[220:223], v[140:143], v[28:31]
    ds_read_b128 v[136:139], v17 offset:32768
    v_mul_f32 v74, v74, v44
    v_mfma_f32_16x16x32_bf16 v[32:35], a[224:227], v[140:143], v[32:35]
    s_add_u32 m0, s69, 4096
    s_nop 0
    buffer_load_dwordx4 v17, s[48:51], s87 offen offset:0 sc1 lds
    v_mfma_f32_16x16x32_bf16 v[36:39], a[228:231], v[140:143], v[36:39]
    s_waitcnt lgkmcnt(4)
    v_exp_f32 v74, v74
    v_mfma_f32_16x16x32_bf16 v[28:31], a[232:235], v[144:147], v[28:31]
    ds_read_b128 v[140:143], v17 offset:33792
    v_fma_f32 v74, v74, v71, v71
    v_fma_f32 v46, v58, v68, v46
    v_mfma_f32_16x16x32_bf16 v[32:35], a[236:239], v[144:147], v[32:35]
    buffer_load_dwordx4 v17, s[48:51], s87 offen offset:1024 sc1 lds
    v_mfma_f32_16x16x32_bf16 v[36:39], a[240:243], v[144:147], v[36:39]
    s_waitcnt lgkmcnt(4)
    v_rcp_f32 v74, v74
    v_mfma_f32_16x16x32_bf16 v[28:31], a[244:247], v[128:131], v[28:31]
    ds_read_b128 v[144:147], v17 offset:34816
    v_mul_f32 v46, v46, v44
    v_mfma_f32_16x16x32_bf16 v[32:35], a[248:251], v[128:131], v[32:35]
    v_mul_f32 v46, v46, v74
    v_fma_f32 v45, v57, v68, v45
    v_mul_f32 v75, v45, v45
    v_mfma_f32_16x16x32_bf16 v[36:39], a[252:255], v[128:131], v[36:39]
    s_waitcnt lgkmcnt(4)
    v_fma_f32 v75, v75, v70, v69
    v_mul_f32 v75, v75, v45
    v_mfma_f32_16x16x32_bf16 v[28:31], a[60:63], v[132:135], v[28:31]
    ds_read_b128 v[128:131], v17 offset:35840
    v_fma_f32 v47, v59, v68, v47
    v_mfma_f32_16x16x32_bf16 v[32:35], a[80:83], v[132:135], v[32:35]
    buffer_load_dwordx4 v17, s[48:51], s87 offen offset:2048 sc1 lds
    v_mfma_f32_16x16x32_bf16 v[36:39], a[84:87], v[132:135], v[36:39]
    s_waitcnt lgkmcnt(3)
    v_exp_f32 v75, v75
    v_mul_f32 v47, v47, v45
    v_mfma_f32_16x16x32_bf16 v[28:31], a[88:91], v[136:139], v[28:31]
    ds_read_b128 v[132:135], v17 offset:36864
    v_fma_f32 v75, v75, v71, v71
    v_mfma_f32_16x16x32_bf16 v[32:35], a[92:95], v[136:139], v[32:35]
    buffer_load_dwordx4 v17, s[48:51], s87 offen offset:3072 sc1 lds
    v_mfma_f32_16x16x32_bf16 v[36:39], a[96:99], v[136:139], v[36:39]
    s_waitcnt lgkmcnt(3)
    v_rcp_f32 v75, v75
    v_mfma_f32_16x16x32_bf16 v[28:31], a[100:103], v[140:143], v[28:31]
    ds_read_b128 v[136:139], v17 offset:37888
    v_mul_f32 v47, v47, v75
    v_mfma_f32_16x16x32_bf16 v[32:35], a[104:107], v[140:143], v[32:35]
    s_add_u32 m0, s69, 8192
    s_nop 0
    buffer_load_dwordx4 v17, s[48:51], s88 offen offset:0 sc1 lds
    v_mfma_f32_16x16x32_bf16 v[36:39], a[108:111], v[140:143], v[36:39]
    s_waitcnt lgkmcnt(3)
    v_cvt_pk_bf16_f32 v79, v46, v47
    ds_write_b32 v11, v79 offset:6144
    v_mfma_f32_16x16x32_bf16 v[28:31], a[112:115], v[144:147], v[28:31]
    ds_read_b128 v[140:143], v17 offset:38912
    v_fma_f32 v48, v60, v68, v48
    v_mfma_f32_16x16x32_bf16 v[32:35], a[116:119], v[144:147], v[32:35]
    v_mul_f32 v76, v48, v48
    v_fma_f32 v76, v76, v70, v69
    v_mfma_f32_16x16x32_bf16 v[36:39], a[120:123], v[144:147], v[36:39]
    s_waitcnt lgkmcnt(4)
    v_mul_f32 v76, v76, v48
    v_exp_f32 v76, v76
    v_mfma_f32_16x16x32_bf16 v[28:31], a[0:3], v[128:131], v[28:31]
    ds_read_b128 v[144:147], v17 offset:39936
    v_fma_f32 v76, v76, v71, v71
    v_mfma_f32_16x16x32_bf16 v[32:35], a[4:7], v[128:131], v[32:35]
    buffer_load_dwordx4 v17, s[48:51], s88 offen offset:1024 sc1 lds
    v_mfma_f32_16x16x32_bf16 v[36:39], a[8:11], v[128:131], v[36:39]
    s_waitcnt lgkmcnt(4)
    v_rcp_f32 v76, v76
    v_mfma_f32_16x16x32_bf16 v[28:31], a[12:15], v[132:135], v[28:31]
    ds_read_b128 v[128:131], v17 offset:40960
    v_fma_f32 v50, v62, v68, v50
    v_mfma_f32_16x16x32_bf16 v[32:35], a[16:19], v[132:135], v[32:35]
    ds_read_b128 v[64:67], v15 offset:768
    v_mul_f32 v50, v50, v48
    v_mul_f32 v50, v50, v76
    v_mfma_f32_16x16x32_bf16 v[36:39], a[20:23], v[132:135], v[36:39]
    s_waitcnt lgkmcnt(5)
    v_fma_f32 v49, v61, v68, v49
    v_mul_f32 v77, v49, v49
    v_mfma_f32_16x16x32_bf16 v[28:31], a[24:27], v[136:139], v[28:31]
    ds_read_b128 v[132:135], v17 offset:41984
    v_fma_f32 v77, v77, v70, v69
    v_mfma_f32_16x16x32_bf16 v[32:35], a[28:31], v[136:139], v[32:35]
    buffer_load_dwordx4 v17, s[48:51], s88 offen offset:2048 sc1 lds
    v_mfma_f32_16x16x32_bf16 v[36:39], a[32:35], v[136:139], v[36:39]
    s_waitcnt lgkmcnt(4)
    v_mul_f32 v77, v77, v49
    v_exp_f32 v77, v77
    v_mfma_f32_16x16x32_bf16 v[28:31], a[36:39], v[140:143], v[28:31]
    ds_read_b128 v[136:139], v17 offset:43008
    v_fma_f32 v77, v77, v71, v71
    v_mfma_f32_16x16x32_bf16 v[32:35], a[40:43], v[140:143], v[32:35]
    buffer_load_dwordx4 v17, s[48:51], s88 offen offset:3072 sc1 lds
    v_mfma_f32_16x16x32_bf16 v[36:39], a[44:47], v[140:143], v[36:39]
    s_waitcnt lgkmcnt(4)
    v_rcp_f32 v77, v77
    v_mfma_f32_16x16x32_bf16 v[28:31], a[48:51], v[144:147], v[28:31]
    ds_read_b128 v[140:143], v17 offset:44032
    v_fma_f32 v51, v63, v68, v51
    v_mfma_f32_16x16x32_bf16 v[32:35], a[52:55], v[144:147], v[32:35]
    v_mul_f32 v51, v51, v49
    v_mul_f32 v51, v51, v77
    v_cvt_pk_bf16_f32 v80, v50, v51
    v_mfma_f32_16x16x32_bf16 v[36:39], a[56:59], v[144:147], v[36:39]
    s_waitcnt lgkmcnt(4)
    ds_write_b32 v12, v80 offset:6144
    v_mfma_f32_16x16x32_bf16 v[40:43], a[124:127], v[128:131], 0
    ds_read_b128 v[144:147], v17 offset:45056
    v_mfma_f32_16x16x32_bf16 v[44:47], a[128:131], v[128:131], 0
    buffer_load_dwordx4 a[124:127], v17, s[48:51], s21 offen offset:0 sc1
    v_mfma_f32_16x16x32_bf16 v[48:51], a[132:135], v[128:131], 0
    s_waitcnt lgkmcnt(4)
    v_mfma_f32_16x16x32_bf16 v[40:43], a[136:139], v[132:135], v[40:43]
    ds_read_b128 v[128:131], v17 offset:46080
    v_fma_f32 v28, v52, v64, v28
    v_mul_f32 v72, v28, v28
    v_mfma_f32_16x16x32_bf16 v[44:47], a[140:143], v[132:135], v[44:47]
    s_waitcnt lgkmcnt(2)
    s_barrier
    v_fma_f32 v72, v72, v66, v65
    v_mfma_f32_16x16x32_bf16 v[48:51], a[144:147], v[132:135], v[48:51]
    v_mul_f32 v72, v72, v28
    v_exp_f32 v72, v72
    v_mfma_f32_16x16x32_bf16 v[40:43], a[148:151], v[136:139], v[40:43]
    ds_read_b128 v[132:135], v17 offset:47104
    v_fma_f32 v72, v72, v67, v67
    v_mfma_f32_16x16x32_bf16 v[44:47], a[152:155], v[136:139], v[44:47]
    ds_read_b128 v[82:85], v13 offset:6144
    v_rcp_f32 v72, v72
    v_mfma_f32_16x16x32_bf16 v[48:51], a[156:159], v[136:139], v[48:51]
    v_fma_f32 v30, v54, v64, v30
    v_mul_f32 v30, v30, v28
    v_mfma_f32_16x16x32_bf16 v[40:43], a[160:163], v[140:143], v[40:43]
    ds_read_b128 v[136:139], v17 offset:48128
    v_mul_f32 v30, v30, v72
    v_fma_f32 v29, v53, v64, v29
    v_mfma_f32_16x16x32_bf16 v[44:47], a[164:167], v[140:143], v[44:47]
    buffer_load_dwordx4 a[128:131], v17, s[48:51], s24 offen offset:0 sc1
    v_mfma_f32_16x16x32_bf16 v[48:51], a[168:171], v[140:143], v[48:51]
    s_waitcnt lgkmcnt(4)
    v_mul_f32 v73, v29, v29
    v_fma_f32 v73, v73, v66, v65
    v_mul_f32 v73, v73, v29
    v_mfma_f32_16x16x32_bf16 v[40:43], a[172:175], v[144:147], v[40:43]
    ds_read_b128 v[140:143], v17 offset:49152
    v_fma_f32 v31, v55, v64, v31
    v_mfma_f32_16x16x32_bf16 v[44:47], a[176:179], v[144:147], v[44:47]
    s_waitcnt lgkmcnt(2)
    s_cbranch_vccz kf_as_5
    buffer_store_dwordx4 v[82:85], v14, s[48:51], s68 offen sc1
kf_as_5:
    v_mfma_f32_16x16x32_bf16 v[48:51], a[180:183], v[144:147], v[48:51]
    v_exp_f32 v73, v73
    v_mul_f32 v31, v31, v29
    v_mfma_f32_16x16x32_bf16 v[40:43], a[184:187], v[128:131], v[40:43]
    ds_read_b128 v[144:147], v17 offset:50176
    v_fma_f32 v73, v73, v67, v67
    v_mfma_f32_16x16x32_bf16 v[44:47], a[188:191], v[128:131], v[44:47]
    buffer_load_dwordx4 a[132:135], v17, s[48:51], s27 offen offset:0 sc1
    v_mfma_f32_16x16x32_bf16 v[48:51], a[192:195], v[128:131], v[48:51]
    v_rcp_f32 v73, v73
    v_fma_f32 v32, v56, v64, v32
    v_mfma_f32_16x16x32_bf16 v[40:43], a[196:199], v[132:135], v[40:43]
    ds_read_b128 v[128:131], v17 offset:51200
    v_mul_f32 v31, v31, v73
    v_mfma_f32_16x16x32_bf16 v[44:47], a[200:203], v[132:135], v[44:47]
    buffer_load_dwordx4 a[136:139], v17, s[48:51], s30 offen offset:0 sc1
    v_mfma_f32_16x16x32_bf16 v[48:51], a[204:207], v[132:135], v[48:51]
    s_waitcnt lgkmcnt(3)
    v_cvt_pk_bf16_f32 v78, v30, v31
    ds_write_b32 v10, v78 offset:0
    v_mfma_f32_16x16x32_bf16 v[40:43], a[208:211], v[136:139], v[40:43]
    ds_read_b128 v[132:135], v17 offset:52224
    v_mul_f32 v74, v32, v32
    v_fma_f32 v74, v74, v66, v65
    v_mfma_f32_16x16x32_bf16 v[44:47], a[212:215], v[136:139], v[44:47]
    buffer_load_dwordx4 a[140:143], v17, s[48:51], s18 offen offset:1024 sc1
    v_mfma_f32_16x16x32_bf16 v[48:51], a[216:219], v[136:139], v[48:51]
    s_waitcnt lgkmcnt(4)
    v_mul_f32 v74, v74, v32
    v_fma_f32 v34, v58, v64, v34
    v_mfma_f32_16x16x32_bf16 v[40:43], a[220:223], v[140:143], v[40:43]
    ds_read_b128 v[136:139], v17 offset:53248
    v_exp_f32 v74, v74
    v_mfma_f32_16x16x32_bf16 v[44:47], a[224:227], v[140:143], v[44:47]
    buffer_load_dwordx4 a[144:147], v17, s[48:51], s21 offen offset:1024 sc1
    v_mfma_f32_16x16x32_bf16 v[48:51], a[228:231], v[140:143], v[48:51]
    s_waitcnt lgkmcnt(4)
    v_fma_f32 v74, v74, v67, v67
    v_mul_f32 v34, v34, v32
    v_mfma_f32_16x16x32_bf16 v[40:43], a[232:235], v[144:147], v[40:43]
    ds_read_b128 v[140:143], v17 offset:54272
    v_rcp_f32 v74, v74
    v_mfma_f32_16x16x32_bf16 v[44:47], a[236:239], v[144:147], v[44:47]
    buffer_load_dwordx4 a[148:151], v17, s[48:51], s24 offen offset:1024 sc1
    v_mfma_f32_16x16x32_bf16 v[48:51], a[240:243], v[144:147], v[48:51]
    s_waitcnt lgkmcnt(4)
    v_mul_f32 v34, v34, v74
    v_fma_f32 v33, v57, v64, v33
    v_mfma_f32_16x16x32_bf16 v[40:43], a[244:247], v[128:131], v[40:43]
    ds_read_b128 v[144:147], v17 offset:55296
    v_mul_f32 v75, v33, v33
    v_fma_f32 v75, v75, v66, v65
    v_mfma_f32_16x16x32_bf16 v[44:47], a[248:251], v[128:131], v[44:47]
    buffer_load_dwordx4 a[152:155], v17, s[48:51], s27 offen offset:1024 sc1
    v_mfma_f32_16x16x32_bf16 v[48:51], a[252:255], v[128:131], v[48:51]
    s_waitcnt lgkmcnt(3)
    v_mul_f32 v75, v75, v33
    v_exp_f32 v75, v75
    v_mfma_f32_16x16x32_bf16 v[40:43], a[60:63], v[132:135], v[40:43]
    ds_read_b128 v[128:131], v17 offset:56320
    v_fma_f32 v75, v75, v67, v67
    v_mfma_f32_16x16x32_bf16 v[44:47], a[80:83], v[132:135], v[44:47]
    buffer_load_dwordx4 a[156:159], v17, s[48:51], s30 offen offset:1024 sc1
    v_mfma_f32_16x16x32_bf16 v[48:51], a[84:87], v[132:135], v[48:51]
    s_waitcnt lgkmcnt(3)
    v_rcp_f32 v75, v75
    v_fma_f32 v35, v59, v64, v35
    v_mfma_f32_16x16x32_bf16 v[40:43], a[88:91], v[136:139], v[40:43]
    ds_read_b128 v[132:135], v17 offset:57344
    v_mul_f32 v35, v35, v33
    v_mfma_f32_16x16x32_bf16 v[44:47], a[92:95], v[136:139], v[44:47]
    buffer_load_dwordx4 a[192:195], v17, s[48:51], s89 offen offset:0 sc1
    v_mfma_f32_16x16x32_bf16 v[48:51], a[96:99], v[136:139], v[48:51]
    s_waitcnt lgkmcnt(3)
    v_mul_f32 v35, v35, v75
    v_cvt_pk_bf16_f32 v79, v34, v35
    v_fma_f32 v36, v60, v64, v36
    v_mfma_f32_16x16x32_bf16 v[40:43], a[100:103], v[140:143], v[40:43]
    ds_read_b128 v[136:139], v17 offset:58368
    ds_write_b32 v11, v79 offset:0
    v_mfma_f32_16x16x32_bf16 v[44:47], a[104:107], v[140:143], v[44:47]
    buffer_load_dwordx4 a[196:199], v17, s[48:51], s89 offen offset:1024 sc1
    v_mfma_f32_16x16x32_bf16 v[48:51], a[108:111], v[140:143], v[48:51]
    s_waitcnt lgkmcnt(4)
    v_mul_f32 v76, v36, v36
    v_fma_f32 v76, v76, v66, v65
    v_mfma_f32_16x16x32_bf16 v[40:43], a[112:115], v[144:147], v[40:43]
    ds_read_b128 v[140:143], v17 offset:59392
    v_mul_f32 v76, v76, v36
    v_fma_f32 v38, v62, v64, v38
    v_mfma_f32_16x16x32_bf16 v[44:47], a[116:119], v[144:147], v[44:47]
    buffer_load_dwordx4 a[200:203], v17, s[48:51], s89 offen offset:2048 sc1
    v_mfma_f32_16x16x32_bf16 v[48:51], a[120:123], v[144:147], v[48:51]
    s_waitcnt lgkmcnt(4)
    v_exp_f32 v76, v76
    v_mfma_f32_16x16x32_bf16 v[40:43], a[0:3], v[128:131], v[40:43]
    ds_read_b128 v[144:147], v17 offset:60416
    v_fma_f32 v76, v76, v67, v67
    v_mul_f32 v38, v38, v36
    v_mfma_f32_16x16x32_bf16 v[44:47], a[4:7], v[128:131], v[44:47]
    buffer_load_dwordx4 a[204:207], v17, s[48:51], s89 offen offset:3072 sc1
    v_mfma_f32_16x16x32_bf16 v[48:51], a[8:11], v[128:131], v[48:51]
    s_waitcnt lgkmcnt(4)
    v_rcp_f32 v76, v76
    v_mfma_f32_16x16x32_bf16 v[40:43], a[12:15], v[132:135], v[40:43]
    s_waitcnt vmcnt(24)
    ds_read_b128 v[128:131], v16 offset:0
    v_mul_f32 v38, v38, v76
    v_fma_f32 v37, v61, v64, v37
    v_mfma_f32_16x16x32_bf16 v[44:47], a[16:19], v[132:135], v[44:47]
    ds_read_b128 v[68:71], v15 offset:1792
    v_mul_f32 v77, v37, v37
    v_fma_f32 v77, v77, v66, v65
    v_mfma_f32_16x16x32_bf16 v[48:51], a[20:23], v[132:135], v[48:51]
    s_waitcnt lgkmcnt(5)
    v_mul_f32 v77, v77, v37
    v_fma_f32 v39, v63, v64, v39
    v_mfma_f32_16x16x32_bf16 v[40:43], a[24:27], v[136:139], v[40:43]
    s_waitcnt vmcnt(23)
    ds_read_b128 v[132:135], v16 offset:1024
    v_exp_f32 v77, v77
    v_mfma_f32_16x16x32_bf16 v[44:47], a[28:31], v[136:139], v[44:47]
    buffer_load_dwordx4 a[208:211], v17, s[48:51], s90 offen offset:0 sc1
    v_mfma_f32_16x16x32_bf16 v[48:51], a[32:35], v[136:139], v[48:51]
    s_waitcnt lgkmcnt(4)
    v_fma_f32 v77, v77, v67, v67
    v_mul_f32 v39, v39, v37
    v_mfma_f32_16x16x32_bf16 v[40:43], a[36:39], v[140:143], v[40:43]
    s_waitcnt vmcnt(23)
    ds_read_b128 v[136:139], v16 offset:2048
    v_rcp_f32 v77, v77
    v_mfma_f32_16x16x32_bf16 v[44:47], a[40:43], v[140:143], v[44:47]
    buffer_load_dwordx4 a[212:215], v17, s[48:51], s90 offen offset:1024 sc1
    v_mfma_f32_16x16x32_bf16 v[48:51], a[44:47], v[140:143], v[48:51]
    s_waitcnt lgkmcnt(4)
    v_mul_f32 v39, v39, v77
    v_cvt_pk_bf16_f32 v80, v38, v39
    v_mfma_f32_16x16x32_bf16 v[40:43], a[48:51], v[144:147], v[40:43]
    s_waitcnt vmcnt(23)
    ds_read_b128 v[140:143], v16 offset:3072
    ds_write_b32 v12, v80 offset:0
    v_mfma_f32_16x16x32_bf16 v[44:47], a[52:55], v[144:147], v[44:47]
    buffer_load_dwordx4 a[216:219], v17, s[48:51], s90 offen offset:2048 sc1
    v_mfma_f32_16x16x32_bf16 v[48:51], a[56:59], v[144:147], v[48:51]
    buffer_load_dwordx4 a[220:223], v17, s[48:51], s90 offen offset:3072 sc1
    s_waitcnt lgkmcnt(5)
    v_mfma_f32_16x16x32_bf16 a[0:3], v[148:151], v[128:131], 0
    s_waitcnt vmcnt(24)
    ds_read_b128 v[144:147], v16 offset:4096
    v_mfma_f32_16x16x32_bf16 a[16:19], v[152:155], v[128:131], 0
    s_mov_b32 s81, 147456
    s_mov_b32 s82, 344064
    v_mfma_f32_16x16x32_bf16 a[32:35], v[156:159], v[128:131], 0
    s_waitcnt lgkmcnt(5)
    v_mfma_f32_16x16x32_bf16 a[48:51], v[160:163], v[128:131], 0
    v_fma_f32 v40, v52, v68, v40
    v_mul_f32 v72, v40, v40
    v_fma_f32 v72, v72, v70, v69
    v_mfma_f32_16x16x32_bf16 a[80:83], v[164:167], v[128:131], 0
    v_mul_f32 v72, v72, v40
    v_exp_f32 v72, v72
    s_waitcnt lgkmcnt(4)
    v_mfma_f32_16x16x32_bf16 a[0:3], v[168:171], v[132:135], a[0:3]
    s_waitcnt vmcnt(23)
    ds_read_b128 v[128:131], v16 offset:5120
    v_fma_f32 v72, v72, v71, v71
    v_fma_f32 v42, v54, v68, v42
    v_mfma_f32_16x16x32_bf16 a[16:19], v[172:175], v[132:135], a[16:19]
    v_rcp_f32 v72, v72
    v_mul_f32 v42, v42, v40
    v_mfma_f32_16x16x32_bf16 a[32:35], v[176:179], v[132:135], a[32:35]
    v_mul_f32 v42, v42, v72
    v_fma_f32 v41, v53, v68, v41
    v_mul_f32 v73, v41, v41
    v_mfma_f32_16x16x32_bf16 a[48:51], v[180:183], v[132:135], a[48:51]
    v_fma_f32 v73, v73, v70, v69
    v_mul_f32 v73, v73, v41
    v_fma_f32 v43, v55, v68, v43
    v_mfma_f32_16x16x32_bf16 a[80:83], v[184:187], v[132:135], a[80:83]
    v_exp_f32 v73, v73
    v_mul_f32 v43, v43, v41
    s_waitcnt lgkmcnt(4)
    v_mfma_f32_16x16x32_bf16 a[0:3], v[188:191], v[136:139], a[0:3]
    s_waitcnt vmcnt(22)
    ds_read_b128 v[132:135], v16 offset:6144
    v_fma_f32 v73, v73, v71, v71
    v_fma_f32 v44, v56, v68, v44
    v_mfma_f32_16x16x32_bf16 a[16:19], v[192:195], v[136:139], a[16:19]
    v_rcp_f32 v73, v73
    v_mul_f32 v74, v44, v44
    v_mfma_f32_16x16x32_bf16 a[32:35], v[196:199], v[136:139], a[32:35]
    v_mul_f32 v43, v43, v73
    v_cvt_pk_bf16_f32 v78, v42, v43
    v_fma_f32 v74, v74, v70, v69
    v_mfma_f32_16x16x32_bf16 a[48:51], v[200:203], v[136:139], a[48:51]
    ds_write_b32 v10, v78 offset:3072
    v_mul_f32 v74, v74, v44
    v_mfma_f32_16x16x32_bf16 a[80:83], v[204:207], v[136:139], a[80:83]
    v_exp_f32 v74, v74
    v_fma_f32 v46, v58, v68, v46
    s_waitcnt lgkmcnt(5)
    v_mfma_f32_16x16x32_bf16 a[0:3], v[208:211], v[140:143], a[0:3]
    s_waitcnt vmcnt(21)
    ds_read_b128 v[136:139], v16 offset:7168
    v_fma_f32 v74, v74, v71, v71
    v_mul_f32 v46, v46, v44
    v_mfma_f32_16x16x32_bf16 a[16:19], v[212:215], v[140:143], a[16:19]
    v_rcp_f32 v74, v74
    v_fma_f32 v45, v57, v68, v45
    v_mfma_f32_16x16x32_bf16 a[32:35], v[216:219], v[140:143], a[32:35]
    v_mul_f32 v46, v46, v74
    v_mul_f32 v75, v45, v45
    v_mfma_f32_16x16x32_bf16 a[48:51], v[220:223], v[140:143], a[48:51]
    v_fma_f32 v75, v75, v70, v69
    v_mul_f32 v75, v75, v45
    v_fma_f32 v47, v59, v68, v47
    v_mfma_f32_16x16x32_bf16 a[80:83], v[224:227], v[140:143], a[80:83]
    v_exp_f32 v75, v75
    v_mul_f32 v47, v47, v45
    s_waitcnt lgkmcnt(4)
    v_mfma_f32_16x16x32_bf16 a[0:3], v[228:231], v[144:147], a[0:3]
    s_waitcnt vmcnt(20)
    ds_read_b128 v[140:143], v16 offset:8192
    v_fma_f32 v75, v75, v71, v71
    v_fma_f32 v48, v60, v68, v48
    v_mfma_f32_16x16x32_bf16 a[16:19], v[232:235], v[144:147], a[16:19]
    v_rcp_f32 v75, v75
    v_mul_f32 v76, v48, v48
    v_mfma_f32_16x16x32_bf16 a[32:35], v[236:239], v[144:147], a[32:35]
    v_mul_f32 v47, v47, v75
    v_cvt_pk_bf16_f32 v79, v46, v47
    v_fma_f32 v76, v76, v70, v69
    v_mfma_f32_16x16x32_bf16 a[48:51], v[240:243], v[144:147], a[48:51]
    ds_write_b32 v11, v79 offset:3072
    v_mul_f32 v76, v76, v48
    v_mfma_f32_16x16x32_bf16 a[80:83], v[244:247], v[144:147], a[80:83]
    v_exp_f32 v76, v76
    v_fma_f32 v50, v62, v68, v50
    s_waitcnt lgkmcnt(5)
    v_mfma_f32_16x16x32_bf16 a[0:3], v[248:251], v[128:131], a[0:3]
    s_waitcnt vmcnt(19)
    ds_read_b128 v[144:147], v16 offset:9216
    v_fma_f32 v76, v76, v71, v71
    v_mul_f32 v50, v50, v48
    v_mfma_f32_16x16x32_bf16 a[16:19], v[252:255], v[128:131], a[16:19]
    v_rcp_f32 v76, v76
    v_fma_f32 v49, v61, v68, v49
    v_mfma_f32_16x16x32_bf16 a[32:35], a[64:67], v[128:131], a[32:35]
    v_mul_f32 v50, v50, v76
    v_mul_f32 v77, v49, v49
    v_fma_f32 v77, v77, v70, v69
    v_mfma_f32_16x16x32_bf16 a[48:51], a[68:71], v[128:131], a[48:51]
    v_mul_f32 v77, v77, v49
    v_exp_f32 v77, v77
    v_mfma_f32_16x16x32_bf16 a[80:83], a[72:75], v[128:131], a[80:83]
    v_fma_f32 v77, v77, v71, v71
    v_rcp_f32 v77, v77
    s_waitcnt lgkmcnt(5)
    v_mfma_f32_16x16x32_bf16 a[0:3], a[76:79], v[132:135], a[0:3]
    s_waitcnt vmcnt(18)
    ds_read_b128 v[128:131], v16 offset:10240
    v_fma_f32 v51, v63, v68, v51
    v_mul_f32 v51, v51, v49
    v_mfma_f32_16x16x32_bf16 a[16:19], v[88:91], v[132:135], a[16:19]
    v_mul_f32 v51, v51, v77
    v_cvt_pk_bf16_f32 v80, v50, v51
    v_mfma_f32_16x16x32_bf16 a[32:35], v[92:95], v[132:135], a[32:35]
    ds_write_b32 v12, v80 offset:3072
    v_mfma_f32_16x16x32_bf16 a[48:51], v[96:99], v[132:135], a[48:51]
    v_mfma_f32_16x16x32_bf16 a[80:83], v[100:103], v[132:135], a[80:83]
    s_waitcnt lgkmcnt(0)
    s_barrier
    ds_read_b128 v[82:85], v13 offset:0
    ds_read_b128 v[72:75], v13 offset:3072
    v_mfma_f32_16x16x32_bf16 a[0:3], v[104:107], v[136:139], a[0:3]
    s_waitcnt vmcnt(17)
    ds_read_b128 v[132:135], v16 offset:11264
    v_mfma_f32_16x16x32_bf16 a[16:19], v[108:111], v[136:139], a[16:19]
    buffer_load_dwordx4 a[160:163], v17, s[48:51], s18 offen offset:2048 sc1
    v_mfma_f32_16x16x32_bf16 a[32:35], v[112:115], v[136:139], a[32:35]
    v_mfma_f32_16x16x32_bf16 a[48:51], v[116:119], v[136:139], a[48:51]
    buffer_load_dwordx4 a[164:167], v17, s[48:51], s21 offen offset:2048 sc1
    v_mfma_f32_16x16x32_bf16 a[80:83], v[120:123], v[136:139], a[80:83]
    s_waitcnt vmcnt(9)
    v_mfma_f32_16x16x32_bf16 a[4:7], v[148:151], a[192:195], 0
    s_waitcnt lgkmcnt(1)
    s_cbranch_vccz kf_as_fin
    buffer_store_dwordx4 v[82:85], v14, s[48:51], s81 offen sc1
    buffer_store_dwordx4 v[72:75], v14, s[48:51], s82 offen sc1
kf_as_fin:
    v_mfma_f32_16x16x32_bf16 a[20:23], v[152:155], a[192:195], 0
    buffer_load_dwordx4 a[168:171], v17, s[48:51], s24 offen offset:2048 sc1
    v_mfma_f32_16x16x32_bf16 a[36:39], v[156:159], a[192:195], 0
    v_lshl_add_u32 v5, v3, 2, v2
    v_and_b32 v5, 15, v5
    v_mfma_f32_16x16x32_bf16 a[52:55], v[160:163], a[192:195], 0
    buffer_load_dwordx4 a[240:243], v17, s[48:51], s27 offen offset:2048 sc1
    v_mfma_f32_16x16x32_bf16 a[84:87], v[164:167], a[192:195], 0
    v_lshlrev_b32 v5, 4, v5
    v_lshl_add_u32 v5, v3, 8, v5
    s_mul_i32 s75, s64, 20480
    s_waitcnt vmcnt(10)
    v_mfma_f32_16x16x32_bf16 a[4:7], v[168:171], a[196:199], a[4:7]
    buffer_load_dwordx4 a[244:247], v17, s[48:51], s30 offen offset:2048 sc1
    v_mfma_f32_16x16x32_bf16 a[20:23], v[172:175], a[196:199], a[20:23]
    v_add_u32 v8, s75, v5
    s_mul_i32 s75, s64, 2560
    s_add_u32 s75, s75, 81920
    v_mfma_f32_16x16x32_bf16 a[36:39], v[176:179], a[196:199], a[36:39]
    buffer_load_dwordx4 a[248:251], v17, s[48:51], s18 offen offset:3072 sc1
    v_mfma_f32_16x16x32_bf16 a[52:55], v[180:183], a[196:199], a[52:55]
    v_lshlrev_b32 v5, 3, v1
    v_add_u32 v9, s75, v5
    v_mfma_f32_16x16x32_bf16 a[84:87], v[184:187], a[196:199], a[84:87]
    buffer_load_dwordx4 a[252:255], v17, s[48:51], s21 offen offset:3072 sc1
    s_waitcnt vmcnt(12)
    v_mfma_f32_16x16x32_bf16 a[4:7], v[188:191], a[200:203], a[4:7]
    ds_write_b64 v9, v[18:19] offset:0
    v_mfma_f32_16x16x32_bf16 a[20:23], v[192:195], a[200:203], a[20:23]
    buffer_load_dwordx4 v[28:31], v17, s[48:51], s24 offen offset:3072 sc1
    v_mfma_f32_16x16x32_bf16 a[36:39], v[196:199], a[200:203], a[36:39]
    ds_write_b64 v9, v[20:21] offset:512
    v_mfma_f32_16x16x32_bf16 a[52:55], v[200:203], a[200:203], a[52:55]
    buffer_load_dwordx4 v[32:35], v17, s[48:51], s27 offen offset:3072 sc1
    v_mfma_f32_16x16x32_bf16 a[84:87], v[204:207], a[200:203], a[84:87]
    ds_write_b64 v9, v[22:23] offset:1024
    s_waitcnt vmcnt(13)
    v_mfma_f32_16x16x32_bf16 a[4:7], v[208:211], a[204:207], a[4:7]
    buffer_load_dwordx4 v[36:39], v17, s[48:51], s30 offen offset:3072 sc1
    v_mfma_f32_16x16x32_bf16 a[20:23], v[212:215], a[204:207], a[20:23]
    ds_write_b64 v9, v[24:25] offset:1536
    v_mfma_f32_16x16x32_bf16 a[36:39], v[216:219], a[204:207], a[36:39]
    buffer_load_dwordx4 a[224:227], v17, s[48:51], s91 offen offset:0 sc1
    v_mfma_f32_16x16x32_bf16 a[52:55], v[220:223], a[204:207], a[52:55]
    ds_write_b64 v9, v[26:27] offset:2048
    s_lshl_b32 s75, s64, 2
    v_mfma_f32_16x16x32_bf16 a[84:87], v[224:227], a[204:207], a[84:87]
    buffer_load_dwordx4 a[228:231], v17, s[48:51], s91 offen offset:1024 sc1
    s_waitcnt vmcnt(15)
    v_mfma_f32_16x16x32_bf16 a[4:7], v[228:231], a[208:211], a[4:7]
    v_add_u32 v5, s75, v2
    v_and_b32 v5, 15, v5
    v_mfma_f32_16x16x32_bf16 a[20:23], v[232:235], a[208:211], a[20:23]
    buffer_load_dwordx4 a[232:235], v17, s[48:51], s91 offen offset:2048 sc1
    v_mfma_f32_16x16x32_bf16 a[36:39], v[236:239], a[208:211], a[36:39]
    v_lshlrev_b32 v5, 4, v5
    v_lshrrev_b32 v6, 2, v2
    v_mfma_f32_16x16x32_bf16 a[52:55], v[240:243], a[208:211], a[52:55]
    buffer_load_dwordx4 a[236:239], v17, s[48:51], s91 offen offset:3072 sc1
    v_mfma_f32_16x16x32_bf16 a[84:87], v[244:247], a[208:211], a[84:87]
    v_lshl_add_u32 v5, v6, 8, v5
    v_lshl_add_u32 v10, v3, 10, v5
    s_waitcnt vmcnt(16)
    v_mfma_f32_16x16x32_bf16 a[4:7], v[248:251], a[212:215], a[4:7]
    v_add_u32 v11, 40960, v10
    v_lshl_add_u32 v12, v3, 12, v10
    v_mfma_f32_16x16x32_bf16 a[20:23], v[252:255], a[212:215], a[20:23]
    buffer_load_dwordx4 a[172:175], v17, s[48:51], s92 offen offset:0 sc1
    v_mfma_f32_16x16x32_bf16 a[36:39], a[64:67], a[212:215], a[36:39]
    v_add_u32 v13, 40960, v12
    v_and_b32 v5, 3, v2
    v_mfma_f32_16x16x32_bf16 a[52:55], a[68:71], a[212:215], a[52:55]
    v_add_u32 v5, s75, v5
    v_lshlrev_b32 v14, 3, v5
    v_mfma_f32_16x16x32_bf16 a[84:87], a[72:75], a[212:215], a[84:87]
    v_lshl_add_u32 v14, v6, 7, v14
    v_lshl_add_u32 v14, v3, 9, v14
    s_waitcnt vmcnt(16)
    v_mfma_f32_16x16x32_bf16 a[4:7], a[76:79], a[216:219], a[4:7]
    buffer_load_dwordx4 a[176:179], v17, s[48:51], s92 offen offset:1024 sc1
    v_mfma_f32_16x16x32_bf16 a[20:23], v[88:91], a[216:219], a[20:23]
    v_add_u32 v14, 81920, v14
    v_lshl_add_u32 v15, v3, 11, v14
    v_mfma_f32_16x16x32_bf16 a[36:39], v[92:95], a[216:219], a[36:39]
    v_mul_u32_u24 v5, 1280, v5
    v_lshl_add_u32 v5, v6, 3, v5
    v_mfma_f32_16x16x32_bf16 a[52:55], v[96:99], a[216:219], a[52:55]
    v_lshl_add_u32 v0, v3, 5, v5
    v_mul_u32_u24 v7, 20480, v3
    v_mfma_f32_16x16x32_bf16 a[84:87], v[100:103], a[216:219], a[84:87]
    buffer_load_dwordx4 a[180:183], v17, s[48:51], s92 offen offset:2048 sc1
    s_waitcnt vmcnt(17)
    v_mfma_f32_16x16x32_bf16 a[4:7], v[104:107], a[220:223], a[4:7]
    v_add_u32 v7, v7, v5
    s_mul_i32 s16, s65, 81920
    s_mul_i32 s75, s66, 160
    v_mfma_f32_16x16x32_bf16 a[20:23], v[108:111], a[220:223], a[20:23]
    s_add_u32 s16, s16, s75
    s_add_u32 s17, s16, 20480
    s_add_u32 s18, s16, 40960
    v_mfma_f32_16x16x32_bf16 a[36:39], v[112:115], a[220:223], a[36:39]
    s_add_u32 s19, s16, 61440
    v_mfma_f32_16x16x32_bf16 a[52:55], v[116:119], a[220:223], a[52:55]
    buffer_load_dwordx4 a[184:187], v17, s[48:51], s92 offen offset:3072 sc1
    v_mfma_f32_16x16x32_bf16 a[84:87], v[120:123], a[220:223], a[84:87]
    v_mfma_f32_16x16x32_bf16 a[0:3], v[124:127], v[140:143], a[0:3]
    v_mfma_f32_16x16x32_bf16 a[16:19], a[124:127], v[140:143], a[16:19]
    v_mfma_f32_16x16x32_bf16 a[32:35], a[128:131], v[140:143], a[32:35]
    buffer_load_dwordx4 a[188:191], v17, s[48:51], s93 offen offset:0 sc1
    v_mfma_f32_16x16x32_bf16 a[48:51], a[132:135], v[140:143], a[48:51]
    v_mfma_f32_16x16x32_bf16 a[80:83], a[136:139], v[140:143], a[80:83]
    v_mfma_f32_16x16x32_bf16 a[0:3], a[140:143], v[144:147], a[0:3]
    v_mfma_f32_16x16x32_bf16 a[16:19], a[144:147], v[144:147], a[16:19]
    buffer_load_dwordx4 a[96:99], v17, s[48:51], s93 offen offset:1024 sc1
    v_mfma_f32_16x16x32_bf16 a[32:35], a[148:151], v[144:147], a[32:35]
    v_mfma_f32_16x16x32_bf16 a[48:51], a[152:155], v[144:147], a[48:51]
    v_mfma_f32_16x16x32_bf16 a[80:83], a[156:159], v[144:147], a[80:83]
    s_waitcnt vmcnt(15)
    v_mfma_f32_16x16x32_bf16 a[0:3], a[160:163], v[128:131], a[0:3]
    buffer_load_dwordx4 a[100:103], v17, s[48:51], s93 offen offset:2048 sc1
    v_mfma_f32_16x16x32_bf16 a[16:19], a[164:167], v[128:131], a[16:19]
    v_mfma_f32_16x16x32_bf16 a[32:35], a[168:171], v[128:131], a[32:35]
    v_mfma_f32_16x16x32_bf16 a[48:51], a[240:243], v[128:131], a[48:51]
    v_mfma_f32_16x16x32_bf16 a[80:83], a[244:247], v[128:131], a[80:83]
    buffer_load_dwordx4 a[104:107], v17, s[48:51], s93 offen offset:3072 sc1
    s_waitcnt vmcnt(12)
    s_waitcnt lgkmcnt(5)
    v_mfma_f32_16x16x32_bf16 a[0:3], a[248:251], v[132:135], a[0:3]
    v_mfma_f32_16x16x32_bf16 a[16:19], a[252:255], v[132:135], a[16:19]
    v_mfma_f32_16x16x32_bf16 a[32:35], v[28:31], v[132:135], a[32:35]
    v_mfma_f32_16x16x32_bf16 a[48:51], v[32:35], v[132:135], a[48:51]
    buffer_load_dwordx4 a[108:111], v17, s[48:51], s44 offen offset:0 sc1
    v_mfma_f32_16x16x32_bf16 a[80:83], v[36:39], v[132:135], a[80:83]
    s_waitcnt vmcnt(12)
    v_mfma_f32_16x16x32_bf16 a[4:7], v[124:127], a[224:227], a[4:7]
    v_accvgpr_read_b32 v5, a0
    v_cmp_u_f32 vcc, v5, v5
    s_cbranch_vccnz kf_a0_slow
kf_a0_ok:
    v_mfma_f32_16x16x32_bf16 a[20:23], a[124:127], a[224:227], a[20:23]
    v_mfma_f32_16x16x32_bf16 a[36:39], a[128:131], a[224:227], a[36:39]
    buffer_load_dwordx4 a[112:115], v17, s[48:51], s44 offen offset:1024 sc1
    v_mfma_f32_16x16x32_bf16 a[52:55], a[132:135], a[224:227], a[52:55]
    v_mfma_f32_16x16x32_bf16 a[84:87], a[136:139], a[224:227], a[84:87]
    ds_write_b128 v8, a[0:3] offset:0
    s_waitcnt vmcnt(12)
    v_mfma_f32_16x16x32_bf16 a[4:7], a[140:143], a[228:231], a[4:7]
    ds_write_b128 v8, a[16:19] offset:1024
    v_mfma_f32_16x16x32_bf16 a[20:23], a[144:147], a[228:231], a[20:23]
    buffer_load_dwordx4 a[116:119], v17, s[48:51], s44 offen offset:2048 sc1
    v_mfma_f32_16x16x32_bf16 a[36:39], a[148:151], a[228:231], a[36:39]
    ds_write_b128 v8, a[32:35] offset:2048
    v_mfma_f32_16x16x32_bf16 a[52:55], a[152:155], a[228:231], a[52:55]
    s_branch kf_pw_k6_o
kf_pw_k6:
    s_branch kf_pw_k_ret
kf_pw_k6_o:
    ds_write_b128 v8, a[48:51] offset:3072
    v_mfma_f32_16x16x32_bf16 a[84:87], a[156:159], a[228:231], a[84:87]
    ds_write_b128 v8, a[80:83] offset:4096
    s_waitcnt vmcnt(12)
    v_mfma_f32_16x16x32_bf16 a[4:7], a[160:163], a[232:235], a[4:7]
    buffer_load_dwordx4 a[120:123], v17, s[48:51], s44 offen offset:3072 sc1
    v_mfma_f32_16x16x32_bf16 a[20:23], a[164:167], a[232:235], a[20:23]
    v_mfma_f32_16x16x32_bf16 a[36:39], a[168:171], a[232:235], a[36:39]
    v_mfma_f32_16x16x32_bf16 a[52:55], a[240:243], a[232:235], a[52:55]
    v_mfma_f32_16x16x32_bf16 a[84:87], a[244:247], a[232:235], a[84:87]
    s_waitcnt vmcnt(12)
    v_mfma_f32_16x16x32_bf16 a[4:7], a[248:251], a[236:239], a[4:7]
    v_mfma_f32_16x16x32_bf16 a[20:23], a[252:255], a[236:239], a[20:23]
    v_mfma_f32_16x16x32_bf16 a[36:39], v[28:31], a[236:239], a[36:39]
    s_waitcnt vmcnt(9)
    v_accvgpr_read_b32 v26, a172
    v_accvgpr_read_b32 v27, a176
    v_mfma_f32_16x16x32_bf16 a[52:55], v[32:35], a[236:239], a[52:55]
    v_accvgpr_read_b32 v6, a180
    v_max3_u32 v6, v6, v26, v27
    v_mfma_f32_16x16x32_bf16 a[84:87], v[36:39], a[236:239], a[84:87]
    v_cmp_eq_u32 vcc, -1, v6
    s_cbranch_vccnz kf_g20_slow
kf_g20_ok:
    v_mfma_f32_16x16x32_bf16 a[8:11], v[148:151], a[172:175], 0
    v_accvgpr_read_b32 v5, a4
    v_cmp_u_f32 vcc, v5, v5
    s_cbranch_vccnz kf_a1_slow
kf_a1_ok:
    v_mfma_f32_16x16x32_bf16 a[24:27], v[152:155], a[172:175], 0
    v_mfma_f32_16x16x32_bf16 a[40:43], v[156:159], a[172:175], 0
    v_mfma_f32_16x16x32_bf16 a[56:59], v[160:163], a[172:175], 0
    v_mfma_f32_16x16x32_bf16 a[88:91], v[164:167], a[172:175], 0
    ds_write_b128 v8, a[4:7] offset:5120
    v_mfma_f32_16x16x32_bf16 a[8:11], v[168:171], a[176:179], a[8:11]
    ds_write_b128 v8, a[20:23] offset:6144
    v_mfma_f32_16x16x32_bf16 a[24:27], v[172:175], a[176:179], a[24:27]
    ds_write_b128 v8, a[36:39] offset:7168
    v_mfma_f32_16x16x32_bf16 a[40:43], v[176:179], a[176:179], a[40:43]
    ds_write_b128 v8, a[52:55] offset:8192
    v_mfma_f32_16x16x32_bf16 a[56:59], v[180:183], a[176:179], a[56:59]
    ds_write_b128 v8, a[84:87] offset:9216
    v_mfma_f32_16x16x32_bf16 a[88:91], v[184:187], a[176:179], a[88:91]
    v_mfma_f32_16x16x32_bf16 a[8:11], v[188:191], a[180:183], a[8:11]
    buffer_load_dwordx4 v[40:43], v17, s[48:51], s45 offen offset:0 sc1
    v_mfma_f32_16x16x32_bf16 a[24:27], v[192:195], a[180:183], a[24:27]
    v_mfma_f32_16x16x32_bf16 a[40:43], v[196:199], a[180:183], a[40:43]
    s_waitcnt vmcnt(7)
    v_accvgpr_read_b32 v26, a184
    v_accvgpr_read_b32 v27, a188
    v_mfma_f32_16x16x32_bf16 a[56:59], v[200:203], a[180:183], a[56:59]
    v_accvgpr_read_b32 v6, a96
    v_max3_u32 v6, v6, v26, v27
    v_mfma_f32_16x16x32_bf16 a[88:91], v[204:207], a[180:183], a[88:91]
    buffer_load_dwordx4 v[44:47], v17, s[48:51], s45 offen offset:1024 sc1
    v_cmp_eq_u32 vcc, -1, v6
    s_cbranch_vccnz kf_g21_slow
kf_g21_ok:
    v_mfma_f32_16x16x32_bf16 a[8:11], v[208:211], a[184:187], a[8:11]
    s_waitcnt lgkmcnt(0)
    s_barrier
    v_mfma_f32_16x16x32_bf16 a[24:27], v[212:215], a[184:187], a[24:27]
    ds_read_b128 v[128:131], v10 offset:0
    v_mfma_f32_16x16x32_bf16 a[40:43], v[216:219], a[184:187], a[40:43]
    ds_read_b128 v[132:135], v10 offset:20480
    v_mfma_f32_16x16x32_bf16 a[56:59], v[220:223], a[184:187], a[56:59]
    buffer_load_dwordx4 v[48:51], v17, s[48:51], s45 offen offset:2048 sc1
    v_mfma_f32_16x16x32_bf16 a[88:91], v[224:227], a[184:187], a[88:91]
    ds_read_b128 v[136:139], v11 offset:0
    v_mfma_f32_16x16x32_bf16 a[8:11], v[228:231], a[188:191], a[8:11]
    ds_read_b128 v[140:143], v11 offset:20480
    v_mfma_f32_16x16x32_bf16 a[24:27], v[232:235], a[188:191], a[24:27]
    ds_read_b64 v[144:145], v14 offset:0
    v_mfma_f32_16x16x32_bf16 a[40:43], v[236:239], a[188:191], a[40:43]
    buffer_load_dwordx4 v[52:55], v17, s[48:51], s45 offen offset:3072 sc1
    v_mfma_f32_16x16x32_bf16 a[56:59], v[240:243], a[188:191], a[56:59]
    v_mfma_f32_16x16x32_bf16 a[88:91], v[244:247], a[188:191], a[88:91]
    v_mfma_f32_16x16x32_bf16 a[8:11], v[248:251], a[96:99], a[8:11]
    v_mfma_f32_16x16x32_bf16 a[24:27], v[252:255], a[96:99], a[24:27]
    buffer_load_dwordx4 v[56:59], v17, s[48:51], s46 offen offset:0 sc1
    v_mfma_f32_16x16x32_bf16 a[40:43], a[64:67], a[96:99], a[40:43]
    s_waitcnt vmcnt(8)
    v_accvgpr_read_b32 v26, a100
    v_accvgpr_read_b32 v27, a104
    v_mfma_f32_16x16x32_bf16 a[56:59], a[68:71], a[96:99], a[56:59]
    v_accvgpr_read_b32 v6, a108
    v_max3_u32 v6, v6, v26, v27
    v_mfma_f32_16x16x32_bf16 a[88:91], a[72:75], a[96:99], a[88:91]
    v_cmp_eq_u32 vcc, -1, v6
    s_cbranch_vccnz kf_g22_slow
kf_g22_ok:
    v_mfma_f32_16x16x32_bf16 a[8:11], a[76:79], a[100:103], a[8:11]
    buffer_load_dwordx4 v[60:63], v17, s[48:51], s46 offen offset:1024 sc1
    v_mfma_f32_16x16x32_bf16 a[24:27], v[88:91], a[100:103], a[24:27]
    s_waitcnt lgkmcnt(0)
    v_pk_add_f32 v[128:129], v[128:129], v[132:133]
    v_pk_add_f32 v[136:137], v[136:137], v[140:141]
    v_mfma_f32_16x16x32_bf16 a[40:43], v[92:95], a[100:103], a[40:43]
    v_pk_add_f32 v[130:131], v[130:131], v[134:135]
    v_pk_add_f32 v[138:139], v[138:139], v[142:143]
    v_mfma_f32_16x16x32_bf16 a[56:59], v[96:99], a[100:103], a[56:59]
    v_pk_add_f32 v[128:129], v[128:129], v[136:137]
    v_pk_add_f32 v[130:131], v[130:131], v[138:139]
    v_mfma_f32_16x16x32_bf16 a[88:91], v[100:103], a[100:103], a[88:91]
    buffer_load_dwordx4 v[64:67], v17, s[48:51], s46 offen offset:2048 sc1
    v_mfma_f32_16x16x32_bf16 a[8:11], v[104:107], a[104:107], a[8:11]
    v_lshlrev_b32 v132, 16, v144
    v_and_b32 v133, 0xffff0000, v144
    v_mfma_f32_16x16x32_bf16 a[24:27], v[108:111], a[104:107], a[24:27]
    v_lshlrev_b32 v134, 16, v145
    v_and_b32 v135, 0xffff0000, v145
    v_mfma_f32_16x16x32_bf16 a[40:43], v[112:115], a[104:107], a[40:43]
    v_cvt_pk_bf16_f32 v18, v128, v129
    v_cvt_pk_bf16_f32 v19, v130, v131
    v_mfma_f32_16x16x32_bf16 a[56:59], v[116:119], a[104:107], a[56:59]
    buffer_load_dwordx4 v[68:71], v17, s[48:51], s46 offen offset:3072 sc1
    v_mfma_f32_16x16x32_bf16 a[88:91], v[120:123], a[104:107], a[88:91]
    v_lshlrev_b32 v128, 16, v18
    v_and_b32 v129, 0xffff0000, v18
    v_mfma_f32_16x16x32_bf16 a[8:11], v[124:127], a[108:111], a[8:11]
    v_lshlrev_b32 v130, 16, v19
    v_and_b32 v131, 0xffff0000, v19
    v_mfma_f32_16x16x32_bf16 a[24:27], a[124:127], a[108:111], a[24:27]
    v_pk_add_f32 v[128:129], v[128:129], v[132:133]
    v_pk_add_f32 v[130:131], v[130:131], v[134:135]
    v_mfma_f32_16x16x32_bf16 a[40:43], a[128:131], a[108:111], a[40:43]
    buffer_load_dwordx4 v[72:75], v17, s[48:51], s47 offen offset:0 sc1
    s_waitcnt vmcnt(9)
    v_accvgpr_read_b32 v26, a112
    v_accvgpr_read_b32 v27, a116
    v_mfma_f32_16x16x32_bf16 a[56:59], a[132:135], a[108:111], a[56:59]
    v_accvgpr_read_b32 v6, a120
    v_max3_u32 v6, v6, v26, v27
    v_mfma_f32_16x16x32_bf16 a[88:91], a[136:139], a[108:111], a[88:91]
    v_cmp_eq_u32 vcc, -1, v6
    s_cbranch_vccnz kf_g23_slow
kf_g23_ok:
    v_mfma_f32_16x16x32_bf16 a[8:11], a[140:143], a[112:115], a[8:11]
    v_cvt_pk_bf16_f32 v20, v128, v129
    v_cvt_pk_bf16_f32 v21, v130, v131
    v_mfma_f32_16x16x32_bf16 a[24:27], a[144:147], a[112:115], a[24:27]
    buffer_load_dwordx4 v[76:79], v17, s[48:51], s47 offen offset:1024 sc1
    v_mfma_f32_16x16x32_bf16 a[40:43], a[148:151], a[112:115], a[40:43]
    buffer_store_dwordx2 v[20:21], v0, s[56:59], s16 offen offset:0
    v_mfma_f32_16x16x32_bf16 a[56:59], a[152:155], a[112:115], a[56:59]
    ds_read_b128 v[128:131], v10 offset:5120
    v_mfma_f32_16x16x32_bf16 a[88:91], a[156:159], a[112:115], a[88:91]
    ds_read_b128 v[132:135], v10 offset:25600
    v_mfma_f32_16x16x32_bf16 a[8:11], a[160:163], a[116:119], a[8:11]
    buffer_load_dwordx4 v[80:83], v17, s[48:51], s47 offen offset:2048 sc1
    v_mfma_f32_16x16x32_bf16 a[24:27], a[164:167], a[116:119], a[24:27]
    ds_read_b128 v[136:139], v11 offset:5120
    v_mfma_f32_16x16x32_bf16 a[40:43], a[168:171], a[116:119], a[40:43]
    ds_read_b128 v[140:143], v11 offset:25600
    v_mfma_f32_16x16x32_bf16 a[56:59], a[240:243], a[116:119], a[56:59]
    ds_read_b64 v[144:145], v14 offset:2560
    v_mfma_f32_16x16x32_bf16 a[88:91], a[244:247], a[116:119], a[88:91]
    buffer_load_dwordx4 v[84:87], v17, s[48:51], s47 offen offset:3072 sc1
    v_mfma_f32_16x16x32_bf16 a[8:11], a[248:251], a[120:123], a[8:11]
    v_mfma_f32_16x16x32_bf16 a[24:27], a[252:255], a[120:123], a[24:27]
    s_waitcnt vmcnt(10)
    v_max3_u32 v6, v40, v41, v42
    v_max3_u32 v26, v43, v44, v45
    v_mfma_f32_16x16x32_bf16 a[40:43], v[28:31], a[120:123], a[40:43]
    v_max3_u32 v6, v6, v46, v47
    v_max3_u32 v26, v26, v48, v49
    v_mfma_f32_16x16x32_bf16 a[56:59], v[32:35], a[120:123], a[56:59]
    v_max3_u32 v6, v6, v50, v51
    v_max_u32 v6, v6, v26
    v_mfma_f32_16x16x32_bf16 a[88:91], v[36:39], a[120:123], a[88:91]
    v_cmp_eq_u32 vcc, -1, v6
    s_cbranch_vccnz kf_g30_slow
kf_g30_ok:
    v_mfma_f32_16x16x32_bf16 a[12:15], v[148:151], v[40:43], 0
    v_accvgpr_read_b32 v5, a8
    v_cmp_u_f32 vcc, v5, v5
    s_cbranch_vccnz kf_a2_slow
kf_a2_ok:
    v_mfma_f32_16x16x32_bf16 a[28:31], v[152:155], v[40:43], 0
    s_waitcnt lgkmcnt(0)
    v_pk_add_f32 v[128:129], v[128:129], v[132:133]
    v_pk_add_f32 v[136:137], v[136:137], v[140:141]
    v_mfma_f32_16x16x32_bf16 a[44:47], v[156:159], v[40:43], 0
    v_pk_add_f32 v[130:131], v[130:131], v[134:135]
    v_pk_add_f32 v[138:139], v[138:139], v[142:143]
    v_mfma_f32_16x16x32_bf16 a[12:15], v[168:171], v[44:47], a[12:15]
    v_pk_add_f32 v[128:129], v[128:129], v[136:137]
    v_pk_add_f32 v[130:131], v[130:131], v[138:139]
    v_mfma_f32_16x16x32_bf16 a[28:31], v[172:175], v[44:47], a[28:31]
    ds_write_b128 v8, a[8:11] offset:10240
    v_mfma_f32_16x16x32_bf16 a[44:47], v[176:179], v[44:47], a[44:47]
    s_waitcnt vmcnt(7)
    v_max3_u32 v6, v52, v53, v54
    v_max3_u32 v26, v55, v56, v57
    v_mfma_f32_16x16x32_bf16 a[12:15], v[188:191], v[48:51], a[12:15]
    v_max3_u32 v6, v6, v58, v59
    v_max3_u32 v26, v26, v60, v61
    v_mfma_f32_16x16x32_bf16 a[28:31], v[192:195], v[48:51], a[28:31]
    v_max3_u32 v6, v6, v62, v63
    v_max_u32 v6, v6, v26
    v_mfma_f32_16x16x32_bf16 a[44:47], v[196:199], v[48:51], a[44:47]
    v_cmp_eq_u32 vcc, -1, v6
    s_cbranch_vccnz kf_g31_slow
kf_g31_ok:
    v_mfma_f32_16x16x32_bf16 a[12:15], v[208:211], v[52:55], a[12:15]
    ds_write_b128 v8, a[24:27] offset:11264
    v_mfma_f32_16x16x32_bf16 a[28:31], v[212:215], v[52:55], a[28:31]
    ds_write_b128 v8, a[40:43] offset:12288
    v_mfma_f32_16x16x32_bf16 a[44:47], v[216:219], v[52:55], a[44:47]
    ds_write_b128 v8, a[56:59] offset:13312
    v_mfma_f32_16x16x32_bf16 a[12:15], v[228:231], v[56:59], a[12:15]
    ds_write_b128 v8, a[88:91] offset:14336
    v_mfma_f32_16x16x32_bf16 a[28:31], v[232:235], v[56:59], a[28:31]
    v_lshlrev_b32 v132, 16, v144
    v_and_b32 v133, 0xffff0000, v144
    v_mfma_f32_16x16x32_bf16 a[44:47], v[236:239], v[56:59], a[44:47]
    s_waitcnt vmcnt(4)
    v_max3_u32 v6, v64, v65, v66
    v_max3_u32 v26, v67, v68, v69
    v_mfma_f32_16x16x32_bf16 a[12:15], v[248:251], v[60:63], a[12:15]
    v_max3_u32 v6, v6, v70, v71
    v_max3_u32 v26, v26, v72, v73
    v_mfma_f32_16x16x32_bf16 a[28:31], v[252:255], v[60:63], a[28:31]
    v_max3_u32 v6, v6, v74, v75
    v_max_u32 v6, v6, v26
    v_mfma_f32_16x16x32_bf16 a[44:47], a[64:67], v[60:63], a[44:47]
    v_cmp_eq_u32 vcc, -1, v6
    s_cbranch_vccnz kf_g32_slow
kf_g32_ok:
    v_mfma_f32_16x16x32_bf16 a[12:15], a[76:79], v[64:67], a[12:15]
    v_lshlrev_b32 v134, 16, v145
    v_and_b32 v135, 0xffff0000, v145
    v_mfma_f32_16x16x32_bf16 a[28:31], v[88:91], v[64:67], a[28:31]
    v_cvt_pk_bf16_f32 v22, v128, v129
    v_cvt_pk_bf16_f32 v23, v130, v131
    v_mfma_f32_16x16x32_bf16 a[44:47], v[92:95], v[64:67], a[44:47]
    v_lshlrev_b32 v128, 16, v22
    v_and_b32 v129, 0xffff0000, v22
    v_mfma_f32_16x16x32_bf16 a[12:15], v[104:107], v[68:71], a[12:15]
    v_lshlrev_b32 v130, 16, v23
    v_and_b32 v131, 0xffff0000, v23
    v_mfma_f32_16x16x32_bf16 a[28:31], v[108:111], v[68:71], a[28:31]
    v_pk_add_f32 v[128:129], v[128:129], v[132:133]
    v_pk_add_f32 v[130:131], v[130:131], v[134:135]
    v_mfma_f32_16x16x32_bf16 a[44:47], v[112:115], v[68:71], a[44:47]
    s_waitcnt vmcnt(0)
    v_max3_u32 v6, v76, v77, v78
    v_max3_u32 v26, v79, v80, v81
    v_mfma_f32_16x16x32_bf16 a[12:15], v[124:127], v[72:75], a[12:15]
    v_max3_u32 v6, v6, v82, v83
    v_max3_u32 v26, v26, v84, v85
    v_mfma_f32_16x16x32_bf16 a[28:31], a[124:127], v[72:75], a[28:31]
    v_max3_u32 v6, v6, v86, v87
    v_max_u32 v6, v6, v26
    v_mfma_f32_16x16x32_bf16 a[44:47], a[128:131], v[72:75], a[44:47]
    v_cmp_eq_u32 vcc, -1, v6
    s_cbranch_vccnz kf_g33_slow
kf_g33_ok:
    v_mfma_f32_16x16x32_bf16 a[12:15], a[140:143], v[76:79], a[12:15]
    v_cvt_pk_bf16_f32 v24, v128, v129
    v_cvt_pk_bf16_f32 v25, v130, v131
    v_mfma_f32_16x16x32_bf16 a[28:31], a[144:147], v[76:79], a[28:31]
    buffer_store_dwordx2 v[24:25], v0, s[56:59], s17 offen offset:0
    v_mfma_f32_16x16x32_bf16 a[44:47], a[148:151], v[76:79], a[44:47]
    s_waitcnt lgkmcnt(0)
    s_barrier
    v_mfma_f32_16x16x32_bf16 a[12:15], a[160:163], v[80:83], a[12:15]
    ds_read_b128 v[128:131], v10 offset:10240
    v_mfma_f32_16x16x32_bf16 a[28:31], a[164:167], v[80:83], a[28:31]
    ds_read_b128 v[132:135], v10 offset:30720
    v_mfma_f32_16x16x32_bf16 a[44:47], a[168:171], v[80:83], a[44:47]
    ds_read_b128 v[136:139], v11 offset:10240
    v_mfma_f32_16x16x32_bf16 a[12:15], a[248:251], v[84:87], a[12:15]
    ds_read_b128 v[140:143], v11 offset:30720
    v_mfma_f32_16x16x32_bf16 a[28:31], a[252:255], v[84:87], a[28:31]
    ds_read_b64 v[144:145], v14 offset:5120
    v_mfma_f32_16x16x32_bf16 a[44:47], v[28:31], v[84:87], a[44:47]
    v_mfma_f32_16x16x32_bf16 a[60:63], v[160:163], v[40:43], 0
    v_mfma_f32_16x16x32_bf16 a[92:95], v[164:167], v[40:43], 0
    v_mfma_f32_16x16x32_bf16 a[60:63], v[180:183], v[44:47], a[60:63]
    ds_write_b128 v8, a[12:15] offset:15360
    v_mfma_f32_16x16x32_bf16 a[92:95], v[184:187], v[44:47], a[92:95]
    ds_write_b128 v8, a[28:31] offset:16384
    v_mfma_f32_16x16x32_bf16 a[60:63], v[200:203], v[48:51], a[60:63]
    ds_write_b128 v8, a[44:47] offset:17408
    v_mfma_f32_16x16x32_bf16 a[92:95], v[204:207], v[48:51], a[92:95]
    s_waitcnt lgkmcnt(3)
    v_pk_add_f32 v[128:129], v[128:129], v[132:133]
    v_pk_add_f32 v[136:137], v[136:137], v[140:141]
    v_mfma_f32_16x16x32_bf16 a[60:63], v[220:223], v[52:55], a[60:63]
    v_pk_add_f32 v[130:131], v[130:131], v[134:135]
    v_pk_add_f32 v[138:139], v[138:139], v[142:143]
    v_mfma_f32_16x16x32_bf16 a[92:95], v[224:227], v[52:55], a[92:95]
    v_pk_add_f32 v[128:129], v[128:129], v[136:137]
    v_pk_add_f32 v[130:131], v[130:131], v[138:139]
    v_mfma_f32_16x16x32_bf16 a[60:63], v[240:243], v[56:59], a[60:63]
    v_lshlrev_b32 v132, 16, v144
    v_and_b32 v133, 0xffff0000, v144
    v_mfma_f32_16x16x32_bf16 a[92:95], v[244:247], v[56:59], a[92:95]
    v_lshlrev_b32 v134, 16, v145
    v_and_b32 v135, 0xffff0000, v145
    v_mfma_f32_16x16x32_bf16 a[60:63], a[68:71], v[60:63], a[60:63]
    v_cvt_pk_bf16_f32 v18, v128, v129
    v_cvt_pk_bf16_f32 v19, v130, v131
    v_mfma_f32_16x16x32_bf16 a[92:95], a[72:75], v[60:63], a[92:95]
    v_lshlrev_b32 v128, 16, v18
    v_and_b32 v129, 0xffff0000, v18
    v_mfma_f32_16x16x32_bf16 a[60:63], v[96:99], v[64:67], a[60:63]
    v_lshlrev_b32 v130, 16, v19
    v_and_b32 v131, 0xffff0000, v19
    v_mfma_f32_16x16x32_bf16 a[92:95], v[100:103], v[64:67], a[92:95]
    v_pk_add_f32 v[128:129], v[128:129], v[132:133]
    v_pk_add_f32 v[130:131], v[130:131], v[134:135]
    v_mfma_f32_16x16x32_bf16 a[60:63], v[116:119], v[68:71], a[60:63]
    v_cvt_pk_bf16_f32 v20, v128, v129
    v_cvt_pk_bf16_f32 v21, v130, v131
    v_mfma_f32_16x16x32_bf16 a[92:95], v[120:123], v[68:71], a[92:95]
    buffer_store_dwordx2 v[20:21], v0, s[56:59], s18 offen offset:0
    v_mfma_f32_16x16x32_bf16 a[60:63], a[132:135], v[72:75], a[60:63]
    v_mfma_f32_16x16x32_bf16 a[92:95], a[136:139], v[72:75], a[92:95]
    v_mfma_f32_16x16x32_bf16 a[60:63], a[152:155], v[76:79], a[60:63]
    v_mfma_f32_16x16x32_bf16 a[92:95], a[156:159], v[76:79], a[92:95]
    v_mfma_f32_16x16x32_bf16 a[60:63], a[240:243], v[80:83], a[60:63]
    v_mfma_f32_16x16x32_bf16 a[92:95], a[244:247], v[80:83], a[92:95]
    v_mfma_f32_16x16x32_bf16 a[60:63], v[32:35], v[84:87], a[60:63]
    v_mfma_f32_16x16x32_bf16 a[92:95], v[36:39], v[84:87], a[92:95]
    s_nop 7
    ds_write_b128 v8, a[60:63] offset:18432
    ds_write_b128 v8, a[92:95] offset:19456
    s_waitcnt lgkmcnt(0)
    s_barrier
    ds_read_b128 v[88:91], v10 offset:15360
    ds_read_b128 v[92:95], v10 offset:35840
    ds_read_b128 v[96:99], v11 offset:15360
    ds_read_b128 v[100:103], v11 offset:35840
    ds_read_b64 v[104:105], v14 offset:7680
    ds_read_b128 v[112:115], v12 offset:4096
    ds_read_b128 v[116:119], v12 offset:24576
    ds_read_b128 v[120:123], v13 offset:4096
    ds_read_b128 v[124:127], v13 offset:24576
    ds_read_b64 v[128:129], v15 offset:2048
    s_waitcnt lgkmcnt(5)
    v_pk_add_f32 v[88:89], v[88:89], v[92:93]
    v_pk_add_f32 v[96:97], v[96:97], v[100:101]
    v_pk_add_f32 v[90:91], v[90:91], v[94:95]
    v_pk_add_f32 v[98:99], v[98:99], v[102:103]
    v_pk_add_f32 v[88:89], v[88:89], v[96:97]
    v_pk_add_f32 v[90:91], v[90:91], v[98:99]
    v_lshlrev_b32 v92, 16, v104
    v_and_b32 v93, 0xffff0000, v104
    v_lshlrev_b32 v94, 16, v105
    v_and_b32 v95, 0xffff0000, v105
    v_cvt_pk_bf16_f32 v106, v88, v89
    v_cvt_pk_bf16_f32 v107, v90, v91
    v_lshlrev_b32 v88, 16, v106
    v_and_b32 v89, 0xffff0000, v106
    v_lshlrev_b32 v90, 16, v107
    v_and_b32 v91, 0xffff0000, v107
    v_pk_add_f32 v[88:89], v[88:89], v[92:93]
    v_pk_add_f32 v[90:91], v[90:91], v[94:95]
    v_cvt_pk_bf16_f32 v108, v88, v89
    v_cvt_pk_bf16_f32 v109, v90, v91
    buffer_store_dwordx2 v[108:109], v0, s[56:59], s19 offen offset:0
    s_waitcnt lgkmcnt(0)
    v_pk_add_f32 v[112:113], v[112:113], v[116:117]
    v_pk_add_f32 v[120:121], v[120:121], v[124:125]
    v_pk_add_f32 v[114:115], v[114:115], v[118:119]
    v_pk_add_f32 v[122:123], v[122:123], v[126:127]
    v_pk_add_f32 v[112:113], v[112:113], v[120:121]
    v_pk_add_f32 v[114:115], v[114:115], v[122:123]
    v_lshlrev_b32 v116, 16, v128
    v_and_b32 v117, 0xffff0000, v128
    v_lshlrev_b32 v118, 16, v129
    v_and_b32 v119, 0xffff0000, v129
    v_cvt_pk_bf16_f32 v130, v112, v113
    v_cvt_pk_bf16_f32 v131, v114, v115
    v_lshlrev_b32 v112, 16, v130
    v_and_b32 v113, 0xffff0000, v130
    v_lshlrev_b32 v114, 16, v131
    v_and_b32 v115, 0xffff0000, v131
    v_pk_add_f32 v[112:113], v[112:113], v[116:117]
    v_pk_add_f32 v[114:115], v[114:115], v[118:119]
    v_cvt_pk_bf16_f32 v132, v112, v113
    v_cvt_pk_bf16_f32 v133, v114, v115
    buffer_store_dwordx2 v[132:133], v7, s[56:59], s16 offen offset:128
kf_kernel_end:
    s_endpgm
kf_sg_slow:
    s_mov_b32 s7, 0
kf_sg_loop:
    s_sleep 2
    buffer_load_dword v55, v31, s[48:51], 0 offen sc1
    s_waitcnt vmcnt(0)
    s_add_u32 s7, s7, 1
    s_cmp_ge_u32 s7, 65536
    s_cbranch_scc1 kf_sg_go
    v_cmp_ne_u32 vcc, 1511506921, v55
    s_cbranch_vccnz kf_sg_loop
    s_branch kf_sg_go
kf_fw_slow:
    s_mov_b32 s7, 0
kf_fw_loop:
    s_sleep 2
    buffer_load_dword v31, v0, s[48:51], s94 offen offset:512 sc1
    s_waitcnt vmcnt(0)
    s_add_u32 s7, s7, 1
    s_cmp_ge_u32 s7, 65536
    s_cbranch_scc1 kf_fw_ok
    v_cmp_le_i32 vcc, 0, v31
    s_cbranch_vccnz kf_fw_loop
    s_branch kf_fw_ok
kf_x_slow:
    s_mov_b32 s7, 0
kf_x_loop:
    buffer_load_dwordx4 v[172:175], v17, s[48:51], s61 offen offset:0 sc1
    buffer_load_dwordx4 v[176:179], v17, s[48:51], s61 offen offset:1024 sc1
    buffer_load_dwordx4 v[180:183], v17, s[48:51], s61 offen offset:2048 sc1
    s_waitcnt vmcnt(0)
    s_add_u32 s7, s7, 1
    s_cmp_ge_u32 s7, 65536
    s_cbranch_scc1 kf_x_ok
    v_add3_u32 v184, s97, v172, v173
    v_add3_u32 v184, v184, v174, v175
    v_add3_u32 v184, v184, v176, v177
    v_add3_u32 v184, v184, v178, v179
    v_add3_u32 v184, v184, v180, v181
    v_cmp_ne_u32 vcc, v184, v182
    s_cbranch_vccnz kf_x_loop
    s_branch kf_x_ok
kf_ck_slow:
    s_mov_b32 s7, 0
kf_ck_loop:
    buffer_load_dword v7, off, s[48:51], s70 sc1
    s_waitcnt vmcnt(0)
    v_readfirstlane_b32 s8, v7
    s_add_u32 s7, s7, 1
    s_cmp_ge_u32 s7, 65536
    s_cbranch_scc1 kf_ck_ok
    s_cmp_ge_u32 s8, 16
    s_cbranch_scc0 kf_ck_loop
    s_branch kf_ck_ok
kf_g20_slow:
    s_mov_b32 s7, 0
kf_g20_loop:
    buffer_load_dwordx4 a[172:175], v17, s[48:51], s92 offen offset:0 sc1
    buffer_load_dwordx4 a[176:179], v17, s[48:51], s92 offen offset:1024 sc1
    buffer_load_dwordx4 a[180:183], v17, s[48:51], s92 offen offset:2048 sc1
    buffer_load_dwordx4 a[184:187], v17, s[48:51], s92 offen offset:3072 sc1
    buffer_load_dwordx4 a[188:191], v17, s[48:51], s93 offen offset:0 sc1
    buffer_load_dwordx4 a[96:99], v17, s[48:51], s93 offen offset:1024 sc1
    buffer_load_dwordx4 a[100:103], v17, s[48:51], s93 offen offset:2048 sc1
    buffer_load_dwordx4 a[104:107], v17, s[48:51], s93 offen offset:3072 sc1
    buffer_load_dwordx4 a[108:111], v17, s[48:51], s44 offen offset:0 sc1
    buffer_load_dwordx4 a[112:115], v17, s[48:51], s44 offen offset:1024 sc1
    buffer_load_dwordx4 a[116:119], v17, s[48:51], s44 offen offset:2048 sc1
    buffer_load_dwordx4 a[120:123], v17, s[48:51], s44 offen offset:3072 sc1
kf_g20_w:
    s_waitcnt vmcnt(0)
    s_add_u32 s7, s7, 1
    s_cmp_ge_u32 s7, 65536
    s_cbranch_scc1 kf_g20_ok
    v_accvgpr_read_b32 v26, a172
    v_accvgpr_read_b32 v27, a176
    v_accvgpr_read_b32 v6, a180
    v_max3_u32 v6, v6, v26, v27
    v_cmp_eq_u32 vcc, -1, v6
    s_cbranch_vccnz kf_g20_loop
    s_branch kf_g20_ok
kf_g21_slow:
    s_mov_b32 s7, 0
kf_g21_loop:
    buffer_load_dwordx4 a[184:187], v17, s[48:51], s92 offen offset:3072 sc1
    buffer_load_dwordx4 a[188:191], v17, s[48:51], s93 offen offset:0 sc1
    buffer_load_dwordx4 a[96:99], v17, s[48:51], s93 offen offset:1024 sc1
    buffer_load_dwordx4 a[100:103], v17, s[48:51], s93 offen offset:2048 sc1
    buffer_load_dwordx4 a[104:107], v17, s[48:51], s93 offen offset:3072 sc1
    buffer_load_dwordx4 a[108:111], v17, s[48:51], s44 offen offset:0 sc1
    buffer_load_dwordx4 a[112:115], v17, s[48:51], s44 offen offset:1024 sc1
    buffer_load_dwordx4 a[116:119], v17, s[48:51], s44 offen offset:2048 sc1
    buffer_load_dwordx4 a[120:123], v17, s[48:51], s44 offen offset:3072 sc1
    buffer_load_dwordx4 v[40:43], v17, s[48:51], s45 offen offset:0 sc1
    buffer_load_dwordx4 v[44:47], v17, s[48:51], s45 offen offset:1024 sc1
kf_g21_w:
    s_waitcnt vmcnt(0)
    s_add_u32 s7, s7, 1
    s_cmp_ge_u32 s7, 65536
    s_cbranch_scc1 kf_g21_ok
    v_accvgpr_read_b32 v26, a184
    v_accvgpr_read_b32 v27, a188
    v_accvgpr_read_b32 v6, a96
    v_max3_u32 v6, v6, v26, v27
    v_cmp_eq_u32 vcc, -1, v6
    s_cbranch_vccnz kf_g21_loop
    s_branch kf_g21_ok
kf_g22_slow:
    s_mov_b32 s7, 0
kf_g22_loop:
    buffer_load_dwordx4 a[100:103], v17, s[48:51], s93 offen offset:2048 sc1
    buffer_load_dwordx4 a[104:107], v17, s[48:51], s93 offen offset:3072 sc1
    buffer_load_dwordx4 a[108:111], v17, s[48:51], s44 offen offset:0 sc1
    buffer_load_dwordx4 a[112:115], v17, s[48:51], s44 offen offset:1024 sc1
    buffer_load_dwordx4 a[116:119], v17, s[48:51], s44 offen offset:2048 sc1
    buffer_load_dwordx4 a[120:123], v17, s[48:51], s44 offen offset:3072 sc1
    buffer_load_dwordx4 v[40:43], v17, s[48:51], s45 offen offset:0 sc1
    buffer_load_dwordx4 v[44:47], v17, s[48:51], s45 offen offset:1024 sc1
    buffer_load_dwordx4 v[48:51], v17, s[48:51], s45 offen offset:2048 sc1
    buffer_load_dwordx4 v[52:55], v17, s[48:51], s45 offen offset:3072 sc1
    buffer_load_dwordx4 v[56:59], v17, s[48:51], s46 offen offset:0 sc1
kf_g22_w:
    s_waitcnt vmcnt(0)
    s_add_u32 s7, s7, 1
    s_cmp_ge_u32 s7, 65536
    s_cbranch_scc1 kf_g22_ok
    v_accvgpr_read_b32 v26, a100
    v_accvgpr_read_b32 v27, a104
    v_accvgpr_read_b32 v6, a108
    v_max3_u32 v6, v6, v26, v27
    v_cmp_eq_u32 vcc, -1, v6
    s_cbranch_vccnz kf_g22_loop
    s_branch kf_g22_ok
kf_g23_slow:
    s_mov_b32 s7, 0
kf_g23_loop:
    buffer_load_dwordx4 a[112:115], v17, s[48:51], s44 offen offset:1024 sc1
    buffer_load_dwordx4 a[116:119], v17, s[48:51], s44 offen offset:2048 sc1
    buffer_load_dwordx4 a[120:123], v17, s[48:51], s44 offen offset:3072 sc1
    buffer_load_dwordx4 v[40:43], v17, s[48:51], s45 offen offset:0 sc1
    buffer_load_dwordx4 v[44:47], v17, s[48:51], s45 offen offset:1024 sc1
    buffer_load_dwordx4 v[48:51], v17, s[48:51], s45 offen offset:2048 sc1
    buffer_load_dwordx4 v[52:55], v17, s[48:51], s45 offen offset:3072 sc1
    buffer_load_dwordx4 v[56:59], v17, s[48:51], s46 offen offset:0 sc1
    buffer_load_dwordx4 v[60:63], v17, s[48:51], s46 offen offset:1024 sc1
    buffer_load_dwordx4 v[64:67], v17, s[48:51], s46 offen offset:2048 sc1
    buffer_load_dwordx4 v[68:71], v17, s[48:51], s46 offen offset:3072 sc1
    buffer_load_dwordx4 v[72:75], v17, s[48:51], s47 offen offset:0 sc1
kf_g23_w:
    s_waitcnt vmcnt(0)
    s_add_u32 s7, s7, 1
    s_cmp_ge_u32 s7, 65536
    s_cbranch_scc1 kf_g23_ok
    v_accvgpr_read_b32 v26, a112
    v_accvgpr_read_b32 v27, a116
    v_accvgpr_read_b32 v6, a120
    v_max3_u32 v6, v6, v26, v27
    v_cmp_eq_u32 vcc, -1, v6
    s_cbranch_vccnz kf_g23_loop
    s_branch kf_g23_ok
kf_g30_slow:
    s_mov_b32 s7, 0
kf_g30_loop:
    buffer_load_dwordx4 v[40:43], v17, s[48:51], s45 offen offset:0 sc1
    buffer_load_dwordx4 v[44:47], v17, s[48:51], s45 offen offset:1024 sc1
    buffer_load_dwordx4 v[48:51], v17, s[48:51], s45 offen offset:2048 sc1
    buffer_load_dwordx4 v[52:55], v17, s[48:51], s45 offen offset:3072 sc1
    buffer_load_dwordx4 v[56:59], v17, s[48:51], s46 offen offset:0 sc1
    buffer_load_dwordx4 v[60:63], v17, s[48:51], s46 offen offset:1024 sc1
    buffer_load_dwordx4 v[64:67], v17, s[48:51], s46 offen offset:2048 sc1
    buffer_load_dwordx4 v[68:71], v17, s[48:51], s46 offen offset:3072 sc1
    buffer_load_dwordx4 v[72:75], v17, s[48:51], s47 offen offset:0 sc1
    buffer_load_dwordx4 v[76:79], v17, s[48:51], s47 offen offset:1024 sc1
    buffer_load_dwordx4 v[80:83], v17, s[48:51], s47 offen offset:2048 sc1
    buffer_load_dwordx4 v[84:87], v17, s[48:51], s47 offen offset:3072 sc1
kf_g30_w:
    s_waitcnt vmcnt(0)
    s_add_u32 s7, s7, 1
    s_cmp_ge_u32 s7, 65536
    s_cbranch_scc1 kf_g30_ok
    v_max3_u32 v6, v40, v41, v42
    v_max3_u32 v26, v43, v44, v45
    v_max3_u32 v6, v6, v46, v47
    v_max3_u32 v26, v26, v48, v49
    v_max3_u32 v6, v6, v50, v51
    v_max_u32 v6, v6, v26
    v_cmp_eq_u32 vcc, -1, v6
    s_cbranch_vccnz kf_g30_loop
    s_branch kf_g30_ok
kf_g31_slow:
    s_mov_b32 s7, 0
kf_g31_loop:
    buffer_load_dwordx4 v[52:55], v17, s[48:51], s45 offen offset:3072 sc1
    buffer_load_dwordx4 v[56:59], v17, s[48:51], s46 offen offset:0 sc1
    buffer_load_dwordx4 v[60:63], v17, s[48:51], s46 offen offset:1024 sc1
    buffer_load_dwordx4 v[64:67], v17, s[48:51], s46 offen offset:2048 sc1
    buffer_load_dwordx4 v[68:71], v17, s[48:51], s46 offen offset:3072 sc1
    buffer_load_dwordx4 v[72:75], v17, s[48:51], s47 offen offset:0 sc1
    buffer_load_dwordx4 v[76:79], v17, s[48:51], s47 offen offset:1024 sc1
    buffer_load_dwordx4 v[80:83], v17, s[48:51], s47 offen offset:2048 sc1
    buffer_load_dwordx4 v[84:87], v17, s[48:51], s47 offen offset:3072 sc1
kf_g31_w:
    s_waitcnt vmcnt(0)
    s_add_u32 s7, s7, 1
    s_cmp_ge_u32 s7, 65536
    s_cbranch_scc1 kf_g31_ok
    v_max3_u32 v6, v52, v53, v54
    v_max3_u32 v26, v55, v56, v57
    v_max3_u32 v6, v6, v58, v59
    v_max3_u32 v26, v26, v60, v61
    v_max3_u32 v6, v6, v62, v63
    v_max_u32 v6, v6, v26
    v_cmp_eq_u32 vcc, -1, v6
    s_cbranch_vccnz kf_g31_loop
    s_branch kf_g31_ok
kf_g32_slow:
    s_mov_b32 s7, 0
kf_g32_loop:
    buffer_load_dwordx4 v[64:67], v17, s[48:51], s46 offen offset:2048 sc1
    buffer_load_dwordx4 v[68:71], v17, s[48:51], s46 offen offset:3072 sc1
    buffer_load_dwordx4 v[72:75], v17, s[48:51], s47 offen offset:0 sc1
    buffer_load_dwordx4 v[76:79], v17, s[48:51], s47 offen offset:1024 sc1
    buffer_load_dwordx4 v[80:83], v17, s[48:51], s47 offen offset:2048 sc1
    buffer_load_dwordx4 v[84:87], v17, s[48:51], s47 offen offset:3072 sc1
kf_g32_w:
    s_waitcnt vmcnt(0)
    s_add_u32 s7, s7, 1
    s_cmp_ge_u32 s7, 65536
    s_cbranch_scc1 kf_g32_ok
    v_max3_u32 v6, v64, v65, v66
    v_max3_u32 v26, v67, v68, v69
    v_max3_u32 v6, v6, v70, v71
    v_max3_u32 v26, v26, v72, v73
    v_max3_u32 v6, v6, v74, v75
    v_max_u32 v6, v6, v26
    v_cmp_eq_u32 vcc, -1, v6
    s_cbranch_vccnz kf_g32_loop
    s_branch kf_g32_ok
kf_g33_slow:
    s_mov_b32 s7, 0
kf_g33_loop:
    buffer_load_dwordx4 v[76:79], v17, s[48:51], s47 offen offset:1024 sc1
    buffer_load_dwordx4 v[80:83], v17, s[48:51], s47 offen offset:2048 sc1
    buffer_load_dwordx4 v[84:87], v17, s[48:51], s47 offen offset:3072 sc1
kf_g33_w:
    s_waitcnt vmcnt(0)
    s_add_u32 s7, s7, 1
    s_cmp_ge_u32 s7, 65536
    s_cbranch_scc1 kf_g33_ok
    v_max3_u32 v6, v76, v77, v78
    v_max3_u32 v26, v79, v80, v81
    v_max3_u32 v6, v6, v82, v83
    v_max3_u32 v26, v26, v84, v85
    v_max3_u32 v6, v6, v86, v87
    v_max_u32 v6, v6, v26
    v_cmp_eq_u32 vcc, -1, v6
    s_cbranch_vccnz kf_g33_loop
    s_branch kf_g33_ok
kf_a0_slow:
    s_mov_b32 s7, 0
kf_a0_loop:
    buffer_load_dwordx4 v[40:43], v17, s[48:51], s86 offen offset:0 sc1
    buffer_load_dwordx4 v[44:47], v17, s[48:51], s86 offen offset:1024 sc1
    buffer_load_dwordx4 v[48:51], v17, s[48:51], s86 offen offset:2048 sc1
    buffer_load_dwordx4 v[52:55], v17, s[48:51], s86 offen offset:3072 sc1
    buffer_load_dwordx4 v[56:59], v17, s[48:51], s87 offen offset:0 sc1
    buffer_load_dwordx4 v[60:63], v17, s[48:51], s87 offen offset:1024 sc1
    buffer_load_dwordx4 v[64:67], v17, s[48:51], s87 offen offset:2048 sc1
    buffer_load_dwordx4 v[68:71], v17, s[48:51], s87 offen offset:3072 sc1
    buffer_load_dwordx4 v[72:75], v17, s[48:51], s88 offen offset:0 sc1
    buffer_load_dwordx4 v[76:79], v17, s[48:51], s88 offen offset:1024 sc1
    buffer_load_dwordx4 v[80:83], v17, s[48:51], s88 offen offset:2048 sc1
    buffer_load_dwordx4 v[84:87], v17, s[48:51], s88 offen offset:3072 sc1
    s_waitcnt vmcnt(0)
    v_mfma_f32_16x16x32_bf16 a[0:3], v[148:151], v[40:43], 0
    v_mfma_f32_16x16x32_bf16 a[16:19], v[152:155], v[40:43], 0
    v_mfma_f32_16x16x32_bf16 a[32:35], v[156:159], v[40:43], 0
    v_mfma_f32_16x16x32_bf16 a[48:51], v[160:163], v[40:43], 0
    v_mfma_f32_16x16x32_bf16 a[80:83], v[164:167], v[40:43], 0
    v_mfma_f32_16x16x32_bf16 a[0:3], v[168:171], v[44:47], a[0:3]
    v_mfma_f32_16x16x32_bf16 a[16:19], v[172:175], v[44:47], a[16:19]
    v_mfma_f32_16x16x32_bf16 a[32:35], v[176:179], v[44:47], a[32:35]
    v_mfma_f32_16x16x32_bf16 a[48:51], v[180:183], v[44:47], a[48:51]
    v_mfma_f32_16x16x32_bf16 a[80:83], v[184:187], v[44:47], a[80:83]
    v_mfma_f32_16x16x32_bf16 a[0:3], v[188:191], v[48:51], a[0:3]
    v_mfma_f32_16x16x32_bf16 a[16:19], v[192:195], v[48:51], a[16:19]
    v_mfma_f32_16x16x32_bf16 a[32:35], v[196:199], v[48:51], a[32:35]
    v_mfma_f32_16x16x32_bf16 a[48:51], v[200:203], v[48:51], a[48:51]
    v_mfma_f32_16x16x32_bf16 a[80:83], v[204:207], v[48:51], a[80:83]
    v_mfma_f32_16x16x32_bf16 a[0:3], v[208:211], v[52:55], a[0:3]
    v_mfma_f32_16x16x32_bf16 a[16:19], v[212:215], v[52:55], a[16:19]
    v_mfma_f32_16x16x32_bf16 a[32:35], v[216:219], v[52:55], a[32:35]
    v_mfma_f32_16x16x32_bf16 a[48:51], v[220:223], v[52:55], a[48:51]
    v_mfma_f32_16x16x32_bf16 a[80:83], v[224:227], v[52:55], a[80:83]
    v_mfma_f32_16x16x32_bf16 a[0:3], v[228:231], v[56:59], a[0:3]
    v_mfma_f32_16x16x32_bf16 a[16:19], v[232:235], v[56:59], a[16:19]
    v_mfma_f32_16x16x32_bf16 a[32:35], v[236:239], v[56:59], a[32:35]
    v_mfma_f32_16x16x32_bf16 a[48:51], v[240:243], v[56:59], a[48:51]
    v_mfma_f32_16x16x32_bf16 a[80:83], v[244:247], v[56:59], a[80:83]
    v_mfma_f32_16x16x32_bf16 a[0:3], v[248:251], v[60:63], a[0:3]
    v_mfma_f32_16x16x32_bf16 a[16:19], v[252:255], v[60:63], a[16:19]
    v_mfma_f32_16x16x32_bf16 a[32:35], a[64:67], v[60:63], a[32:35]
    v_mfma_f32_16x16x32_bf16 a[48:51], a[68:71], v[60:63], a[48:51]
    v_mfma_f32_16x16x32_bf16 a[80:83], a[72:75], v[60:63], a[80:83]
    v_mfma_f32_16x16x32_bf16 a[0:3], a[76:79], v[64:67], a[0:3]
    v_mfma_f32_16x16x32_bf16 a[16:19], v[88:91], v[64:67], a[16:19]
    v_mfma_f32_16x16x32_bf16 a[32:35], v[92:95], v[64:67], a[32:35]
    v_mfma_f32_16x16x32_bf16 a[48:51], v[96:99], v[64:67], a[48:51]
    v_mfma_f32_16x16x32_bf16 a[80:83], v[100:103], v[64:67], a[80:83]
    v_mfma_f32_16x16x32_bf16 a[0:3], v[104:107], v[68:71], a[0:3]
    v_mfma_f32_16x16x32_bf16 a[16:19], v[108:111], v[68:71], a[16:19]
    v_mfma_f32_16x16x32_bf16 a[32:35], v[112:115], v[68:71], a[32:35]
    v_mfma_f32_16x16x32_bf16 a[48:51], v[116:119], v[68:71], a[48:51]
    v_mfma_f32_16x16x32_bf16 a[80:83], v[120:123], v[68:71], a[80:83]
    v_mfma_f32_16x16x32_bf16 a[0:3], v[124:127], v[72:75], a[0:3]
    v_mfma_f32_16x16x32_bf16 a[16:19], a[124:127], v[72:75], a[16:19]
    v_mfma_f32_16x16x32_bf16 a[32:35], a[128:131], v[72:75], a[32:35]
    v_mfma_f32_16x16x32_bf16 a[48:51], a[132:135], v[72:75], a[48:51]
    v_mfma_f32_16x16x32_bf16 a[80:83], a[136:139], v[72:75], a[80:83]
    v_mfma_f32_16x16x32_bf16 a[0:3], a[140:143], v[76:79], a[0:3]
    v_mfma_f32_16x16x32_bf16 a[16:19], a[144:147], v[76:79], a[16:19]
    v_mfma_f32_16x16x32_bf16 a[32:35], a[148:151], v[76:79], a[32:35]
    v_mfma_f32_16x16x32_bf16 a[48:51], a[152:155], v[76:79], a[48:51]
    v_mfma_f32_16x16x32_bf16 a[80:83], a[156:159], v[76:79], a[80:83]
    v_mfma_f32_16x16x32_bf16 a[0:3], a[160:163], v[80:83], a[0:3]
    v_mfma_f32_16x16x32_bf16 a[16:19], a[164:167], v[80:83], a[16:19]
    v_mfma_f32_16x16x32_bf16 a[32:35], a[168:171], v[80:83], a[32:35]
    v_mfma_f32_16x16x32_bf16 a[48:51], a[240:243], v[80:83], a[48:51]
    v_mfma_f32_16x16x32_bf16 a[80:83], a[244:247], v[80:83], a[80:83]
    v_mfma_f32_16x16x32_bf16 a[0:3], a[248:251], v[84:87], a[0:3]
    v_mfma_f32_16x16x32_bf16 a[16:19], a[252:255], v[84:87], a[16:19]
    v_mfma_f32_16x16x32_bf16 a[32:35], v[28:31], v[84:87], a[32:35]
    v_mfma_f32_16x16x32_bf16 a[48:51], v[32:35], v[84:87], a[48:51]
    v_mfma_f32_16x16x32_bf16 a[80:83], v[36:39], v[84:87], a[80:83]
    s_nop 7
    s_nop 7
    s_add_u32 s7, s7, 1
    s_cmp_ge_u32 s7, 16384
    s_cbranch_scc1 kf_a0_ok
    v_accvgpr_read_b32 v5, a0
    v_cmp_u_f32 vcc, v5, v5
    s_cbranch_vccnz kf_a0_loop
    s_branch kf_a0_ok
kf_a1_slow:
    s_mov_b32 s7, 0
kf_a1_loop:
    buffer_load_dwordx4 a[192:195], v17, s[48:51], s89 offen offset:0 sc1
    buffer_load_dwordx4 a[196:199], v17, s[48:51], s89 offen offset:1024 sc1
    buffer_load_dwordx4 a[200:203], v17, s[48:51], s89 offen offset:2048 sc1
    buffer_load_dwordx4 a[204:207], v17, s[48:51], s89 offen offset:3072 sc1
    buffer_load_dwordx4 a[208:211], v17, s[48:51], s90 offen offset:0 sc1
    buffer_load_dwordx4 a[212:215], v17, s[48:51], s90 offen offset:1024 sc1
    buffer_load_dwordx4 a[216:219], v17, s[48:51], s90 offen offset:2048 sc1
    buffer_load_dwordx4 a[220:223], v17, s[48:51], s90 offen offset:3072 sc1
    buffer_load_dwordx4 a[224:227], v17, s[48:51], s91 offen offset:0 sc1
    buffer_load_dwordx4 a[228:231], v17, s[48:51], s91 offen offset:1024 sc1
    buffer_load_dwordx4 a[232:235], v17, s[48:51], s91 offen offset:2048 sc1
    buffer_load_dwordx4 a[236:239], v17, s[48:51], s91 offen offset:3072 sc1
    s_waitcnt vmcnt(0)
    v_mfma_f32_16x16x32_bf16 a[4:7], v[148:151], a[192:195], 0
    v_mfma_f32_16x16x32_bf16 a[20:23], v[152:155], a[192:195], 0
    v_mfma_f32_16x16x32_bf16 a[36:39], v[156:159], a[192:195], 0
    v_mfma_f32_16x16x32_bf16 a[52:55], v[160:163], a[192:195], 0
    v_mfma_f32_16x16x32_bf16 a[84:87], v[164:167], a[192:195], 0
    v_mfma_f32_16x16x32_bf16 a[4:7], v[168:171], a[196:199], a[4:7]
    v_mfma_f32_16x16x32_bf16 a[20:23], v[172:175], a[196:199], a[20:23]
    v_mfma_f32_16x16x32_bf16 a[36:39], v[176:179], a[196:199], a[36:39]
    v_mfma_f32_16x16x32_bf16 a[52:55], v[180:183], a[196:199], a[52:55]
    v_mfma_f32_16x16x32_bf16 a[84:87], v[184:187], a[196:199], a[84:87]
    v_mfma_f32_16x16x32_bf16 a[4:7], v[188:191], a[200:203], a[4:7]
    v_mfma_f32_16x16x32_bf16 a[20:23], v[192:195], a[200:203], a[20:23]
    v_mfma_f32_16x16x32_bf16 a[36:39], v[196:199], a[200:203], a[36:39]
    v_mfma_f32_16x16x32_bf16 a[52:55], v[200:203], a[200:203], a[52:55]
    v_mfma_f32_16x16x32_bf16 a[84:87], v[204:207], a[200:203], a[84:87]
    v_mfma_f32_16x16x32_bf16 a[4:7], v[208:211], a[204:207], a[4:7]
    v_mfma_f32_16x16x32_bf16 a[20:23], v[212:215], a[204:207], a[20:23]
    v_mfma_f32_16x16x32_bf16 a[36:39], v[216:219], a[204:207], a[36:39]
    v_mfma_f32_16x16x32_bf16 a[52:55], v[220:223], a[204:207], a[52:55]
    v_mfma_f32_16x16x32_bf16 a[84:87], v[224:227], a[204:207], a[84:87]
    v_mfma_f32_16x16x32_bf16 a[4:7], v[228:231], a[208:211], a[4:7]
    v_mfma_f32_16x16x32_bf16 a[20:23], v[232:235], a[208:211], a[20:23]
    v_mfma_f32_16x16x32_bf16 a[36:39], v[236:239], a[208:211], a[36:39]
    v_mfma_f32_16x16x32_bf16 a[52:55], v[240:243], a[208:211], a[52:55]
    v_mfma_f32_16x16x32_bf16 a[84:87], v[244:247], a[208:211], a[84:87]
    v_mfma_f32_16x16x32_bf16 a[4:7], v[248:251], a[212:215], a[4:7]
    v_mfma_f32_16x16x32_bf16 a[20:23], v[252:255], a[212:215], a[20:23]
    v_mfma_f32_16x16x32_bf16 a[36:39], a[64:67], a[212:215], a[36:39]
    v_mfma_f32_16x16x32_bf16 a[52:55], a[68:71], a[212:215], a[52:55]
    v_mfma_f32_16x16x32_bf16 a[84:87], a[72:75], a[212:215], a[84:87]
    v_mfma_f32_16x16x32_bf16 a[4:7], a[76:79], a[216:219], a[4:7]
    v_mfma_f32_16x16x32_bf16 a[20:23], v[88:91], a[216:219], a[20:23]
    v_mfma_f32_16x16x32_bf16 a[36:39], v[92:95], a[216:219], a[36:39]
    v_mfma_f32_16x16x32_bf16 a[52:55], v[96:99], a[216:219], a[52:55]
    v_mfma_f32_16x16x32_bf16 a[84:87], v[100:103], a[216:219], a[84:87]
    v_mfma_f32_16x16x32_bf16 a[4:7], v[104:107], a[220:223], a[4:7]
    v_mfma_f32_16x16x32_bf16 a[20:23], v[108:111], a[220:223], a[20:23]
    v_mfma_f32_16x16x32_bf16 a[36:39], v[112:115], a[220:223], a[36:39]
    v_mfma_f32_16x16x32_bf16 a[52:55], v[116:119], a[220:223], a[52:55]
    v_mfma_f32_16x16x32_bf16 a[84:87], v[120:123], a[220:223], a[84:87]
    v_mfma_f32_16x16x32_bf16 a[4:7], v[124:127], a[224:227], a[4:7]
    v_mfma_f32_16x16x32_bf16 a[20:23], a[124:127], a[224:227], a[20:23]
    v_mfma_f32_16x16x32_bf16 a[36:39], a[128:131], a[224:227], a[36:39]
    v_mfma_f32_16x16x32_bf16 a[52:55], a[132:135], a[224:227], a[52:55]
    v_mfma_f32_16x16x32_bf16 a[84:87], a[136:139], a[224:227], a[84:87]
    v_mfma_f32_16x16x32_bf16 a[4:7], a[140:143], a[228:231], a[4:7]
    v_mfma_f32_16x16x32_bf16 a[20:23], a[144:147], a[228:231], a[20:23]
    v_mfma_f32_16x16x32_bf16 a[36:39], a[148:151], a[228:231], a[36:39]
    v_mfma_f32_16x16x32_bf16 a[52:55], a[152:155], a[228:231], a[52:55]
    v_mfma_f32_16x16x32_bf16 a[84:87], a[156:159], a[228:231], a[84:87]
    v_mfma_f32_16x16x32_bf16 a[4:7], a[160:163], a[232:235], a[4:7]
    v_mfma_f32_16x16x32_bf16 a[20:23], a[164:167], a[232:235], a[20:23]
    v_mfma_f32_16x16x32_bf16 a[36:39], a[168:171], a[232:235], a[36:39]
    v_mfma_f32_16x16x32_bf16 a[52:55], a[240:243], a[232:235], a[52:55]
    v_mfma_f32_16x16x32_bf16 a[84:87], a[244:247], a[232:235], a[84:87]
    v_mfma_f32_16x16x32_bf16 a[4:7], a[248:251], a[236:239], a[4:7]
    v_mfma_f32_16x16x32_bf16 a[20:23], a[252:255], a[236:239], a[20:23]
    v_mfma_f32_16x16x32_bf16 a[36:39], v[28:31], a[236:239], a[36:39]
    v_mfma_f32_16x16x32_bf16 a[52:55], v[32:35], a[236:239], a[52:55]
    v_mfma_f32_16x16x32_bf16 a[84:87], v[36:39], a[236:239], a[84:87]
    s_nop 7
    s_nop 7
    s_add_u32 s7, s7, 1
    s_cmp_ge_u32 s7, 16384
    s_cbranch_scc1 kf_a1_ok
    v_accvgpr_read_b32 v5, a4
    v_cmp_u_f32 vcc, v5, v5
    s_cbranch_vccnz kf_a1_loop
    s_branch kf_a1_ok
kf_a2_slow:
    s_mov_b32 s7, 0
kf_a2_loop:
    buffer_load_dwordx4 a[172:175], v17, s[48:51], s92 offen offset:0 sc1
    buffer_load_dwordx4 a[176:179], v17, s[48:51], s92 offen offset:1024 sc1
    buffer_load_dwordx4 a[180:183], v17, s[48:51], s92 offen offset:2048 sc1
    buffer_load_dwordx4 a[184:187], v17, s[48:51], s92 offen offset:3072 sc1
    buffer_load_dwordx4 a[188:191], v17, s[48:51], s93 offen offset:0 sc1
    buffer_load_dwordx4 a[96:99], v17, s[48:51], s93 offen offset:1024 sc1
    buffer_load_dwordx4 a[100:103], v17, s[48:51], s93 offen offset:2048 sc1
    buffer_load_dwordx4 a[104:107], v17, s[48:51], s93 offen offset:3072 sc1
    buffer_load_dwordx4 a[108:111], v17, s[48:51], s44 offen offset:0 sc1
    buffer_load_dwordx4 a[112:115], v17, s[48:51], s44 offen offset:1024 sc1
    buffer_load_dwordx4 a[116:119], v17, s[48:51], s44 offen offset:2048 sc1
    buffer_load_dwordx4 a[120:123], v17, s[48:51], s44 offen offset:3072 sc1
    s_waitcnt vmcnt(0)
    v_mfma_f32_16x16x32_bf16 a[8:11], v[148:151], a[172:175], 0
    v_mfma_f32_16x16x32_bf16 a[24:27], v[152:155], a[172:175], 0
    v_mfma_f32_16x16x32_bf16 a[40:43], v[156:159], a[172:175], 0
    v_mfma_f32_16x16x32_bf16 a[56:59], v[160:163], a[172:175], 0
    v_mfma_f32_16x16x32_bf16 a[88:91], v[164:167], a[172:175], 0
    v_mfma_f32_16x16x32_bf16 a[8:11], v[168:171], a[176:179], a[8:11]
    v_mfma_f32_16x16x32_bf16 a[24:27], v[172:175], a[176:179], a[24:27]
    v_mfma_f32_16x16x32_bf16 a[40:43], v[176:179], a[176:179], a[40:43]
    v_mfma_f32_16x16x32_bf16 a[56:59], v[180:183], a[176:179], a[56:59]
    v_mfma_f32_16x16x32_bf16 a[88:91], v[184:187], a[176:179], a[88:91]
    v_mfma_f32_16x16x32_bf16 a[8:11], v[188:191], a[180:183], a[8:11]
    v_mfma_f32_16x16x32_bf16 a[24:27], v[192:195], a[180:183], a[24:27]
    v_mfma_f32_16x16x32_bf16 a[40:43], v[196:199], a[180:183], a[40:43]
    v_mfma_f32_16x16x32_bf16 a[56:59], v[200:203], a[180:183], a[56:59]
    v_mfma_f32_16x16x32_bf16 a[88:91], v[204:207], a[180:183], a[88:91]
    v_mfma_f32_16x16x32_bf16 a[8:11], v[208:211], a[184:187], a[8:11]
    v_mfma_f32_16x16x32_bf16 a[24:27], v[212:215], a[184:187], a[24:27]
    v_mfma_f32_16x16x32_bf16 a[40:43], v[216:219], a[184:187], a[40:43]
    v_mfma_f32_16x16x32_bf16 a[56:59], v[220:223], a[184:187], a[56:59]
    v_mfma_f32_16x16x32_bf16 a[88:91], v[224:227], a[184:187], a[88:91]
    v_mfma_f32_16x16x32_bf16 a[8:11], v[228:231], a[188:191], a[8:11]
    v_mfma_f32_16x16x32_bf16 a[24:27], v[232:235], a[188:191], a[24:27]
    v_mfma_f32_16x16x32_bf16 a[40:43], v[236:239], a[188:191], a[40:43]
    v_mfma_f32_16x16x32_bf16 a[56:59], v[240:243], a[188:191], a[56:59]
    v_mfma_f32_16x16x32_bf16 a[88:91], v[244:247], a[188:191], a[88:91]
    v_mfma_f32_16x16x32_bf16 a[8:11], v[248:251], a[96:99], a[8:11]
    v_mfma_f32_16x16x32_bf16 a[24:27], v[252:255], a[96:99], a[24:27]
    v_mfma_f32_16x16x32_bf16 a[40:43], a[64:67], a[96:99], a[40:43]
    v_mfma_f32_16x16x32_bf16 a[56:59], a[68:71], a[96:99], a[56:59]
    v_mfma_f32_16x16x32_bf16 a[88:91], a[72:75], a[96:99], a[88:91]
    v_mfma_f32_16x16x32_bf16 a[8:11], a[76:79], a[100:103], a[8:11]
    v_mfma_f32_16x16x32_bf16 a[24:27], v[88:91], a[100:103], a[24:27]
    v_mfma_f32_16x16x32_bf16 a[40:43], v[92:95], a[100:103], a[40:43]
    v_mfma_f32_16x16x32_bf16 a[56:59], v[96:99], a[100:103], a[56:59]
    v_mfma_f32_16x16x32_bf16 a[88:91], v[100:103], a[100:103], a[88:91]
    v_mfma_f32_16x16x32_bf16 a[8:11], v[104:107], a[104:107], a[8:11]
    v_mfma_f32_16x16x32_bf16 a[24:27], v[108:111], a[104:107], a[24:27]
    v_mfma_f32_16x16x32_bf16 a[40:43], v[112:115], a[104:107], a[40:43]
    v_mfma_f32_16x16x32_bf16 a[56:59], v[116:119], a[104:107], a[56:59]
    v_mfma_f32_16x16x32_bf16 a[88:91], v[120:123], a[104:107], a[88:91]
    v_mfma_f32_16x16x32_bf16 a[8:11], v[124:127], a[108:111], a[8:11]
    v_mfma_f32_16x16x32_bf16 a[24:27], a[124:127], a[108:111], a[24:27]
    v_mfma_f32_16x16x32_bf16 a[40:43], a[128:131], a[108:111], a[40:43]
    v_mfma_f32_16x16x32_bf16 a[56:59], a[132:135], a[108:111], a[56:59]
    v_mfma_f32_16x16x32_bf16 a[88:91], a[136:139], a[108:111], a[88:91]
    v_mfma_f32_16x16x32_bf16 a[8:11], a[140:143], a[112:115], a[8:11]
    v_mfma_f32_16x16x32_bf16 a[24:27], a[144:147], a[112:115], a[24:27]
    v_mfma_f32_16x16x32_bf16 a[40:43], a[148:151], a[112:115], a[40:43]
    v_mfma_f32_16x16x32_bf16 a[56:59], a[152:155], a[112:115], a[56:59]
    v_mfma_f32_16x16x32_bf16 a[88:91], a[156:159], a[112:115], a[88:91]
    v_mfma_f32_16x16x32_bf16 a[8:11], a[160:163], a[116:119], a[8:11]
    v_mfma_f32_16x16x32_bf16 a[24:27], a[164:167], a[116:119], a[24:27]
    v_mfma_f32_16x16x32_bf16 a[40:43], a[168:171], a[116:119], a[40:43]
    v_mfma_f32_16x16x32_bf16 a[56:59], a[240:243], a[116:119], a[56:59]
    v_mfma_f32_16x16x32_bf16 a[88:91], a[244:247], a[116:119], a[88:91]
    v_mfma_f32_16x16x32_bf16 a[8:11], a[248:251], a[120:123], a[8:11]
    v_mfma_f32_16x16x32_bf16 a[24:27], a[252:255], a[120:123], a[24:27]
    v_mfma_f32_16x16x32_bf16 a[40:43], v[28:31], a[120:123], a[40:43]
    v_mfma_f32_16x16x32_bf16 a[56:59], v[32:35], a[120:123], a[56:59]
    v_mfma_f32_16x16x32_bf16 a[88:91], v[36:39], a[120:123], a[88:91]
    s_nop 7
    s_nop 7
    s_add_u32 s7, s7, 1
    s_cmp_ge_u32 s7, 16384
    s_cbranch_scc1 kf_a2_ok
    v_accvgpr_read_b32 v5, a8
    v_cmp_u_f32 vcc, v5, v5
    s_cbranch_vccnz kf_a2_loop
    s_branch kf_a2_ok
kf_code_end:
.section .rodata,"a"
.p2align 6
.amdhsa_kernel kf_kernel
  .amdhsa_next_free_vgpr 512
  .amdhsa_next_free_sgpr 102
  .amdhsa_accum_offset 256
  .amdhsa_group_segment_fixed_size 0
  .amdhsa_kernarg_size 96
  .amdhsa_user_sgpr_count 2
  .amdhsa_user_sgpr_kernarg_segment_ptr 1
  .amdhsa_system_sgpr_workgroup_id_x 1
.end_amdhsa_kernel
```
